```python
import torch

def _softmax(x, axis=-1):
    return torch.softmax(x, dim=axis)

def _gelu(x):
    return torch.nn.functional.gelu(x, approximate='tanh')

def _silu(x):
    return torch.nn.functional.silu(x)

def _sigmoid(x):
    return torch.sigmoid(x)

def _layernorm(x, axis=-1, eps=1e-05):
    m = x.mean(dim=axis, keepdim=True)
    v = x.var(dim=axis, keepdim=True, unbiased=False)
    return (x - m) / torch.sqrt(v + eps)

def _scatter_add(tgt, idx, src, axis=0):
    return tgt.clone().index_add_(axis, idx, src)

def _segment_sum(src, seg, n):
    out = torch.zeros((n,) + src.shape[1:], dtype=src.dtype)
    return out.index_add_(0, seg, src)

def _pad(x, pw):
    flat = tuple((v for pair in reversed(pw) for v in pair))
    return torch.nn.functional.pad(x, flat)
kernel_name = 'standalone__tree_speculative_verify_tree_attention_over_candidate_token_tree__prompt'

def setup_inputs():

    _w = lambda a: (lambda t: t.to(torch.bfloat16) if t.is_floating_point() else t)(torch.as_tensor(a))
    B, Hq, Hkv, T, C, D = (1, 32, 8, 2048, 2048, 128)
    tree_mask = torch.zeros((B, T, T), dtype=float)
    for b in range(B):
        parent = torch.zeros(T, dtype=torch.int64)
        for i in range(1, T):
            parent[i] = int(torch.randint(0, i, (1,)).item())
        for i in range(T):
            j = i
            tree_mask[b, i, j] = 1.0
            while j > 0:
                j = parent[j]
                tree_mask[b, i, j] = 1.0
    return {'q': _w((lambda *s: torch.randn(*s, dtype=torch.bfloat16) * 0.8)(B, Hq, T, D)), 'k_cache': _w((lambda *s: torch.randn(*s, dtype=torch.bfloat16) * 0.8)(B, Hkv, C, D)), 'v_cache': _w((lambda *s: torch.randn(*s, dtype=torch.bfloat16) * 0.05)(B, Hkv, C, D)), 'k_tree': _w((lambda *s: torch.randn(*s, dtype=torch.bfloat16) * 0.8)(B, Hkv, T, D)), 'v_tree': _w((lambda *s: torch.randn(*s, dtype=torch.bfloat16) * 0.05)(B, Hkv, T, D)), 'tree_mask': _w(tree_mask)}

def reference(q, k_cache, v_cache, k_tree, v_tree, tree_mask):
    B, Hq, T, D = q.shape
    Hkv, C = (k_cache.shape[1], k_cache.shape[2])
    rep = Hq // Hkv
    kc = (lambda x, n, axis: torch.repeat_interleave(x, n, dim=axis))(k_cache, rep, axis=1)
    vc = (lambda x, n, axis: torch.repeat_interleave(x, n, dim=axis))(v_cache, rep, axis=1)
    kt = (lambda x, n, axis: torch.repeat_interleave(x, n, dim=axis))(k_tree, rep, axis=1)
    vt = (lambda x, n, axis: torch.repeat_interleave(x, n, dim=axis))(v_tree, rep, axis=1)
    k = torch.concatenate([kc, kt], axis=2)
    v = torch.concatenate([vc, vt], axis=2)
    scale = D ** (-0.5)
    scores = torch.einsum('bhqd,bhkd->bhqk', q, k) * scale
    ctx_mask = torch.ones((B, 1, T, C), dtype=scores.dtype)
    tm = tree_mask[:, None, :, :].clone()
    full_mask = torch.concatenate([ctx_mask, tm], axis=-1)
    scores = scores + (1.0 - full_mask) * -1000000000.0
    p = _softmax(scores, axis=-1)
    return torch.einsum('bhqk,bhkd->bhqd', p, v)
```

```asm
; @launch kernel=tsv_prep_kernel grid=(256,1,1) block=(256,1,1) lds=1024
; @launch kernel=standalone__tree_speculative_verify_tree_attention_over_candidate_token_tree__prompt_kernel grid=(256,1,1) block=(256,1,1) lds=163840
.amdgcn_target "amdgcn-amd-amdhsa--gfx950"
.text
.globl tsv_prep_kernel
.p2align 8
.type tsv_prep_kernel,@function
tsv_prep_kernel:
    s_cmp_ge_u32 s2, 256
    s_cbranch_scc1 PREP_END
    s_load_dwordx2 s[4:5], s[0:1], 40
    s_load_dwordx2 s[6:7], s[0:1], 64
    s_lshr_b32 s20, s2, 3
    s_and_b32 s21, s2, 7
    v_lshrrev_b32 v1, 5, v0
    v_and_b32 v2, 31, v0
    v_lshlrev_b32 v3, 2, v0
    v_mov_b32 v4, 0
    ds_write_b32 v3, v4
    s_waitcnt lgkmcnt(0)
    s_waitcnt lgkmcnt(0)
    s_mov_b32 s8, s4
    s_and_b32 s9, s5, 0xffff
    s_mov_b32 s10, 0x800000
    s_mov_b32 s11, 0x00020000
    s_mov_b32 s12, s6
    s_and_b32 s13, s7, 0xffff
    s_mov_b32 s14, 0x801000
    s_mov_b32 s15, 0x00020000
    s_add_u32 s22, s6, 0x900000
    s_addc_u32 s23, s7, 0
    s_mov_b32 s16, s22
    s_and_b32 s17, s23, 0xffff
    s_mov_b32 s18, 0x2000
    s_mov_b32 s19, 0x00020000
    v_lshlrev_b32 v5, 15, v1
    v_lshl_add_u32 v5, v2, 4, v5
    s_lshl_b32 s24, s20, 18
    s_lshl_b32 s25, s21, 9
    s_add_u32 s24, s24, s25
    buffer_load_dwordx4 v[32:35], v5, s[8:11], s24 offen
    s_add_u32 s24, s24, 4096
    buffer_load_dwordx4 v[36:39], v5, s[8:11], s24 offen
    s_add_u32 s24, s24, 4096
    buffer_load_dwordx4 v[40:43], v5, s[8:11], s24 offen
    s_add_u32 s24, s24, 4096
    buffer_load_dwordx4 v[44:47], v5, s[8:11], s24 offen
    s_add_u32 s24, s24, 4096
    buffer_load_dwordx4 v[48:51], v5, s[8:11], s24 offen
    s_add_u32 s24, s24, 4096
    buffer_load_dwordx4 v[52:55], v5, s[8:11], s24 offen
    s_add_u32 s24, s24, 4096
    buffer_load_dwordx4 v[56:59], v5, s[8:11], s24 offen
    s_add_u32 s24, s24, 4096
    buffer_load_dwordx4 v[60:63], v5, s[8:11], s24 offen
    s_add_u32 s24, s24, 4096
    s_barrier
    s_waitcnt vmcnt(0)
    v_or3_b32 v8, v32, v36, v40
    v_or3_b32 v8, v8, v44, v48
    v_or3_b32 v8, v8, v52, v56
    v_or_b32 v8, v8, v60
    v_and_b32 v8, 0x7fff7fff, v8
    v_add_u32 v8, 0x7fff7fff, v8
    v_or3_b32 v9, v33, v37, v41
    v_or3_b32 v9, v9, v45, v49
    v_or3_b32 v9, v9, v53, v57
    v_or_b32 v9, v9, v61
    v_and_b32 v9, 0x7fff7fff, v9
    v_add_u32 v9, 0x7fff7fff, v9
    v_or3_b32 v10, v34, v38, v42
    v_or3_b32 v10, v10, v46, v50
    v_or3_b32 v10, v10, v54, v58
    v_or_b32 v10, v10, v62
    v_and_b32 v10, 0x7fff7fff, v10
    v_add_u32 v10, 0x7fff7fff, v10
    v_or3_b32 v11, v35, v39, v43
    v_or3_b32 v11, v11, v47, v51
    v_or3_b32 v11, v11, v55, v59
    v_or_b32 v11, v11, v63
    v_and_b32 v11, 0x7fff7fff, v11
    v_add_u32 v11, 0x7fff7fff, v11
    v_mov_b32 v12, 0
    v_bfe_u32 v13, v8, 15, 1
    v_lshl_or_b32 v12, v13, 0, v12
    v_lshrrev_b32 v13, 31, v8
    v_lshl_or_b32 v12, v13, 1, v12
    v_bfe_u32 v13, v9, 15, 1
    v_lshl_or_b32 v12, v13, 2, v12
    v_lshrrev_b32 v13, 31, v9
    v_lshl_or_b32 v12, v13, 3, v12
    v_bfe_u32 v13, v10, 15, 1
    v_lshl_or_b32 v12, v13, 4, v12
    v_lshrrev_b32 v13, 31, v10
    v_lshl_or_b32 v12, v13, 5, v12
    v_bfe_u32 v13, v11, 15, 1
    v_lshl_or_b32 v12, v13, 6, v12
    v_lshrrev_b32 v13, 31, v11
    v_lshl_or_b32 v12, v13, 7, v12
    v_and_b32 v13, 3, v2
    v_lshlrev_b32 v13, 3, v13
    v_lshlrev_b32 v12, v13, v12
    v_lshrrev_b32 v13, 2, v2
    v_lshlrev_b32 v13, 2, v13
    ds_or_b32 v13, v12
    s_mov_b32 s26, 0xce6e6b28
    v_lshlrev_b32 v14, 16, v32
    v_and_b32 v15, 0xffff0000, v32
    v_sub_f32 v14, 1.0, v14
    v_sub_f32 v15, 1.0, v15
    v_cvt_pk_bf16_f32 v16, v14, v15
    v_lshlrev_b32 v14, 16, v16
    v_and_b32 v15, 0xffff0000, v16
    v_mul_f32 v14, s26, v14
    v_mul_f32 v15, s26, v15
    v_cvt_pk_bf16_f32 v32, v14, v15
    v_lshlrev_b32 v14, 16, v33
    v_and_b32 v15, 0xffff0000, v33
    v_sub_f32 v14, 1.0, v14
    v_sub_f32 v15, 1.0, v15
    v_cvt_pk_bf16_f32 v16, v14, v15
    v_lshlrev_b32 v14, 16, v16
    v_and_b32 v15, 0xffff0000, v16
    v_mul_f32 v14, s26, v14
    v_mul_f32 v15, s26, v15
    v_cvt_pk_bf16_f32 v33, v14, v15
    v_lshlrev_b32 v14, 16, v34
    v_and_b32 v15, 0xffff0000, v34
    v_sub_f32 v14, 1.0, v14
    v_sub_f32 v15, 1.0, v15
    v_cvt_pk_bf16_f32 v16, v14, v15
    v_lshlrev_b32 v14, 16, v16
    v_and_b32 v15, 0xffff0000, v16
    v_mul_f32 v14, s26, v14
    v_mul_f32 v15, s26, v15
    v_cvt_pk_bf16_f32 v34, v14, v15
    v_lshlrev_b32 v14, 16, v35
    v_and_b32 v15, 0xffff0000, v35
    v_sub_f32 v14, 1.0, v14
    v_sub_f32 v15, 1.0, v15
    v_cvt_pk_bf16_f32 v16, v14, v15
    v_lshlrev_b32 v14, 16, v16
    v_and_b32 v15, 0xffff0000, v16
    v_mul_f32 v14, s26, v14
    v_mul_f32 v15, s26, v15
    v_cvt_pk_bf16_f32 v35, v14, v15
    v_lshlrev_b32 v14, 16, v36
    v_and_b32 v15, 0xffff0000, v36
    v_sub_f32 v14, 1.0, v14
    v_sub_f32 v15, 1.0, v15
    v_cvt_pk_bf16_f32 v16, v14, v15
    v_lshlrev_b32 v14, 16, v16
    v_and_b32 v15, 0xffff0000, v16
    v_mul_f32 v14, s26, v14
    v_mul_f32 v15, s26, v15
    v_cvt_pk_bf16_f32 v36, v14, v15
    v_lshlrev_b32 v14, 16, v37
    v_and_b32 v15, 0xffff0000, v37
    v_sub_f32 v14, 1.0, v14
    v_sub_f32 v15, 1.0, v15
    v_cvt_pk_bf16_f32 v16, v14, v15
    v_lshlrev_b32 v14, 16, v16
    v_and_b32 v15, 0xffff0000, v16
    v_mul_f32 v14, s26, v14
    v_mul_f32 v15, s26, v15
    v_cvt_pk_bf16_f32 v37, v14, v15
    v_lshlrev_b32 v14, 16, v38
    v_and_b32 v15, 0xffff0000, v38
    v_sub_f32 v14, 1.0, v14
    v_sub_f32 v15, 1.0, v15
    v_cvt_pk_bf16_f32 v16, v14, v15
    v_lshlrev_b32 v14, 16, v16
    v_and_b32 v15, 0xffff0000, v16
    v_mul_f32 v14, s26, v14
    v_mul_f32 v15, s26, v15
    v_cvt_pk_bf16_f32 v38, v14, v15
    v_lshlrev_b32 v14, 16, v39
    v_and_b32 v15, 0xffff0000, v39
    v_sub_f32 v14, 1.0, v14
    v_sub_f32 v15, 1.0, v15
    v_cvt_pk_bf16_f32 v16, v14, v15
    v_lshlrev_b32 v14, 16, v16
    v_and_b32 v15, 0xffff0000, v16
    v_mul_f32 v14, s26, v14
    v_mul_f32 v15, s26, v15
    v_cvt_pk_bf16_f32 v39, v14, v15
    v_lshlrev_b32 v14, 16, v40
    v_and_b32 v15, 0xffff0000, v40
    v_sub_f32 v14, 1.0, v14
    v_sub_f32 v15, 1.0, v15
    v_cvt_pk_bf16_f32 v16, v14, v15
    v_lshlrev_b32 v14, 16, v16
    v_and_b32 v15, 0xffff0000, v16
    v_mul_f32 v14, s26, v14
    v_mul_f32 v15, s26, v15
    v_cvt_pk_bf16_f32 v40, v14, v15
    v_lshlrev_b32 v14, 16, v41
    v_and_b32 v15, 0xffff0000, v41
    v_sub_f32 v14, 1.0, v14
    v_sub_f32 v15, 1.0, v15
    v_cvt_pk_bf16_f32 v16, v14, v15
    v_lshlrev_b32 v14, 16, v16
    v_and_b32 v15, 0xffff0000, v16
    v_mul_f32 v14, s26, v14
    v_mul_f32 v15, s26, v15
    v_cvt_pk_bf16_f32 v41, v14, v15
    v_lshlrev_b32 v14, 16, v42
    v_and_b32 v15, 0xffff0000, v42
    v_sub_f32 v14, 1.0, v14
    v_sub_f32 v15, 1.0, v15
    v_cvt_pk_bf16_f32 v16, v14, v15
    v_lshlrev_b32 v14, 16, v16
    v_and_b32 v15, 0xffff0000, v16
    v_mul_f32 v14, s26, v14
    v_mul_f32 v15, s26, v15
    v_cvt_pk_bf16_f32 v42, v14, v15
    v_lshlrev_b32 v14, 16, v43
    v_and_b32 v15, 0xffff0000, v43
    v_sub_f32 v14, 1.0, v14
    v_sub_f32 v15, 1.0, v15
    v_cvt_pk_bf16_f32 v16, v14, v15
    v_lshlrev_b32 v14, 16, v16
    v_and_b32 v15, 0xffff0000, v16
    v_mul_f32 v14, s26, v14
    v_mul_f32 v15, s26, v15
    v_cvt_pk_bf16_f32 v43, v14, v15
    v_lshlrev_b32 v14, 16, v44
    v_and_b32 v15, 0xffff0000, v44
    v_sub_f32 v14, 1.0, v14
    v_sub_f32 v15, 1.0, v15
    v_cvt_pk_bf16_f32 v16, v14, v15
    v_lshlrev_b32 v14, 16, v16
    v_and_b32 v15, 0xffff0000, v16
    v_mul_f32 v14, s26, v14
    v_mul_f32 v15, s26, v15
    v_cvt_pk_bf16_f32 v44, v14, v15
    v_lshlrev_b32 v14, 16, v45
    v_and_b32 v15, 0xffff0000, v45
    v_sub_f32 v14, 1.0, v14
    v_sub_f32 v15, 1.0, v15
    v_cvt_pk_bf16_f32 v16, v14, v15
    v_lshlrev_b32 v14, 16, v16
    v_and_b32 v15, 0xffff0000, v16
    v_mul_f32 v14, s26, v14
    v_mul_f32 v15, s26, v15
    v_cvt_pk_bf16_f32 v45, v14, v15
    v_lshlrev_b32 v14, 16, v46
    v_and_b32 v15, 0xffff0000, v46
    v_sub_f32 v14, 1.0, v14
    v_sub_f32 v15, 1.0, v15
    v_cvt_pk_bf16_f32 v16, v14, v15
    v_lshlrev_b32 v14, 16, v16
    v_and_b32 v15, 0xffff0000, v16
    v_mul_f32 v14, s26, v14
    v_mul_f32 v15, s26, v15
    v_cvt_pk_bf16_f32 v46, v14, v15
    v_lshlrev_b32 v14, 16, v47
    v_and_b32 v15, 0xffff0000, v47
    v_sub_f32 v14, 1.0, v14
    v_sub_f32 v15, 1.0, v15
    v_cvt_pk_bf16_f32 v16, v14, v15
    v_lshlrev_b32 v14, 16, v16
    v_and_b32 v15, 0xffff0000, v16
    v_mul_f32 v14, s26, v14
    v_mul_f32 v15, s26, v15
    v_cvt_pk_bf16_f32 v47, v14, v15
    v_lshlrev_b32 v14, 16, v48
    v_and_b32 v15, 0xffff0000, v48
    v_sub_f32 v14, 1.0, v14
    v_sub_f32 v15, 1.0, v15
    v_cvt_pk_bf16_f32 v16, v14, v15
    v_lshlrev_b32 v14, 16, v16
    v_and_b32 v15, 0xffff0000, v16
    v_mul_f32 v14, s26, v14
    v_mul_f32 v15, s26, v15
    v_cvt_pk_bf16_f32 v48, v14, v15
    v_lshlrev_b32 v14, 16, v49
    v_and_b32 v15, 0xffff0000, v49
    v_sub_f32 v14, 1.0, v14
    v_sub_f32 v15, 1.0, v15
    v_cvt_pk_bf16_f32 v16, v14, v15
    v_lshlrev_b32 v14, 16, v16
    v_and_b32 v15, 0xffff0000, v16
    v_mul_f32 v14, s26, v14
    v_mul_f32 v15, s26, v15
    v_cvt_pk_bf16_f32 v49, v14, v15
    v_lshlrev_b32 v14, 16, v50
    v_and_b32 v15, 0xffff0000, v50
    v_sub_f32 v14, 1.0, v14
    v_sub_f32 v15, 1.0, v15
    v_cvt_pk_bf16_f32 v16, v14, v15
    v_lshlrev_b32 v14, 16, v16
    v_and_b32 v15, 0xffff0000, v16
    v_mul_f32 v14, s26, v14
    v_mul_f32 v15, s26, v15
    v_cvt_pk_bf16_f32 v50, v14, v15
    v_lshlrev_b32 v14, 16, v51
    v_and_b32 v15, 0xffff0000, v51
    v_sub_f32 v14, 1.0, v14
    v_sub_f32 v15, 1.0, v15
    v_cvt_pk_bf16_f32 v16, v14, v15
    v_lshlrev_b32 v14, 16, v16
    v_and_b32 v15, 0xffff0000, v16
    v_mul_f32 v14, s26, v14
    v_mul_f32 v15, s26, v15
    v_cvt_pk_bf16_f32 v51, v14, v15
    v_lshlrev_b32 v14, 16, v52
    v_and_b32 v15, 0xffff0000, v52
    v_sub_f32 v14, 1.0, v14
    v_sub_f32 v15, 1.0, v15
    v_cvt_pk_bf16_f32 v16, v14, v15
    v_lshlrev_b32 v14, 16, v16
    v_and_b32 v15, 0xffff0000, v16
    v_mul_f32 v14, s26, v14
    v_mul_f32 v15, s26, v15
    v_cvt_pk_bf16_f32 v52, v14, v15
    v_lshlrev_b32 v14, 16, v53
    v_and_b32 v15, 0xffff0000, v53
    v_sub_f32 v14, 1.0, v14
    v_sub_f32 v15, 1.0, v15
    v_cvt_pk_bf16_f32 v16, v14, v15
    v_lshlrev_b32 v14, 16, v16
    v_and_b32 v15, 0xffff0000, v16
    v_mul_f32 v14, s26, v14
    v_mul_f32 v15, s26, v15
    v_cvt_pk_bf16_f32 v53, v14, v15
    v_lshlrev_b32 v14, 16, v54
    v_and_b32 v15, 0xffff0000, v54
    v_sub_f32 v14, 1.0, v14
    v_sub_f32 v15, 1.0, v15
    v_cvt_pk_bf16_f32 v16, v14, v15
    v_lshlrev_b32 v14, 16, v16
    v_and_b32 v15, 0xffff0000, v16
    v_mul_f32 v14, s26, v14
    v_mul_f32 v15, s26, v15
    v_cvt_pk_bf16_f32 v54, v14, v15
    v_lshlrev_b32 v14, 16, v55
    v_and_b32 v15, 0xffff0000, v55
    v_sub_f32 v14, 1.0, v14
    v_sub_f32 v15, 1.0, v15
    v_cvt_pk_bf16_f32 v16, v14, v15
    v_lshlrev_b32 v14, 16, v16
    v_and_b32 v15, 0xffff0000, v16
    v_mul_f32 v14, s26, v14
    v_mul_f32 v15, s26, v15
    v_cvt_pk_bf16_f32 v55, v14, v15
    v_lshlrev_b32 v14, 16, v56
    v_and_b32 v15, 0xffff0000, v56
    v_sub_f32 v14, 1.0, v14
    v_sub_f32 v15, 1.0, v15
    v_cvt_pk_bf16_f32 v16, v14, v15
    v_lshlrev_b32 v14, 16, v16
    v_and_b32 v15, 0xffff0000, v16
    v_mul_f32 v14, s26, v14
    v_mul_f32 v15, s26, v15
    v_cvt_pk_bf16_f32 v56, v14, v15
    v_lshlrev_b32 v14, 16, v57
    v_and_b32 v15, 0xffff0000, v57
    v_sub_f32 v14, 1.0, v14
    v_sub_f32 v15, 1.0, v15
    v_cvt_pk_bf16_f32 v16, v14, v15
    v_lshlrev_b32 v14, 16, v16
    v_and_b32 v15, 0xffff0000, v16
    v_mul_f32 v14, s26, v14
    v_mul_f32 v15, s26, v15
    v_cvt_pk_bf16_f32 v57, v14, v15
    v_lshlrev_b32 v14, 16, v58
    v_and_b32 v15, 0xffff0000, v58
    v_sub_f32 v14, 1.0, v14
    v_sub_f32 v15, 1.0, v15
    v_cvt_pk_bf16_f32 v16, v14, v15
    v_lshlrev_b32 v14, 16, v16
    v_and_b32 v15, 0xffff0000, v16
    v_mul_f32 v14, s26, v14
    v_mul_f32 v15, s26, v15
    v_cvt_pk_bf16_f32 v58, v14, v15
    v_lshlrev_b32 v14, 16, v59
    v_and_b32 v15, 0xffff0000, v59
    v_sub_f32 v14, 1.0, v14
    v_sub_f32 v15, 1.0, v15
    v_cvt_pk_bf16_f32 v16, v14, v15
    v_lshlrev_b32 v14, 16, v16
    v_and_b32 v15, 0xffff0000, v16
    v_mul_f32 v14, s26, v14
    v_mul_f32 v15, s26, v15
    v_cvt_pk_bf16_f32 v59, v14, v15
    v_lshlrev_b32 v14, 16, v60
    v_and_b32 v15, 0xffff0000, v60
    v_sub_f32 v14, 1.0, v14
    v_sub_f32 v15, 1.0, v15
    v_cvt_pk_bf16_f32 v16, v14, v15
    v_lshlrev_b32 v14, 16, v16
    v_and_b32 v15, 0xffff0000, v16
    v_mul_f32 v14, s26, v14
    v_mul_f32 v15, s26, v15
    v_cvt_pk_bf16_f32 v60, v14, v15
    v_lshlrev_b32 v14, 16, v61
    v_and_b32 v15, 0xffff0000, v61
    v_sub_f32 v14, 1.0, v14
    v_sub_f32 v15, 1.0, v15
    v_cvt_pk_bf16_f32 v16, v14, v15
    v_lshlrev_b32 v14, 16, v16
    v_and_b32 v15, 0xffff0000, v16
    v_mul_f32 v14, s26, v14
    v_mul_f32 v15, s26, v15
    v_cvt_pk_bf16_f32 v61, v14, v15
    v_lshlrev_b32 v14, 16, v62
    v_and_b32 v15, 0xffff0000, v62
    v_sub_f32 v14, 1.0, v14
    v_sub_f32 v15, 1.0, v15
    v_cvt_pk_bf16_f32 v16, v14, v15
    v_lshlrev_b32 v14, 16, v16
    v_and_b32 v15, 0xffff0000, v16
    v_mul_f32 v14, s26, v14
    v_mul_f32 v15, s26, v15
    v_cvt_pk_bf16_f32 v62, v14, v15
    v_lshlrev_b32 v14, 16, v63
    v_and_b32 v15, 0xffff0000, v63
    v_sub_f32 v14, 1.0, v14
    v_sub_f32 v15, 1.0, v15
    v_cvt_pk_bf16_f32 v16, v14, v15
    v_lshlrev_b32 v14, 16, v16
    v_and_b32 v15, 0xffff0000, v16
    v_mul_f32 v14, s26, v14
    v_mul_f32 v15, s26, v15
    v_cvt_pk_bf16_f32 v63, v14, v15
    v_lshlrev_b32 v6, 15, v2
    v_lshl_add_u32 v6, v1, 4, v6
    s_lshl_b32 s24, s21, 20
    s_lshl_b32 s25, s20, 7
    s_add_u32 s24, s24, s25
    v_and_b32 v17, 0xffff, v32
    v_lshl_or_b32 v64, v36, 16, v17
    v_and_b32 v17, 0xffff, v40
    v_lshl_or_b32 v65, v44, 16, v17
    v_and_b32 v17, 0xffff, v48
    v_lshl_or_b32 v66, v52, 16, v17
    v_and_b32 v17, 0xffff, v56
    v_lshl_or_b32 v67, v60, 16, v17
    buffer_store_dwordx4 v[64:67], v6, s[12:15], s24 offen
    s_add_u32 s24, s24, 4096
    v_lshrrev_b32 v17, 16, v32
    v_and_b32 v18, 0xffff0000, v36
    v_or_b32 v68, v18, v17
    v_lshrrev_b32 v17, 16, v40
    v_and_b32 v18, 0xffff0000, v44
    v_or_b32 v69, v18, v17
    v_lshrrev_b32 v17, 16, v48
    v_and_b32 v18, 0xffff0000, v52
    v_or_b32 v70, v18, v17
    v_lshrrev_b32 v17, 16, v56
    v_and_b32 v18, 0xffff0000, v60
    v_or_b32 v71, v18, v17
    buffer_store_dwordx4 v[68:71], v6, s[12:15], s24 offen
    s_add_u32 s24, s24, 4096
    v_and_b32 v17, 0xffff, v33
    v_lshl_or_b32 v64, v37, 16, v17
    v_and_b32 v17, 0xffff, v41
    v_lshl_or_b32 v65, v45, 16, v17
    v_and_b32 v17, 0xffff, v49
    v_lshl_or_b32 v66, v53, 16, v17
    v_and_b32 v17, 0xffff, v57
    v_lshl_or_b32 v67, v61, 16, v17
    buffer_store_dwordx4 v[64:67], v6, s[12:15], s24 offen
    s_add_u32 s24, s24, 4096
    v_lshrrev_b32 v17, 16, v33
    v_and_b32 v18, 0xffff0000, v37
    v_or_b32 v68, v18, v17
    v_lshrrev_b32 v17, 16, v41
    v_and_b32 v18, 0xffff0000, v45
    v_or_b32 v69, v18, v17
    v_lshrrev_b32 v17, 16, v49
    v_and_b32 v18, 0xffff0000, v53
    v_or_b32 v70, v18, v17
    v_lshrrev_b32 v17, 16, v57
    v_and_b32 v18, 0xffff0000, v61
    v_or_b32 v71, v18, v17
    buffer_store_dwordx4 v[68:71], v6, s[12:15], s24 offen
    s_add_u32 s24, s24, 4096
    v_and_b32 v17, 0xffff, v34
    v_lshl_or_b32 v64, v38, 16, v17
    v_and_b32 v17, 0xffff, v42
    v_lshl_or_b32 v65, v46, 16, v17
    v_and_b32 v17, 0xffff, v50
    v_lshl_or_b32 v66, v54, 16, v17
    v_and_b32 v17, 0xffff, v58
    v_lshl_or_b32 v67, v62, 16, v17
    buffer_store_dwordx4 v[64:67], v6, s[12:15], s24 offen
    s_add_u32 s24, s24, 4096
    v_lshrrev_b32 v17, 16, v34
    v_and_b32 v18, 0xffff0000, v38
    v_or_b32 v68, v18, v17
    v_lshrrev_b32 v17, 16, v42
    v_and_b32 v18, 0xffff0000, v46
    v_or_b32 v69, v18, v17
    v_lshrrev_b32 v17, 16, v50
    v_and_b32 v18, 0xffff0000, v54
    v_or_b32 v70, v18, v17
    v_lshrrev_b32 v17, 16, v58
    v_and_b32 v18, 0xffff0000, v62
    v_or_b32 v71, v18, v17
    buffer_store_dwordx4 v[68:71], v6, s[12:15], s24 offen
    s_add_u32 s24, s24, 4096
    v_and_b32 v17, 0xffff, v35
    v_lshl_or_b32 v64, v39, 16, v17
    v_and_b32 v17, 0xffff, v43
    v_lshl_or_b32 v65, v47, 16, v17
    v_and_b32 v17, 0xffff, v51
    v_lshl_or_b32 v66, v55, 16, v17
    v_and_b32 v17, 0xffff, v59
    v_lshl_or_b32 v67, v63, 16, v17
    buffer_store_dwordx4 v[64:67], v6, s[12:15], s24 offen
    s_add_u32 s24, s24, 4096
    v_lshrrev_b32 v17, 16, v35
    v_and_b32 v18, 0xffff0000, v39
    v_or_b32 v68, v18, v17
    v_lshrrev_b32 v17, 16, v43
    v_and_b32 v18, 0xffff0000, v47
    v_or_b32 v69, v18, v17
    v_lshrrev_b32 v17, 16, v51
    v_and_b32 v18, 0xffff0000, v55
    v_or_b32 v70, v18, v17
    v_lshrrev_b32 v17, 16, v59
    v_and_b32 v18, 0xffff0000, v63
    v_or_b32 v71, v18, v17
    buffer_store_dwordx4 v[68:71], v6, s[12:15], s24 offen
    s_add_u32 s24, s24, 4096
    s_cmp_lg_u32 s2, 0
    s_cbranch_scc1 PREP_FL
    v_mov_b32 v72, 0xce6ece6e
    v_mov_b32 v73, 0xce6ece6e
    v_mov_b32 v74, 0xce6ece6e
    v_mov_b32 v75, 0xce6ece6e
    v_lshlrev_b32 v7, 4, v0
    s_mov_b32 s24, 0x800000
    buffer_store_dwordx4 v[72:75], v7, s[12:15], s24 offen
PREP_FL:
    s_waitcnt lgkmcnt(0)
    s_barrier
    v_cmp_gt_u32 vcc, 8, v0
    s_and_saveexec_b64 s[28:29], vcc
    s_cbranch_execz PREP_SKIP
    ds_read_b32 v4, v3
    s_lshl_b32 s24, s20, 8
    s_lshl_b32 s25, s21, 5
    s_add_u32 s24, s24, s25
    s_waitcnt lgkmcnt(0)
    buffer_store_dword v4, v3, s[16:19], s24 offen
PREP_SKIP:
    s_mov_b64 exec, s[28:29]
PREP_END:
    s_endpgm
.globl standalone__tree_speculative_verify_tree_attention_over_candidate_token_tree__prompt_kernel
.p2align 8
.type standalone__tree_speculative_verify_tree_attention_over_candidate_token_tree__prompt_kernel,@function
standalone__tree_speculative_verify_tree_attention_over_candidate_token_tree__prompt_kernel:
    s_cmp_ge_u32 s2, 256
    s_cbranch_scc1 MAIN_END
    s_load_dwordx16 s[56:71], s[0:1], 0
    s_load_dwordx2 s[72:73], s[0:1], 64
    v_lshrrev_b32 v1, 6, v0
    v_and_b32 v0, 63, v0
    v_readfirstlane_b32 s50, v1
    s_and_b32 s51, s2, 7
    s_lshr_b32 s52, s2, 3
    s_lshl_b32 s52, s52, 6
    v_and_b32 v2, 31, v0
    v_lshrrev_b32 v3, 5, v0
    v_and_b32 v4, 15, v0
    v_lshrrev_b32 v5, 4, v0
    s_lshl_b32 s53, s50, 12
    s_lshl_b32 s54, s50, 11
    v_lshlrev_b32 v6, 8, v5
    v_add_u32 v6, s53, v6
    v_or_b32 v7, 0, v5
    v_xor_b32 v7, v7, v4
    v_lshlrev_b32 v236, 4, v7
    v_add_u32 v228, v6, v236
    v_or_b32 v7, 4, v5
    v_xor_b32 v7, v7, v4
    v_lshlrev_b32 v237, 4, v7
    v_add_u32 v229, v6, v237
    v_or_b32 v7, 8, v5
    v_xor_b32 v7, v7, v4
    v_lshlrev_b32 v238, 4, v7
    v_add_u32 v230, v6, v238
    v_or_b32 v7, 12, v5
    v_xor_b32 v7, v7, v4
    v_lshlrev_b32 v239, 4, v7
    v_add_u32 v231, v6, v239
    v_lshlrev_b32 v7, 2, v5
    v_xor_b32 v7, v7, v4
    v_lshlrev_b32 v240, 4, v7
    v_add_u32 v232, v6, v240
    v_and_b32 v7, 1, v5
    v_lshlrev_b32 v7, 2, v7
    v_and_b32 v8, 7, v0
    v_xor_b32 v7, v7, v8
    v_lshlrev_b32 v7, 4, v7
    s_lshl_b32 s55, s52, 1
    v_add_u32 v243, s55, v7
    s_lshl_b32 s55, s50, 6
    v_lshlrev_b32 v7, 4, v5
    v_add_u32 v250, s55, v7
    v_bfe_u32 v7, v0, 3, 2
    v_lshlrev_b32 v7, 4, v7
    v_lshl_add_u32 v7, v3, 2, v7
    v_add_u32 v251, s55, v7
    v_lshlrev_b32 v9, 8, v2
    v_or_b32 v7, 0, v3
    v_xor_b32 v7, v7, v4
    v_lshl_add_u32 v212, v7, 4, v9
    v_or_b32 v7, 2, v3
    v_xor_b32 v7, v7, v4
    v_lshl_add_u32 v213, v7, 4, v9
    v_or_b32 v7, 4, v3
    v_xor_b32 v7, v7, v4
    v_lshl_add_u32 v214, v7, 4, v9
    v_or_b32 v7, 6, v3
    v_xor_b32 v7, v7, v4
    v_lshl_add_u32 v215, v7, 4, v9
    v_or_b32 v7, 8, v3
    v_xor_b32 v7, v7, v4
    v_lshl_add_u32 v216, v7, 4, v9
    v_or_b32 v7, 10, v3
    v_xor_b32 v7, v7, v4
    v_lshl_add_u32 v217, v7, 4, v9
    v_or_b32 v7, 12, v3
    v_xor_b32 v7, v7, v4
    v_lshl_add_u32 v218, v7, 4, v9
    v_or_b32 v7, 14, v3
    v_xor_b32 v7, v7, v4
    v_lshl_add_u32 v219, v7, 4, v9
    v_lshrrev_b32 v10, 2, v4
    v_lshl_add_u32 v11, v3, 2, v10
    v_and_b32 v7, 1, v5
    v_lshlrev_b32 v7, 5, v7
    v_and_b32 v8, 3, v0
    v_lshl_add_u32 v8, v8, 3, v7
    v_lshl_add_u32 v9, v11, 8, v8
    v_add_u32 v9, 0x4000, v9
    v_xor_b32 v7, 0, v10
    v_lshl_add_u32 v220, v7, 6, v9
    v_xor_b32 v7, 1, v10
    v_lshl_add_u32 v221, v7, 6, v9
    v_xor_b32 v7, 2, v10
    v_lshl_add_u32 v222, v7, 6, v9
    v_xor_b32 v7, 3, v10
    v_lshl_add_u32 v223, v7, 6, v9
    v_lshl_add_u32 v9, v11, 7, v8
    v_add_u32 v9, 0x20000, v9
    v_bfe_u32 v12, v10, 1, 1
    v_xor_b32 v7, 0, v12
    v_lshl_add_u32 v224, v7, 6, v9
    v_add_u32 v226, 0x2000, v224
    v_xor_b32 v7, 1, v12
    v_lshl_add_u32 v225, v7, 6, v9
    v_add_u32 v227, 0x2000, v225
    v_lshlrev_b32 v12, 8, v2
    v_lshl_add_u32 v12, v3, 4, v12
    v_add_u32 v13, 0x2000, v12
    s_waitcnt lgkmcnt(0)
    s_lshl_b32 s44, s51, 2
    s_add_u32 s44, s44, s50
    s_lshl_b32 s44, s44, 11
    s_add_u32 s44, s44, s52
    s_lshl_b32 s45, s44, 8
    s_add_u32 s56, s56, s45
    s_addc_u32 s57, s57, 0
    s_mov_b32 s4, s56
    s_and_b32 s5, s57, 0xffff
    s_mov_b32 s6, 0x4000
    s_mov_b32 s7, 0x00020000
    s_add_u32 s68, s68, s45
    s_addc_u32 s69, s69, 0
    s_mov_b32 s28, s68
    s_and_b32 s29, s69, 0xffff
    s_mov_b32 s30, 0x4000
    s_mov_b32 s31, 0x00020000
    s_lshl_b32 s45, s51, 19
    s_add_u32 s58, s58, s45
    s_addc_u32 s59, s59, 0
    s_mov_b32 s8, s58
    s_and_b32 s9, s59, 0xffff
    s_mov_b32 s10, 0x80000
    s_mov_b32 s11, 0x00020000
    s_add_u32 s60, s60, s45
    s_addc_u32 s61, s61, 0
    s_mov_b32 s12, s60
    s_and_b32 s13, s61, 0xffff
    s_mov_b32 s14, 0x80000
    s_mov_b32 s15, 0x00020000
    s_add_u32 s62, s62, s45
    s_addc_u32 s63, s63, 0
    s_mov_b32 s16, s62
    s_and_b32 s17, s63, 0xffff
    s_mov_b32 s18, 0x80000
    s_mov_b32 s19, 0x00020000
    s_add_u32 s64, s64, s45
    s_addc_u32 s65, s65, 0
    s_mov_b32 s20, s64
    s_and_b32 s21, s65, 0xffff
    s_mov_b32 s22, 0x80000
    s_mov_b32 s23, 0x00020000
    s_mov_b32 s24, s72
    s_and_b32 s25, s73, 0xffff
    s_mov_b32 s26, 0x801000
    s_mov_b32 s27, 0x00020000
    s_add_u32 s74, s72, 0x900000
    s_addc_u32 s75, s73, 0
    s_mov_b32 s32, s74
    s_and_b32 s33, s75, 0xffff
    s_mov_b32 s34, 0x2000
    s_mov_b32 s35, 0x00020000
    s_lshl_b32 s44, s2, 14
    s_add_u32 s44, s44, 0xa00000
    s_add_u32 s74, s72, s44
    s_addc_u32 s75, s73, 0
    s_mov_b32 s76, s74
    s_and_b32 s77, s75, 0xffff
    s_mov_b32 s78, 0x4000
    s_mov_b32 s79, 0x00020000
    s_mov_b32 s36, 0x3e0293ee
    s_mov_b32 s47, 0x45800000
    s_mov_b32 s37, 0
    s_mov_b32 s48, s53
    s_add_u32 m0, s48, 0
    s_nop 0
    buffer_load_dwordx4 v228, s[8:11], s37 offen offset:0 lds
    s_add_u32 m0, s48, 0
    s_nop 0
    buffer_load_dwordx4 v229, s[8:11], s37 offen offset:1024 lds
    s_add_u32 m0, s48, 0
    s_nop 0
    buffer_load_dwordx4 v230, s[8:11], s37 offen offset:2048 lds
    s_add_u32 m0, s48, 0
    s_nop 0
    buffer_load_dwordx4 v231, s[8:11], s37 offen offset:3072 lds
    s_add_u32 m0, s48, 16384
    s_nop 0
    buffer_load_dwordx4 v232, s[12:15], s37 offen offset:0 lds
    s_add_u32 m0, s48, 16384
    s_nop 0
    buffer_load_dwordx4 v232, s[12:15], s37 offen offset:1024 lds
    s_add_u32 m0, s48, 16384
    s_nop 0
    buffer_load_dwordx4 v232, s[12:15], s37 offen offset:2048 lds
    s_add_u32 m0, s48, 16384
    s_nop 0
    buffer_load_dwordx4 v232, s[12:15], s37 offen offset:3072 lds
    s_add_u32 s37, s37, 16384
    s_add_u32 s48, s48, 0x8000
    s_add_u32 m0, s48, 0
    s_nop 0
    buffer_load_dwordx4 v228, s[8:11], s37 offen offset:0 lds
    s_add_u32 m0, s48, 0
    s_nop 0
    buffer_load_dwordx4 v229, s[8:11], s37 offen offset:1024 lds
    s_add_u32 m0, s48, 0
    s_nop 0
    buffer_load_dwordx4 v230, s[8:11], s37 offen offset:2048 lds
    s_add_u32 m0, s48, 0
    s_nop 0
    buffer_load_dwordx4 v231, s[8:11], s37 offen offset:3072 lds
    s_add_u32 m0, s48, 16384
    s_nop 0
    buffer_load_dwordx4 v232, s[12:15], s37 offen offset:0 lds
    s_add_u32 m0, s48, 16384
    s_nop 0
    buffer_load_dwordx4 v232, s[12:15], s37 offen offset:1024 lds
    s_add_u32 m0, s48, 16384
    s_nop 0
    buffer_load_dwordx4 v232, s[12:15], s37 offen offset:2048 lds
    s_add_u32 m0, s48, 16384
    s_nop 0
    buffer_load_dwordx4 v232, s[12:15], s37 offen offset:3072 lds
    s_add_u32 s37, s37, 16384
    s_add_u32 s48, s48, 0x8000
    s_add_u32 m0, s48, 0
    s_nop 0
    buffer_load_dwordx4 v228, s[8:11], s37 offen offset:0 lds
    s_add_u32 m0, s48, 0
    s_nop 0
    buffer_load_dwordx4 v229, s[8:11], s37 offen offset:1024 lds
    s_add_u32 m0, s48, 0
    s_nop 0
    buffer_load_dwordx4 v230, s[8:11], s37 offen offset:2048 lds
    s_add_u32 m0, s48, 0
    s_nop 0
    buffer_load_dwordx4 v231, s[8:11], s37 offen offset:3072 lds
    s_add_u32 m0, s48, 16384
    s_nop 0
    buffer_load_dwordx4 v232, s[12:15], s37 offen offset:0 lds
    s_add_u32 m0, s48, 16384
    s_nop 0
    buffer_load_dwordx4 v232, s[12:15], s37 offen offset:1024 lds
    s_add_u32 m0, s48, 16384
    s_nop 0
    buffer_load_dwordx4 v232, s[12:15], s37 offen offset:2048 lds
    s_add_u32 m0, s48, 16384
    s_nop 0
    buffer_load_dwordx4 v232, s[12:15], s37 offen offset:3072 lds
    s_add_u32 s37, s37, 16384
    s_add_u32 s48, s48, 0x8000
    s_lshl_b32 s44, s52, 2
    v_lshlrev_b32 v16, 2, v0
    buffer_load_dword v17, v16, s[32:35], s44 offen
    buffer_load_dwordx4 a[128:131], v12, s[4:7], 0 offen offset:0
    buffer_load_dwordx4 a[132:135], v12, s[4:7], 0 offen offset:32
    buffer_load_dwordx4 a[136:139], v12, s[4:7], 0 offen offset:64
    buffer_load_dwordx4 a[140:143], v12, s[4:7], 0 offen offset:96
    buffer_load_dwordx4 a[144:147], v12, s[4:7], 0 offen offset:128
    buffer_load_dwordx4 a[148:151], v12, s[4:7], 0 offen offset:160
    buffer_load_dwordx4 a[152:155], v12, s[4:7], 0 offen offset:192
    buffer_load_dwordx4 a[156:159], v12, s[4:7], 0 offen offset:224
    buffer_load_dwordx4 a[160:163], v13, s[4:7], 0 offen offset:0
    buffer_load_dwordx4 a[164:167], v13, s[4:7], 0 offen offset:32
    buffer_load_dwordx4 a[168:171], v13, s[4:7], 0 offen offset:64
    buffer_load_dwordx4 a[172:175], v13, s[4:7], 0 offen offset:96
    buffer_load_dwordx4 a[176:179], v13, s[4:7], 0 offen offset:128
    buffer_load_dwordx4 a[180:183], v13, s[4:7], 0 offen offset:160
    buffer_load_dwordx4 a[184:187], v13, s[4:7], 0 offen offset:192
    buffer_load_dwordx4 a[188:191], v13, s[4:7], 0 offen offset:224
    v_accvgpr_write_b32 a0, 0
    v_accvgpr_write_b32 a1, 0
    v_accvgpr_write_b32 a2, 0
    v_accvgpr_write_b32 a3, 0
    v_accvgpr_write_b32 a4, 0
    v_accvgpr_write_b32 a5, 0
    v_accvgpr_write_b32 a6, 0
    v_accvgpr_write_b32 a7, 0
    v_accvgpr_write_b32 a8, 0
    v_accvgpr_write_b32 a9, 0
    v_accvgpr_write_b32 a10, 0
    v_accvgpr_write_b32 a11, 0
    v_accvgpr_write_b32 a12, 0
    v_accvgpr_write_b32 a13, 0
    v_accvgpr_write_b32 a14, 0
    v_accvgpr_write_b32 a15, 0
    v_accvgpr_write_b32 a16, 0
    v_accvgpr_write_b32 a17, 0
    v_accvgpr_write_b32 a18, 0
    v_accvgpr_write_b32 a19, 0
    v_accvgpr_write_b32 a20, 0
    v_accvgpr_write_b32 a21, 0
    v_accvgpr_write_b32 a22, 0
    v_accvgpr_write_b32 a23, 0
    v_accvgpr_write_b32 a24, 0
    v_accvgpr_write_b32 a25, 0
    v_accvgpr_write_b32 a26, 0
    v_accvgpr_write_b32 a27, 0
    v_accvgpr_write_b32 a28, 0
    v_accvgpr_write_b32 a29, 0
    v_accvgpr_write_b32 a30, 0
    v_accvgpr_write_b32 a31, 0
    v_accvgpr_write_b32 a32, 0
    v_accvgpr_write_b32 a33, 0
    v_accvgpr_write_b32 a34, 0
    v_accvgpr_write_b32 a35, 0
    v_accvgpr_write_b32 a36, 0
    v_accvgpr_write_b32 a37, 0
    v_accvgpr_write_b32 a38, 0
    v_accvgpr_write_b32 a39, 0
    v_accvgpr_write_b32 a40, 0
    v_accvgpr_write_b32 a41, 0
    v_accvgpr_write_b32 a42, 0
    v_accvgpr_write_b32 a43, 0
    v_accvgpr_write_b32 a44, 0
    v_accvgpr_write_b32 a45, 0
    v_accvgpr_write_b32 a46, 0
    v_accvgpr_write_b32 a47, 0
    v_accvgpr_write_b32 a48, 0
    v_accvgpr_write_b32 a49, 0
    v_accvgpr_write_b32 a50, 0
    v_accvgpr_write_b32 a51, 0
    v_accvgpr_write_b32 a52, 0
    v_accvgpr_write_b32 a53, 0
    v_accvgpr_write_b32 a54, 0
    v_accvgpr_write_b32 a55, 0
    v_accvgpr_write_b32 a56, 0
    v_accvgpr_write_b32 a57, 0
    v_accvgpr_write_b32 a58, 0
    v_accvgpr_write_b32 a59, 0
    v_accvgpr_write_b32 a60, 0
    v_accvgpr_write_b32 a61, 0
    v_accvgpr_write_b32 a62, 0
    v_accvgpr_write_b32 a63, 0
    v_accvgpr_write_b32 a64, 0
    v_accvgpr_write_b32 a65, 0
    v_accvgpr_write_b32 a66, 0
    v_accvgpr_write_b32 a67, 0
    v_accvgpr_write_b32 a68, 0
    v_accvgpr_write_b32 a69, 0
    v_accvgpr_write_b32 a70, 0
    v_accvgpr_write_b32 a71, 0
    v_accvgpr_write_b32 a72, 0
    v_accvgpr_write_b32 a73, 0
    v_accvgpr_write_b32 a74, 0
    v_accvgpr_write_b32 a75, 0
    v_accvgpr_write_b32 a76, 0
    v_accvgpr_write_b32 a77, 0
    v_accvgpr_write_b32 a78, 0
    v_accvgpr_write_b32 a79, 0
    v_accvgpr_write_b32 a80, 0
    v_accvgpr_write_b32 a81, 0
    v_accvgpr_write_b32 a82, 0
    v_accvgpr_write_b32 a83, 0
    v_accvgpr_write_b32 a84, 0
    v_accvgpr_write_b32 a85, 0
    v_accvgpr_write_b32 a86, 0
    v_accvgpr_write_b32 a87, 0
    v_accvgpr_write_b32 a88, 0
    v_accvgpr_write_b32 a89, 0
    v_accvgpr_write_b32 a90, 0
    v_accvgpr_write_b32 a91, 0
    v_accvgpr_write_b32 a92, 0
    v_accvgpr_write_b32 a93, 0
    v_accvgpr_write_b32 a94, 0
    v_accvgpr_write_b32 a95, 0
    v_accvgpr_write_b32 a96, 0
    v_accvgpr_write_b32 a97, 0
    v_accvgpr_write_b32 a98, 0
    v_accvgpr_write_b32 a99, 0
    v_accvgpr_write_b32 a100, 0
    v_accvgpr_write_b32 a101, 0
    v_accvgpr_write_b32 a102, 0
    v_accvgpr_write_b32 a103, 0
    v_accvgpr_write_b32 a104, 0
    v_accvgpr_write_b32 a105, 0
    v_accvgpr_write_b32 a106, 0
    v_accvgpr_write_b32 a107, 0
    v_accvgpr_write_b32 a108, 0
    v_accvgpr_write_b32 a109, 0
    v_accvgpr_write_b32 a110, 0
    v_accvgpr_write_b32 a111, 0
    v_accvgpr_write_b32 a112, 0
    v_accvgpr_write_b32 a113, 0
    v_accvgpr_write_b32 a114, 0
    v_accvgpr_write_b32 a115, 0
    v_accvgpr_write_b32 a116, 0
    v_accvgpr_write_b32 a117, 0
    v_accvgpr_write_b32 a118, 0
    v_accvgpr_write_b32 a119, 0
    v_accvgpr_write_b32 a120, 0
    v_accvgpr_write_b32 a121, 0
    v_accvgpr_write_b32 a122, 0
    v_accvgpr_write_b32 a123, 0
    v_accvgpr_write_b32 a124, 0
    v_accvgpr_write_b32 a125, 0
    v_accvgpr_write_b32 a126, 0
    v_accvgpr_write_b32 a127, 0
    v_mov_b32 v194, 0
    v_mov_b32 v195, 0
    v_mov_b32 v196, 0
    v_mov_b32 v197, 0
    s_cmp_lg_u32 s50, 0
    s_cbranch_scc1 LIST_DONE
    s_mov_b32 s44, 0
    s_waitcnt vmcnt(16)
    v_lshlrev_b32 v18, 5, v0
    v_bfe_u32 v19, v17, 0, 1
    v_cmp_ne_u32 vcc, 0, v19
    v_add_u32 v21, 0, v18
    s_nop 0
    v_mbcnt_lo_u32_b32 v20, vcc_lo, 0
    v_mbcnt_hi_u32_b32 v20, vcc_hi, v20
    v_add_u32 v20, s44, v20
    v_lshlrev_b32 v20, 2, v20
    s_mov_b64 exec, vcc
    s_cbranch_execz LB_SKIP_0
    buffer_store_dword v21, v20, s[76:79], 0 offen
LB_SKIP_0:
    s_mov_b64 exec, -1
    s_bcnt1_i32_b64 s45, vcc
    s_add_u32 s44, s44, s45
    v_bfe_u32 v19, v17, 1, 1
    v_cmp_ne_u32 vcc, 0, v19
    v_add_u32 v21, 1, v18
    s_nop 0
    v_mbcnt_lo_u32_b32 v20, vcc_lo, 0
    v_mbcnt_hi_u32_b32 v20, vcc_hi, v20
    v_add_u32 v20, s44, v20
    v_lshlrev_b32 v20, 2, v20
    s_mov_b64 exec, vcc
    s_cbranch_execz LB_SKIP_1
    buffer_store_dword v21, v20, s[76:79], 0 offen
LB_SKIP_1:
    s_mov_b64 exec, -1
    s_bcnt1_i32_b64 s45, vcc
    s_add_u32 s44, s44, s45
    v_bfe_u32 v19, v17, 2, 1
    v_cmp_ne_u32 vcc, 0, v19
    v_add_u32 v21, 2, v18
    s_nop 0
    v_mbcnt_lo_u32_b32 v20, vcc_lo, 0
    v_mbcnt_hi_u32_b32 v20, vcc_hi, v20
    v_add_u32 v20, s44, v20
    v_lshlrev_b32 v20, 2, v20
    s_mov_b64 exec, vcc
    s_cbranch_execz LB_SKIP_2
    buffer_store_dword v21, v20, s[76:79], 0 offen
LB_SKIP_2:
    s_mov_b64 exec, -1
    s_bcnt1_i32_b64 s45, vcc
    s_add_u32 s44, s44, s45
    v_bfe_u32 v19, v17, 3, 1
    v_cmp_ne_u32 vcc, 0, v19
    v_add_u32 v21, 3, v18
    s_nop 0
    v_mbcnt_lo_u32_b32 v20, vcc_lo, 0
    v_mbcnt_hi_u32_b32 v20, vcc_hi, v20
    v_add_u32 v20, s44, v20
    v_lshlrev_b32 v20, 2, v20
    s_mov_b64 exec, vcc
    s_cbranch_execz LB_SKIP_3
    buffer_store_dword v21, v20, s[76:79], 0 offen
LB_SKIP_3:
    s_mov_b64 exec, -1
    s_bcnt1_i32_b64 s45, vcc
    s_add_u32 s44, s44, s45
    v_bfe_u32 v19, v17, 4, 1
    v_cmp_ne_u32 vcc, 0, v19
    v_add_u32 v21, 4, v18
    s_nop 0
    v_mbcnt_lo_u32_b32 v20, vcc_lo, 0
    v_mbcnt_hi_u32_b32 v20, vcc_hi, v20
    v_add_u32 v20, s44, v20
    v_lshlrev_b32 v20, 2, v20
    s_mov_b64 exec, vcc
    s_cbranch_execz LB_SKIP_4
    buffer_store_dword v21, v20, s[76:79], 0 offen
LB_SKIP_4:
    s_mov_b64 exec, -1
    s_bcnt1_i32_b64 s45, vcc
    s_add_u32 s44, s44, s45
    v_bfe_u32 v19, v17, 5, 1
    v_cmp_ne_u32 vcc, 0, v19
    v_add_u32 v21, 5, v18
    s_nop 0
    v_mbcnt_lo_u32_b32 v20, vcc_lo, 0
    v_mbcnt_hi_u32_b32 v20, vcc_hi, v20
    v_add_u32 v20, s44, v20
    v_lshlrev_b32 v20, 2, v20
    s_mov_b64 exec, vcc
    s_cbranch_execz LB_SKIP_5
    buffer_store_dword v21, v20, s[76:79], 0 offen
LB_SKIP_5:
    s_mov_b64 exec, -1
    s_bcnt1_i32_b64 s45, vcc
    s_add_u32 s44, s44, s45
    v_bfe_u32 v19, v17, 6, 1
    v_cmp_ne_u32 vcc, 0, v19
    v_add_u32 v21, 6, v18
    s_nop 0
    v_mbcnt_lo_u32_b32 v20, vcc_lo, 0
    v_mbcnt_hi_u32_b32 v20, vcc_hi, v20
    v_add_u32 v20, s44, v20
    v_lshlrev_b32 v20, 2, v20
    s_mov_b64 exec, vcc
    s_cbranch_execz LB_SKIP_6
    buffer_store_dword v21, v20, s[76:79], 0 offen
LB_SKIP_6:
    s_mov_b64 exec, -1
    s_bcnt1_i32_b64 s45, vcc
    s_add_u32 s44, s44, s45
    v_bfe_u32 v19, v17, 7, 1
    v_cmp_ne_u32 vcc, 0, v19
    v_add_u32 v21, 7, v18
    s_nop 0
    v_mbcnt_lo_u32_b32 v20, vcc_lo, 0
    v_mbcnt_hi_u32_b32 v20, vcc_hi, v20
    v_add_u32 v20, s44, v20
    v_lshlrev_b32 v20, 2, v20
    s_mov_b64 exec, vcc
    s_cbranch_execz LB_SKIP_7
    buffer_store_dword v21, v20, s[76:79], 0 offen
LB_SKIP_7:
    s_mov_b64 exec, -1
    s_bcnt1_i32_b64 s45, vcc
    s_add_u32 s44, s44, s45
    v_bfe_u32 v19, v17, 8, 1
    v_cmp_ne_u32 vcc, 0, v19
    v_add_u32 v21, 8, v18
    s_nop 0
    v_mbcnt_lo_u32_b32 v20, vcc_lo, 0
    v_mbcnt_hi_u32_b32 v20, vcc_hi, v20
    v_add_u32 v20, s44, v20
    v_lshlrev_b32 v20, 2, v20
    s_mov_b64 exec, vcc
    s_cbranch_execz LB_SKIP_8
    buffer_store_dword v21, v20, s[76:79], 0 offen
LB_SKIP_8:
    s_mov_b64 exec, -1
    s_bcnt1_i32_b64 s45, vcc
    s_add_u32 s44, s44, s45
    v_bfe_u32 v19, v17, 9, 1
    v_cmp_ne_u32 vcc, 0, v19
    v_add_u32 v21, 9, v18
    s_nop 0
    v_mbcnt_lo_u32_b32 v20, vcc_lo, 0
    v_mbcnt_hi_u32_b32 v20, vcc_hi, v20
    v_add_u32 v20, s44, v20
    v_lshlrev_b32 v20, 2, v20
    s_mov_b64 exec, vcc
    s_cbranch_execz LB_SKIP_9
    buffer_store_dword v21, v20, s[76:79], 0 offen
LB_SKIP_9:
    s_mov_b64 exec, -1
    s_bcnt1_i32_b64 s45, vcc
    s_add_u32 s44, s44, s45
    v_bfe_u32 v19, v17, 10, 1
    v_cmp_ne_u32 vcc, 0, v19
    v_add_u32 v21, 10, v18
    s_nop 0
    v_mbcnt_lo_u32_b32 v20, vcc_lo, 0
    v_mbcnt_hi_u32_b32 v20, vcc_hi, v20
    v_add_u32 v20, s44, v20
    v_lshlrev_b32 v20, 2, v20
    s_mov_b64 exec, vcc
    s_cbranch_execz LB_SKIP_10
    buffer_store_dword v21, v20, s[76:79], 0 offen
LB_SKIP_10:
    s_mov_b64 exec, -1
    s_bcnt1_i32_b64 s45, vcc
    s_add_u32 s44, s44, s45
    v_bfe_u32 v19, v17, 11, 1
    v_cmp_ne_u32 vcc, 0, v19
    v_add_u32 v21, 11, v18
    s_nop 0
    v_mbcnt_lo_u32_b32 v20, vcc_lo, 0
    v_mbcnt_hi_u32_b32 v20, vcc_hi, v20
    v_add_u32 v20, s44, v20
    v_lshlrev_b32 v20, 2, v20
    s_mov_b64 exec, vcc
    s_cbranch_execz LB_SKIP_11
    buffer_store_dword v21, v20, s[76:79], 0 offen
LB_SKIP_11:
    s_mov_b64 exec, -1
    s_bcnt1_i32_b64 s45, vcc
    s_add_u32 s44, s44, s45
    v_bfe_u32 v19, v17, 12, 1
    v_cmp_ne_u32 vcc, 0, v19
    v_add_u32 v21, 12, v18
    s_nop 0
    v_mbcnt_lo_u32_b32 v20, vcc_lo, 0
    v_mbcnt_hi_u32_b32 v20, vcc_hi, v20
    v_add_u32 v20, s44, v20
    v_lshlrev_b32 v20, 2, v20
    s_mov_b64 exec, vcc
    s_cbranch_execz LB_SKIP_12
    buffer_store_dword v21, v20, s[76:79], 0 offen
LB_SKIP_12:
    s_mov_b64 exec, -1
    s_bcnt1_i32_b64 s45, vcc
    s_add_u32 s44, s44, s45
    v_bfe_u32 v19, v17, 13, 1
    v_cmp_ne_u32 vcc, 0, v19
    v_add_u32 v21, 13, v18
    s_nop 0
    v_mbcnt_lo_u32_b32 v20, vcc_lo, 0
    v_mbcnt_hi_u32_b32 v20, vcc_hi, v20
    v_add_u32 v20, s44, v20
    v_lshlrev_b32 v20, 2, v20
    s_mov_b64 exec, vcc
    s_cbranch_execz LB_SKIP_13
    buffer_store_dword v21, v20, s[76:79], 0 offen
LB_SKIP_13:
    s_mov_b64 exec, -1
    s_bcnt1_i32_b64 s45, vcc
    s_add_u32 s44, s44, s45
    v_bfe_u32 v19, v17, 14, 1
    v_cmp_ne_u32 vcc, 0, v19
    v_add_u32 v21, 14, v18
    s_nop 0
    v_mbcnt_lo_u32_b32 v20, vcc_lo, 0
    v_mbcnt_hi_u32_b32 v20, vcc_hi, v20
    v_add_u32 v20, s44, v20
    v_lshlrev_b32 v20, 2, v20
    s_mov_b64 exec, vcc
    s_cbranch_execz LB_SKIP_14
    buffer_store_dword v21, v20, s[76:79], 0 offen
LB_SKIP_14:
    s_mov_b64 exec, -1
    s_bcnt1_i32_b64 s45, vcc
    s_add_u32 s44, s44, s45
    v_bfe_u32 v19, v17, 15, 1
    v_cmp_ne_u32 vcc, 0, v19
    v_add_u32 v21, 15, v18
    s_nop 0
    v_mbcnt_lo_u32_b32 v20, vcc_lo, 0
    v_mbcnt_hi_u32_b32 v20, vcc_hi, v20
    v_add_u32 v20, s44, v20
    v_lshlrev_b32 v20, 2, v20
    s_mov_b64 exec, vcc
    s_cbranch_execz LB_SKIP_15
    buffer_store_dword v21, v20, s[76:79], 0 offen
LB_SKIP_15:
    s_mov_b64 exec, -1
    s_bcnt1_i32_b64 s45, vcc
    s_add_u32 s44, s44, s45
    v_bfe_u32 v19, v17, 16, 1
    v_cmp_ne_u32 vcc, 0, v19
    v_add_u32 v21, 16, v18
    s_nop 0
    v_mbcnt_lo_u32_b32 v20, vcc_lo, 0
    v_mbcnt_hi_u32_b32 v20, vcc_hi, v20
    v_add_u32 v20, s44, v20
    v_lshlrev_b32 v20, 2, v20
    s_mov_b64 exec, vcc
    s_cbranch_execz LB_SKIP_16
    buffer_store_dword v21, v20, s[76:79], 0 offen
LB_SKIP_16:
    s_mov_b64 exec, -1
    s_bcnt1_i32_b64 s45, vcc
    s_add_u32 s44, s44, s45
    v_bfe_u32 v19, v17, 17, 1
    v_cmp_ne_u32 vcc, 0, v19
    v_add_u32 v21, 17, v18
    s_nop 0
    v_mbcnt_lo_u32_b32 v20, vcc_lo, 0
    v_mbcnt_hi_u32_b32 v20, vcc_hi, v20
    v_add_u32 v20, s44, v20
    v_lshlrev_b32 v20, 2, v20
    s_mov_b64 exec, vcc
    s_cbranch_execz LB_SKIP_17
    buffer_store_dword v21, v20, s[76:79], 0 offen
LB_SKIP_17:
    s_mov_b64 exec, -1
    s_bcnt1_i32_b64 s45, vcc
    s_add_u32 s44, s44, s45
    v_bfe_u32 v19, v17, 18, 1
    v_cmp_ne_u32 vcc, 0, v19
    v_add_u32 v21, 18, v18
    s_nop 0
    v_mbcnt_lo_u32_b32 v20, vcc_lo, 0
    v_mbcnt_hi_u32_b32 v20, vcc_hi, v20
    v_add_u32 v20, s44, v20
    v_lshlrev_b32 v20, 2, v20
    s_mov_b64 exec, vcc
    s_cbranch_execz LB_SKIP_18
    buffer_store_dword v21, v20, s[76:79], 0 offen
LB_SKIP_18:
    s_mov_b64 exec, -1
    s_bcnt1_i32_b64 s45, vcc
    s_add_u32 s44, s44, s45
    v_bfe_u32 v19, v17, 19, 1
    v_cmp_ne_u32 vcc, 0, v19
    v_add_u32 v21, 19, v18
    s_nop 0
    v_mbcnt_lo_u32_b32 v20, vcc_lo, 0
    v_mbcnt_hi_u32_b32 v20, vcc_hi, v20
    v_add_u32 v20, s44, v20
    v_lshlrev_b32 v20, 2, v20
    s_mov_b64 exec, vcc
    s_cbranch_execz LB_SKIP_19
    buffer_store_dword v21, v20, s[76:79], 0 offen
LB_SKIP_19:
    s_mov_b64 exec, -1
    s_bcnt1_i32_b64 s45, vcc
    s_add_u32 s44, s44, s45
    v_bfe_u32 v19, v17, 20, 1
    v_cmp_ne_u32 vcc, 0, v19
    v_add_u32 v21, 20, v18
    s_nop 0
    v_mbcnt_lo_u32_b32 v20, vcc_lo, 0
    v_mbcnt_hi_u32_b32 v20, vcc_hi, v20
    v_add_u32 v20, s44, v20
    v_lshlrev_b32 v20, 2, v20
    s_mov_b64 exec, vcc
    s_cbranch_execz LB_SKIP_20
    buffer_store_dword v21, v20, s[76:79], 0 offen
LB_SKIP_20:
    s_mov_b64 exec, -1
    s_bcnt1_i32_b64 s45, vcc
    s_add_u32 s44, s44, s45
    v_bfe_u32 v19, v17, 21, 1
    v_cmp_ne_u32 vcc, 0, v19
    v_add_u32 v21, 21, v18
    s_nop 0
    v_mbcnt_lo_u32_b32 v20, vcc_lo, 0
    v_mbcnt_hi_u32_b32 v20, vcc_hi, v20
    v_add_u32 v20, s44, v20
    v_lshlrev_b32 v20, 2, v20
    s_mov_b64 exec, vcc
    s_cbranch_execz LB_SKIP_21
    buffer_store_dword v21, v20, s[76:79], 0 offen
LB_SKIP_21:
    s_mov_b64 exec, -1
    s_bcnt1_i32_b64 s45, vcc
    s_add_u32 s44, s44, s45
    v_bfe_u32 v19, v17, 22, 1
    v_cmp_ne_u32 vcc, 0, v19
    v_add_u32 v21, 22, v18
    s_nop 0
    v_mbcnt_lo_u32_b32 v20, vcc_lo, 0
    v_mbcnt_hi_u32_b32 v20, vcc_hi, v20
    v_add_u32 v20, s44, v20
    v_lshlrev_b32 v20, 2, v20
    s_mov_b64 exec, vcc
    s_cbranch_execz LB_SKIP_22
    buffer_store_dword v21, v20, s[76:79], 0 offen
LB_SKIP_22:
    s_mov_b64 exec, -1
    s_bcnt1_i32_b64 s45, vcc
    s_add_u32 s44, s44, s45
    v_bfe_u32 v19, v17, 23, 1
    v_cmp_ne_u32 vcc, 0, v19
    v_add_u32 v21, 23, v18
    s_nop 0
    v_mbcnt_lo_u32_b32 v20, vcc_lo, 0
    v_mbcnt_hi_u32_b32 v20, vcc_hi, v20
    v_add_u32 v20, s44, v20
    v_lshlrev_b32 v20, 2, v20
    s_mov_b64 exec, vcc
    s_cbranch_execz LB_SKIP_23
    buffer_store_dword v21, v20, s[76:79], 0 offen
LB_SKIP_23:
    s_mov_b64 exec, -1
    s_bcnt1_i32_b64 s45, vcc
    s_add_u32 s44, s44, s45
    v_bfe_u32 v19, v17, 24, 1
    v_cmp_ne_u32 vcc, 0, v19
    v_add_u32 v21, 24, v18
    s_nop 0
    v_mbcnt_lo_u32_b32 v20, vcc_lo, 0
    v_mbcnt_hi_u32_b32 v20, vcc_hi, v20
    v_add_u32 v20, s44, v20
    v_lshlrev_b32 v20, 2, v20
    s_mov_b64 exec, vcc
    s_cbranch_execz LB_SKIP_24
    buffer_store_dword v21, v20, s[76:79], 0 offen
LB_SKIP_24:
    s_mov_b64 exec, -1
    s_bcnt1_i32_b64 s45, vcc
    s_add_u32 s44, s44, s45
    v_bfe_u32 v19, v17, 25, 1
    v_cmp_ne_u32 vcc, 0, v19
    v_add_u32 v21, 25, v18
    s_nop 0
    v_mbcnt_lo_u32_b32 v20, vcc_lo, 0
    v_mbcnt_hi_u32_b32 v20, vcc_hi, v20
    v_add_u32 v20, s44, v20
    v_lshlrev_b32 v20, 2, v20
    s_mov_b64 exec, vcc
    s_cbranch_execz LB_SKIP_25
    buffer_store_dword v21, v20, s[76:79], 0 offen
LB_SKIP_25:
    s_mov_b64 exec, -1
    s_bcnt1_i32_b64 s45, vcc
    s_add_u32 s44, s44, s45
    v_bfe_u32 v19, v17, 26, 1
    v_cmp_ne_u32 vcc, 0, v19
    v_add_u32 v21, 26, v18
    s_nop 0
    v_mbcnt_lo_u32_b32 v20, vcc_lo, 0
    v_mbcnt_hi_u32_b32 v20, vcc_hi, v20
    v_add_u32 v20, s44, v20
    v_lshlrev_b32 v20, 2, v20
    s_mov_b64 exec, vcc
    s_cbranch_execz LB_SKIP_26
    buffer_store_dword v21, v20, s[76:79], 0 offen
LB_SKIP_26:
    s_mov_b64 exec, -1
    s_bcnt1_i32_b64 s45, vcc
    s_add_u32 s44, s44, s45
    v_bfe_u32 v19, v17, 27, 1
    v_cmp_ne_u32 vcc, 0, v19
    v_add_u32 v21, 27, v18
    s_nop 0
    v_mbcnt_lo_u32_b32 v20, vcc_lo, 0
    v_mbcnt_hi_u32_b32 v20, vcc_hi, v20
    v_add_u32 v20, s44, v20
    v_lshlrev_b32 v20, 2, v20
    s_mov_b64 exec, vcc
    s_cbranch_execz LB_SKIP_27
    buffer_store_dword v21, v20, s[76:79], 0 offen
LB_SKIP_27:
    s_mov_b64 exec, -1
    s_bcnt1_i32_b64 s45, vcc
    s_add_u32 s44, s44, s45
    v_bfe_u32 v19, v17, 28, 1
    v_cmp_ne_u32 vcc, 0, v19
    v_add_u32 v21, 28, v18
    s_nop 0
    v_mbcnt_lo_u32_b32 v20, vcc_lo, 0
    v_mbcnt_hi_u32_b32 v20, vcc_hi, v20
    v_add_u32 v20, s44, v20
    v_lshlrev_b32 v20, 2, v20
    s_mov_b64 exec, vcc
    s_cbranch_execz LB_SKIP_28
    buffer_store_dword v21, v20, s[76:79], 0 offen
LB_SKIP_28:
    s_mov_b64 exec, -1
    s_bcnt1_i32_b64 s45, vcc
    s_add_u32 s44, s44, s45
    v_bfe_u32 v19, v17, 29, 1
    v_cmp_ne_u32 vcc, 0, v19
    v_add_u32 v21, 29, v18
    s_nop 0
    v_mbcnt_lo_u32_b32 v20, vcc_lo, 0
    v_mbcnt_hi_u32_b32 v20, vcc_hi, v20
    v_add_u32 v20, s44, v20
    v_lshlrev_b32 v20, 2, v20
    s_mov_b64 exec, vcc
    s_cbranch_execz LB_SKIP_29
    buffer_store_dword v21, v20, s[76:79], 0 offen
LB_SKIP_29:
    s_mov_b64 exec, -1
    s_bcnt1_i32_b64 s45, vcc
    s_add_u32 s44, s44, s45
    v_bfe_u32 v19, v17, 30, 1
    v_cmp_ne_u32 vcc, 0, v19
    v_add_u32 v21, 30, v18
    s_nop 0
    v_mbcnt_lo_u32_b32 v20, vcc_lo, 0
    v_mbcnt_hi_u32_b32 v20, vcc_hi, v20
    v_add_u32 v20, s44, v20
    v_lshlrev_b32 v20, 2, v20
    s_mov_b64 exec, vcc
    s_cbranch_execz LB_SKIP_30
    buffer_store_dword v21, v20, s[76:79], 0 offen
LB_SKIP_30:
    s_mov_b64 exec, -1
    s_bcnt1_i32_b64 s45, vcc
    s_add_u32 s44, s44, s45
    v_bfe_u32 v19, v17, 31, 1
    v_cmp_ne_u32 vcc, 0, v19
    v_add_u32 v21, 31, v18
    s_nop 0
    v_mbcnt_lo_u32_b32 v20, vcc_lo, 0
    v_mbcnt_hi_u32_b32 v20, vcc_hi, v20
    v_add_u32 v20, s44, v20
    v_lshlrev_b32 v20, 2, v20
    s_mov_b64 exec, vcc
    s_cbranch_execz LB_SKIP_31
    buffer_store_dword v21, v20, s[76:79], 0 offen
LB_SKIP_31:
    s_mov_b64 exec, -1
    s_bcnt1_i32_b64 s45, vcc
    s_add_u32 s44, s44, s45
    v_add_u32 v20, s44, v0
    v_lshlrev_b32 v20, 2, v20
    v_mov_b32 v21, 0x800
    buffer_store_dword v21, v20, s[76:79], 0 offen offset:0
    buffer_store_dword v21, v20, s[76:79], 0 offen offset:256
    buffer_store_dword v21, v20, s[76:79], 0 offen offset:512
    buffer_store_dword v21, v20, s[76:79], 0 offen offset:768
    buffer_store_dword v21, v20, s[76:79], 0 offen offset:1024
    s_nop 1
    v_mov_b32 v20, 0x26000
    v_mov_b32 v22, s44
    ds_write_b32 v20, v22
LIST_DONE:
    s_waitcnt vmcnt(0) lgkmcnt(0)
    s_waitcnt vmcnt(0) lgkmcnt(0)
    s_barrier
    v_mov_b32 v20, 0x26000
    ds_read_b32 v21, v20
    s_waitcnt lgkmcnt(0)
    v_readfirstlane_b32 s39, v21
    s_add_u32 s39, s39, 63
    s_lshr_b32 s39, s39, 6
    s_min_u32 s39, s39, 32
    ds_read_b128 a[192:195], v212 offset:0
    ds_read_b128 a[196:199], v213 offset:0
    ds_read_b128 a[200:203], v214 offset:0
    ds_read_b128 a[204:207], v215 offset:0
    s_waitcnt lgkmcnt(3)
    v_mfma_f32_32x32x16_bf16 v[0:15], a[192:195], a[128:131], 0
    v_mfma_f32_32x32x16_bf16 v[16:31], a[192:195], a[160:163], 0
    ds_read_b128 a[192:195], v216 offset:0
    s_waitcnt lgkmcnt(3)
    v_mfma_f32_32x32x16_bf16 v[0:15], a[196:199], a[132:135], v[0:15]
    v_mfma_f32_32x32x16_bf16 v[16:31], a[196:199], a[164:167], v[16:31]
    ds_read_b128 a[196:199], v217 offset:0
    s_waitcnt lgkmcnt(3)
    v_mfma_f32_32x32x16_bf16 v[0:15], a[200:203], a[136:139], v[0:15]
    v_mfma_f32_32x32x16_bf16 v[16:31], a[200:203], a[168:171], v[16:31]
    ds_read_b128 a[200:203], v218 offset:0
    s_waitcnt lgkmcnt(3)
    v_mfma_f32_32x32x16_bf16 v[0:15], a[204:207], a[140:143], v[0:15]
    v_mfma_f32_32x32x16_bf16 v[16:31], a[204:207], a[172:175], v[16:31]
    ds_read_b128 a[204:207], v219 offset:0
    s_waitcnt lgkmcnt(3)
    v_mfma_f32_32x32x16_bf16 v[0:15], a[192:195], a[144:147], v[0:15]
    v_mfma_f32_32x32x16_bf16 v[16:31], a[192:195], a[176:179], v[16:31]
    ds_read_b128 a[192:195], v212 offset:8192
    s_waitcnt lgkmcnt(3)
    v_mfma_f32_32x32x16_bf16 v[0:15], a[196:199], a[148:151], v[0:15]
    v_mfma_f32_32x32x16_bf16 v[16:31], a[196:199], a[180:183], v[16:31]
    ds_read_b128 a[196:199], v213 offset:8192
    s_waitcnt lgkmcnt(3)
    v_mfma_f32_32x32x16_bf16 v[0:15], a[200:203], a[152:155], v[0:15]
    v_mfma_f32_32x32x16_bf16 v[16:31], a[200:203], a[184:187], v[16:31]
    ds_read_b128 a[200:203], v214 offset:8192
    s_waitcnt lgkmcnt(3)
    v_mfma_f32_32x32x16_bf16 v[0:15], a[204:207], a[156:159], v[0:15]
    v_mfma_f32_32x32x16_bf16 v[16:31], a[204:207], a[188:191], v[16:31]
    ds_read_b128 a[204:207], v215 offset:8192
    s_waitcnt lgkmcnt(3)
    v_mfma_f32_32x32x16_bf16 v[32:47], a[192:195], a[128:131], 0
    v_mfma_f32_32x32x16_bf16 v[48:63], a[192:195], a[160:163], 0
    ds_read_b128 a[192:195], v216 offset:8192
    s_waitcnt lgkmcnt(3)
    v_mfma_f32_32x32x16_bf16 v[32:47], a[196:199], a[132:135], v[32:47]
    v_mfma_f32_32x32x16_bf16 v[48:63], a[196:199], a[164:167], v[48:63]
    ds_read_b128 a[196:199], v217 offset:8192
    s_waitcnt lgkmcnt(3)
    v_mfma_f32_32x32x16_bf16 v[32:47], a[200:203], a[136:139], v[32:47]
    v_mfma_f32_32x32x16_bf16 v[48:63], a[200:203], a[168:171], v[48:63]
    ds_read_b128 a[200:203], v218 offset:8192
    s_waitcnt lgkmcnt(3)
    v_mfma_f32_32x32x16_bf16 v[32:47], a[204:207], a[140:143], v[32:47]
    v_mfma_f32_32x32x16_bf16 v[48:63], a[204:207], a[172:175], v[48:63]
    ds_read_b128 a[204:207], v219 offset:8192
    s_waitcnt lgkmcnt(3)
    v_mfma_f32_32x32x16_bf16 v[32:47], a[192:195], a[144:147], v[32:47]
    v_mfma_f32_32x32x16_bf16 v[48:63], a[192:195], a[176:179], v[48:63]
    s_waitcnt lgkmcnt(2)
    v_mfma_f32_32x32x16_bf16 v[32:47], a[196:199], a[148:151], v[32:47]
    v_mfma_f32_32x32x16_bf16 v[48:63], a[196:199], a[180:183], v[48:63]
    s_waitcnt lgkmcnt(1)
    v_mfma_f32_32x32x16_bf16 v[32:47], a[200:203], a[152:155], v[32:47]
    v_mfma_f32_32x32x16_bf16 v[48:63], a[200:203], a[184:187], v[48:63]
    s_waitcnt lgkmcnt(0)
    v_mfma_f32_32x32x16_bf16 v[32:47], a[204:207], a[156:159], v[32:47]
    v_mfma_f32_32x32x16_bf16 v[48:63], a[204:207], a[188:191], v[48:63]
    v_add_u32 v212, 0x8000, v212
    v_add_u32 v213, 0x8000, v213
    v_add_u32 v214, 0x8000, v214
    v_add_u32 v215, 0x8000, v215
    v_add_u32 v216, 0x8000, v216
    v_add_u32 v217, 0x8000, v217
    v_add_u32 v218, 0x8000, v218
    v_add_u32 v219, 0x8000, v219
    s_mov_b32 s40, 0x8000
    s_mov_b32 s41, 0x8000
    s_mov_b32 s43, 0x18000
    s_add_u32 s48, s43, s53
    s_add_u32 s49, s54, 0x26000
    ds_read_b128 a[192:195], v212 offset:0
    ds_read_b128 a[196:199], v213 offset:0
    ds_read_b128 a[200:203], v214 offset:0
    v_max3_f32 v252, v0, v1, v2
    v_max3_f32 v252, v252, v3, v4
    v_max3_f32 v252, v252, v5, v6
    v_max3_f32 v252, v252, v7, v8
    v_max3_f32 v252, v252, v9, v10
    v_max3_f32 v252, v252, v11, v12
    v_max3_f32 v252, v252, v13, v14
    v_max3_f32 v252, v252, v15, v32
    v_max3_f32 v252, v252, v33, v34
    v_max3_f32 v252, v252, v35, v36
    v_max3_f32 v252, v252, v37, v38
    v_max3_f32 v252, v252, v39, v40
    v_max3_f32 v252, v252, v41, v42
    v_max3_f32 v252, v252, v43, v44
    v_max3_f32 v252, v252, v45, v46
    v_max_f32 v252, v252, v47
    v_mov_b32 v253, v252
    s_nop 1
    v_permlane32_swap_b32 v252, v253
    v_max_f32 v252, v252, v253
    v_mul_f32 v252, s36, v252
    v_sub_f32 v192, 0, v252
    v_max3_f32 v252, v16, v17, v18
    v_max3_f32 v252, v252, v19, v20
    v_max3_f32 v252, v252, v21, v22
    v_max3_f32 v252, v252, v23, v24
    v_max3_f32 v252, v252, v25, v26
    v_max3_f32 v252, v252, v27, v28
    v_max3_f32 v252, v252, v29, v30
    v_max3_f32 v252, v252, v31, v48
    v_max3_f32 v252, v252, v49, v50
    v_max3_f32 v252, v252, v51, v52
    v_max3_f32 v252, v252, v53, v54
    v_max3_f32 v252, v252, v55, v56
    v_max3_f32 v252, v252, v57, v58
    v_max3_f32 v252, v252, v59, v60
    v_max3_f32 v252, v252, v61, v62
    v_max_f32 v252, v252, v63
    v_mov_b32 v253, v252
    s_nop 1
    v_permlane32_swap_b32 v252, v253
    v_max_f32 v252, v252, v253
    v_mul_f32 v252, s36, v252
    v_sub_f32 v193, 0, v252
    v_fma_f32 v198, v0, s36, v192
    v_fma_f32 v199, v1, s36, v192
    v_exp_f32 v201, v198
    v_fma_f32 v200, v2, s36, v192
    v_exp_f32 v202, v199
    v_add_f32 v196, v196, v201
    v_fma_f32 v198, v3, s36, v192
    v_exp_f32 v203, v200
    v_add_f32 v196, v196, v202
    v_cvt_pk_bf16_f32 v128, v201, v202
    v_fma_f32 v199, v4, s36, v192
    v_exp_f32 v204, v198
    v_add_f32 v196, v196, v203
    v_fma_f32 v200, v5, s36, v192
    v_exp_f32 v201, v199
    v_add_f32 v196, v196, v204
    v_cvt_pk_bf16_f32 v129, v203, v204
    v_fma_f32 v198, v6, s36, v192
    v_exp_f32 v202, v200
    v_add_f32 v196, v196, v201
    v_fma_f32 v199, v7, s36, v192
    v_exp_f32 v203, v198
    v_add_f32 v196, v196, v202
    v_cvt_pk_bf16_f32 v130, v201, v202
    v_fma_f32 v200, v8, s36, v192
    v_exp_f32 v204, v199
    v_add_f32 v196, v196, v203
    v_fma_f32 v198, v9, s36, v192
    v_exp_f32 v201, v200
    v_add_f32 v196, v196, v204
    v_cvt_pk_bf16_f32 v131, v203, v204
    v_fma_f32 v199, v10, s36, v192
    v_exp_f32 v202, v198
    v_add_f32 v196, v196, v201
    v_fma_f32 v200, v11, s36, v192
    v_exp_f32 v203, v199
    v_add_f32 v196, v196, v202
    v_cvt_pk_bf16_f32 v132, v201, v202
    v_fma_f32 v198, v12, s36, v192
    v_exp_f32 v204, v200
    v_add_f32 v196, v196, v203
    v_fma_f32 v199, v13, s36, v192
    v_exp_f32 v201, v198
    v_add_f32 v196, v196, v204
    v_cvt_pk_bf16_f32 v133, v203, v204
    v_fma_f32 v200, v14, s36, v192
    v_exp_f32 v202, v199
    v_add_f32 v196, v196, v201
    v_fma_f32 v198, v15, s36, v192
    v_exp_f32 v203, v200
    v_add_f32 v196, v196, v202
    v_cvt_pk_bf16_f32 v134, v201, v202
    v_fma_f32 v199, v16, s36, v193
    v_exp_f32 v204, v198
    v_add_f32 v196, v196, v203
    v_fma_f32 v200, v17, s36, v193
    v_exp_f32 v201, v199
    v_add_f32 v196, v196, v204
    v_cvt_pk_bf16_f32 v135, v203, v204
    v_fma_f32 v198, v18, s36, v193
    v_exp_f32 v202, v200
    v_add_f32 v197, v197, v201
    v_fma_f32 v199, v19, s36, v193
    v_exp_f32 v203, v198
    v_add_f32 v197, v197, v202
    v_cvt_pk_bf16_f32 v144, v201, v202
    v_fma_f32 v200, v20, s36, v193
    v_exp_f32 v204, v199
    v_add_f32 v197, v197, v203
    v_fma_f32 v198, v21, s36, v193
    v_exp_f32 v201, v200
    v_add_f32 v197, v197, v204
    v_cvt_pk_bf16_f32 v145, v203, v204
    v_fma_f32 v199, v22, s36, v193
    v_exp_f32 v202, v198
    v_add_f32 v197, v197, v201
    v_fma_f32 v200, v23, s36, v193
    v_exp_f32 v203, v199
    v_add_f32 v197, v197, v202
    v_cvt_pk_bf16_f32 v146, v201, v202
    v_fma_f32 v198, v24, s36, v193
    v_exp_f32 v204, v200
    v_add_f32 v197, v197, v203
    v_fma_f32 v199, v25, s36, v193
    v_exp_f32 v201, v198
    v_add_f32 v197, v197, v204
    v_cvt_pk_bf16_f32 v147, v203, v204
    v_fma_f32 v200, v26, s36, v193
    v_exp_f32 v202, v199
    v_add_f32 v197, v197, v201
    v_fma_f32 v198, v27, s36, v193
    v_exp_f32 v203, v200
    v_add_f32 v197, v197, v202
    v_cvt_pk_bf16_f32 v148, v201, v202
    v_fma_f32 v199, v28, s36, v193
    v_exp_f32 v204, v198
    v_add_f32 v197, v197, v203
    v_fma_f32 v200, v29, s36, v193
    v_exp_f32 v201, v199
    v_add_f32 v197, v197, v204
    v_cvt_pk_bf16_f32 v149, v203, v204
    v_fma_f32 v198, v30, s36, v193
    v_exp_f32 v202, v200
    v_add_f32 v197, v197, v201
    v_fma_f32 v199, v31, s36, v193
    v_exp_f32 v203, v198
    v_add_f32 v197, v197, v202
    v_cvt_pk_bf16_f32 v150, v201, v202
    v_exp_f32 v204, v199
    v_add_f32 v197, v197, v203
    v_add_f32 v197, v197, v204
    v_cvt_pk_bf16_f32 v151, v203, v204
    s_mov_b32 s38, 14
LOOP_A:
    ds_read_b128 a[204:207], v215 offset:0
    v_fma_f32 v198, v32, s36, v192
    v_fma_f32 v199, v33, s36, v192
    v_exp_f32 v201, v198
    s_waitcnt lgkmcnt(3)
    v_mfma_f32_32x32x16_bf16 v[64:79], a[192:195], a[128:131], 0
    s_add_u32 m0, s48, 0
    s_nop 0
    buffer_load_dwordx4 v228, s[8:11], s37 offen offset:0 lds
    v_fma_f32 v200, v34, s36, v192
    v_exp_f32 v202, v199
    v_add_f32 v196, v196, v201
    v_mfma_f32_32x32x16_bf16 v[80:95], a[192:195], a[160:163], 0
    ds_read_b128 a[192:195], v216 offset:0
    v_fma_f32 v198, v35, s36, v192
    v_exp_f32 v203, v200
    v_add_f32 v196, v196, v202
    s_waitcnt lgkmcnt(3)
    v_mfma_f32_32x32x16_bf16 v[64:79], a[196:199], a[132:135], v[64:79]
    v_cvt_pk_bf16_f32 v136, v201, v202
    v_fma_f32 v199, v36, s36, v192
    v_exp_f32 v204, v198
    v_add_f32 v196, v196, v203
    v_fma_f32 v200, v37, s36, v192
    v_mfma_f32_32x32x16_bf16 v[80:95], a[196:199], a[164:167], v[80:95]
    ds_read_b128 a[196:199], v217 offset:0
    v_exp_f32 v201, v199
    v_add_f32 v196, v196, v204
    v_cvt_pk_bf16_f32 v137, v203, v204
    s_waitcnt lgkmcnt(3)
    v_mfma_f32_32x32x16_bf16 v[64:79], a[200:203], a[136:139], v[64:79]
    v_fma_f32 v198, v38, s36, v192
    v_exp_f32 v202, v200
    v_add_f32 v196, v196, v201
    v_fma_f32 v199, v39, s36, v192
    v_mfma_f32_32x32x16_bf16 v[80:95], a[200:203], a[168:171], v[80:95]
    ds_read_b128 a[200:203], v218 offset:0
    v_exp_f32 v203, v198
    v_add_f32 v196, v196, v202
    v_cvt_pk_bf16_f32 v138, v201, v202
    s_waitcnt lgkmcnt(3)
    v_mfma_f32_32x32x16_bf16 v[64:79], a[204:207], a[140:143], v[64:79]
    s_add_u32 m0, s48, 0
    s_nop 0
    buffer_load_dwordx4 v229, s[8:11], s37 offen offset:1024 lds
    v_fma_f32 v200, v40, s36, v192
    v_exp_f32 v204, v199
    v_add_f32 v196, v196, v203
    v_mfma_f32_32x32x16_bf16 v[80:95], a[204:207], a[172:175], v[80:95]
    ds_read_b128 a[204:207], v219 offset:0
    v_fma_f32 v198, v41, s36, v192
    v_exp_f32 v201, v200
    v_add_f32 v196, v196, v204
    s_waitcnt lgkmcnt(3)
    v_mfma_f32_32x32x16_bf16 v[64:79], a[192:195], a[144:147], v[64:79]
    v_cvt_pk_bf16_f32 v139, v203, v204
    v_fma_f32 v199, v42, s36, v192
    v_exp_f32 v202, v198
    v_add_f32 v196, v196, v201
    v_fma_f32 v200, v43, s36, v192
    v_mfma_f32_32x32x16_bf16 v[80:95], a[192:195], a[176:179], v[80:95]
    ds_read_b128 a[192:195], v212 offset:8192
    v_exp_f32 v203, v199
    v_add_f32 v196, v196, v202
    v_cvt_pk_bf16_f32 v140, v201, v202
    s_waitcnt lgkmcnt(3)
    v_mfma_f32_32x32x16_bf16 v[64:79], a[196:199], a[148:151], v[64:79]
    s_add_u32 m0, s48, 0
    s_nop 0
    buffer_load_dwordx4 v230, s[8:11], s37 offen offset:2048 lds
    v_fma_f32 v198, v44, s36, v192
    v_exp_f32 v204, v200
    v_add_f32 v196, v196, v203
    v_mfma_f32_32x32x16_bf16 v[80:95], a[196:199], a[180:183], v[80:95]
    ds_read_b128 a[196:199], v213 offset:8192
    v_fma_f32 v199, v45, s36, v192
    v_exp_f32 v201, v198
    v_add_f32 v196, v196, v204
    s_waitcnt lgkmcnt(3)
    v_mfma_f32_32x32x16_bf16 v[64:79], a[200:203], a[152:155], v[64:79]
    v_cvt_pk_bf16_f32 v141, v203, v204
    v_fma_f32 v200, v46, s36, v192
    v_exp_f32 v202, v199
    v_add_f32 v196, v196, v201
    v_fma_f32 v198, v47, s36, v192
    v_mfma_f32_32x32x16_bf16 v[80:95], a[200:203], a[184:187], v[80:95]
    ds_read_b128 a[200:203], v214 offset:8192
    v_exp_f32 v203, v200
    v_add_f32 v196, v196, v202
    v_cvt_pk_bf16_f32 v142, v201, v202
    s_waitcnt lgkmcnt(3)
    v_mfma_f32_32x32x16_bf16 v[64:79], a[204:207], a[156:159], v[64:79]
    v_fma_f32 v199, v48, s36, v193
    v_exp_f32 v204, v198
    v_add_f32 v196, v196, v203
    v_fma_f32 v200, v49, s36, v193
    v_mfma_f32_32x32x16_bf16 v[80:95], a[204:207], a[188:191], v[80:95]
    ds_read_b128 a[204:207], v215 offset:8192
    v_exp_f32 v201, v199
    v_add_f32 v196, v196, v204
    v_cvt_pk_bf16_f32 v143, v203, v204
    s_waitcnt lgkmcnt(3)
    v_mfma_f32_32x32x16_bf16 v[96:111], a[192:195], a[128:131], 0
    s_add_u32 m0, s48, 0
    s_nop 0
    buffer_load_dwordx4 v231, s[8:11], s37 offen offset:3072 lds
    v_fma_f32 v198, v50, s36, v193
    v_exp_f32 v202, v200
    v_add_f32 v197, v197, v201
    v_mfma_f32_32x32x16_bf16 v[112:127], a[192:195], a[160:163], 0
    ds_read_b128 a[192:195], v216 offset:8192
    v_fma_f32 v199, v51, s36, v193
    v_exp_f32 v203, v198
    v_add_f32 v197, v197, v202
    s_waitcnt lgkmcnt(3)
    v_mfma_f32_32x32x16_bf16 v[96:111], a[196:199], a[132:135], v[96:111]
    v_cvt_pk_bf16_f32 v152, v201, v202
    v_fma_f32 v200, v52, s36, v193
    v_exp_f32 v204, v199
    v_add_f32 v197, v197, v203
    v_fma_f32 v198, v53, s36, v193
    v_mfma_f32_32x32x16_bf16 v[112:127], a[196:199], a[164:167], v[112:127]
    ds_read_b128 a[196:199], v217 offset:8192
    v_exp_f32 v201, v200
    v_add_f32 v197, v197, v204
    v_cvt_pk_bf16_f32 v153, v203, v204
    s_waitcnt lgkmcnt(3)
    v_mfma_f32_32x32x16_bf16 v[96:111], a[200:203], a[136:139], v[96:111]
    v_fma_f32 v199, v54, s36, v193
    v_exp_f32 v202, v198
    v_add_f32 v197, v197, v201
    v_fma_f32 v200, v55, s36, v193
    v_mfma_f32_32x32x16_bf16 v[112:127], a[200:203], a[168:171], v[112:127]
    ds_read_b128 a[200:203], v218 offset:8192
    v_exp_f32 v203, v199
    v_add_f32 v197, v197, v202
    v_cvt_pk_bf16_f32 v154, v201, v202
    s_waitcnt lgkmcnt(3)
    v_mfma_f32_32x32x16_bf16 v[96:111], a[204:207], a[140:143], v[96:111]
    v_fma_f32 v198, v56, s36, v193
    v_exp_f32 v204, v200
    v_add_f32 v197, v197, v203
    v_fma_f32 v199, v57, s36, v193
    v_mfma_f32_32x32x16_bf16 v[112:127], a[204:207], a[172:175], v[112:127]
    ds_read_b128 a[204:207], v219 offset:8192
    v_exp_f32 v201, v198
    v_add_f32 v197, v197, v204
    v_cvt_pk_bf16_f32 v155, v203, v204
    s_waitcnt lgkmcnt(3)
    v_mfma_f32_32x32x16_bf16 v[96:111], a[192:195], a[144:147], v[96:111]
    v_fma_f32 v200, v58, s36, v193
    v_exp_f32 v202, v199
    v_add_f32 v197, v197, v201
    v_fma_f32 v198, v59, s36, v193
    v_mfma_f32_32x32x16_bf16 v[112:127], a[192:195], a[176:179], v[112:127]
    v_exp_f32 v203, v200
    v_add_f32 v197, v197, v202
    v_cvt_pk_bf16_f32 v156, v201, v202
    v_fma_f32 v199, v60, s36, v193
    s_waitcnt lgkmcnt(2)
    v_mfma_f32_32x32x16_bf16 v[96:111], a[196:199], a[148:151], v[96:111]
    v_exp_f32 v204, v198
    v_add_f32 v197, v197, v203
    v_fma_f32 v200, v61, s36, v193
    v_exp_f32 v201, v199
    v_mfma_f32_32x32x16_bf16 v[112:127], a[196:199], a[180:183], v[112:127]
    ds_read_b64_tr_b16 a[208:209], v220 offset:0
    v_add_f32 v197, v197, v204
    v_cvt_pk_bf16_f32 v157, v203, v204
    v_fma_f32 v198, v62, s36, v193
    s_waitcnt lgkmcnt(2)
    v_mfma_f32_32x32x16_bf16 v[96:111], a[200:203], a[152:155], v[96:111]
    ds_read_b64_tr_b16 a[210:211], v220 offset:2048
    ds_read_b64_tr_b16 a[212:213], v221 offset:0
    v_exp_f32 v202, v200
    v_add_f32 v197, v197, v201
    v_mfma_f32_32x32x16_bf16 v[112:127], a[200:203], a[184:187], v[112:127]
    ds_read_b64_tr_b16 a[214:215], v221 offset:2048
    ds_read_b64_tr_b16 a[216:217], v222 offset:0
    v_fma_f32 v199, v63, s36, v193
    v_exp_f32 v203, v198
    s_waitcnt lgkmcnt(5)
    v_mfma_f32_32x32x16_bf16 v[96:111], a[204:207], a[156:159], v[96:111]
    ds_read_b64_tr_b16 a[218:219], v222 offset:2048
    v_add_f32 v197, v197, v202
    v_cvt_pk_bf16_f32 v158, v201, v202
    v_exp_f32 v204, v199
    v_add_f32 v197, v197, v203
    v_add_f32 v197, v197, v204
    v_cvt_pk_bf16_f32 v159, v203, v204
    v_mfma_f32_32x32x16_bf16 v[112:127], a[204:207], a[188:191], v[112:127]
    v_cmp_lt_f32 vcc, 0x45800000, v196
    v_cmp_lt_f32 s[44:45], s47, v197
    s_or_b64 vcc, vcc, s[44:45]
    s_cbranch_vccnz RARE_A0
    v_add_f32 v194, v194, v196
    v_mov_b32 v196, 0
    v_add_f32 v195, v195, v197
    v_mov_b32 v197, 0
BACK_A0:
    ds_read_b64_tr_b16 a[220:221], v223 offset:0
    v_fma_f32 v198, v64, s36, v192
    v_fma_f32 v199, v65, s36, v192
    v_exp_f32 v201, v198
    v_fma_f32 v200, v66, s36, v192
    s_waitcnt lgkmcnt(5)
    v_mfma_f32_32x32x16_bf16 a[0:15], a[208:211], v[128:131], a[0:15]
    ds_read_b64_tr_b16 a[222:223], v223 offset:2048
    s_add_u32 m0, s48, 16384
    s_nop 0
    buffer_load_dwordx4 v232, s[12:15], s37 offen offset:0 lds
    v_exp_f32 v202, v199
    v_add_f32 v196, v196, v201
    v_mfma_f32_32x32x16_bf16 a[64:79], a[208:211], v[144:147], a[64:79]
    ds_read_b64_tr_b16 a[208:209], v220 offset:4096
    v_fma_f32 v198, v67, s36, v192
    v_exp_f32 v203, v200
    v_add_f32 v196, v196, v202
    v_cvt_pk_bf16_f32 v160, v201, v202
    s_waitcnt lgkmcnt(5)
    v_mfma_f32_32x32x16_bf16 a[16:31], a[212:215], v[128:131], a[16:31]
    ds_read_b64_tr_b16 a[210:211], v220 offset:6144
    v_fma_f32 v199, v68, s36, v192
    v_exp_f32 v204, v198
    v_add_f32 v196, v196, v203
    v_fma_f32 v200, v69, s36, v192
    v_mfma_f32_32x32x16_bf16 a[80:95], a[212:215], v[144:147], a[80:95]
    ds_read_b64_tr_b16 a[212:213], v221 offset:4096
    v_exp_f32 v201, v199
    v_add_f32 v196, v196, v204
    v_cvt_pk_bf16_f32 v161, v203, v204
    v_fma_f32 v198, v70, s36, v192
    s_waitcnt lgkmcnt(5)
    v_mfma_f32_32x32x16_bf16 a[32:47], a[216:219], v[128:131], a[32:47]
    ds_read_b64_tr_b16 a[214:215], v221 offset:6144
    v_exp_f32 v202, v200
    v_add_f32 v196, v196, v201
    v_fma_f32 v199, v71, s36, v192
    v_mfma_f32_32x32x16_bf16 a[96:111], a[216:219], v[144:147], a[96:111]
    ds_read_b64_tr_b16 a[216:217], v222 offset:4096
    s_add_u32 m0, s48, 16384
    s_nop 0
    buffer_load_dwordx4 v232, s[12:15], s37 offen offset:1024 lds
    v_exp_f32 v203, v198
    v_add_f32 v196, v196, v202
    s_waitcnt lgkmcnt(5)
    v_mfma_f32_32x32x16_bf16 a[48:63], a[220:223], v[128:131], a[48:63]
    ds_read_b64_tr_b16 a[218:219], v222 offset:6144
    v_cvt_pk_bf16_f32 v162, v201, v202
    v_fma_f32 v200, v72, s36, v192
    v_exp_f32 v204, v199
    v_add_f32 v196, v196, v203
    v_mfma_f32_32x32x16_bf16 a[112:127], a[220:223], v[144:147], a[112:127]
    ds_read_b64_tr_b16 a[220:221], v223 offset:4096
    v_fma_f32 v198, v73, s36, v192
    v_exp_f32 v201, v200
    v_add_f32 v196, v196, v204
    v_cvt_pk_bf16_f32 v163, v203, v204
    s_waitcnt lgkmcnt(5)
    v_mfma_f32_32x32x16_bf16 a[0:15], a[208:211], v[132:135], a[0:15]
    ds_read_b64_tr_b16 a[222:223], v223 offset:6144
    v_fma_f32 v199, v74, s36, v192
    v_exp_f32 v202, v198
    v_add_f32 v196, v196, v201
    v_fma_f32 v200, v75, s36, v192
    v_mfma_f32_32x32x16_bf16 a[64:79], a[208:211], v[148:151], a[64:79]
    ds_read_b64_tr_b16 a[208:209], v220 offset:8192
    v_exp_f32 v203, v199
    v_add_f32 v196, v196, v202
    v_cvt_pk_bf16_f32 v164, v201, v202
    v_fma_f32 v198, v76, s36, v192
    s_waitcnt lgkmcnt(5)
    v_mfma_f32_32x32x16_bf16 a[16:31], a[212:215], v[132:135], a[16:31]
    ds_read_b64_tr_b16 a[210:211], v220 offset:10240
    s_add_u32 m0, s48, 16384
    s_nop 0
    buffer_load_dwordx4 v232, s[12:15], s37 offen offset:2048 lds
    v_exp_f32 v204, v200
    v_add_f32 v196, v196, v203
    v_mfma_f32_32x32x16_bf16 a[80:95], a[212:215], v[148:151], a[80:95]
    ds_read_b64_tr_b16 a[212:213], v221 offset:8192
    v_fma_f32 v199, v77, s36, v192
    v_exp_f32 v201, v198
    v_add_f32 v196, v196, v204
    v_cvt_pk_bf16_f32 v165, v203, v204
    s_waitcnt lgkmcnt(5)
    v_mfma_f32_32x32x16_bf16 a[32:47], a[216:219], v[132:135], a[32:47]
    ds_read_b64_tr_b16 a[214:215], v221 offset:10240
    v_fma_f32 v200, v78, s36, v192
    v_exp_f32 v202, v199
    v_add_f32 v196, v196, v201
    v_fma_f32 v198, v79, s36, v192
    v_mfma_f32_32x32x16_bf16 a[96:111], a[216:219], v[148:151], a[96:111]
    ds_read_b64_tr_b16 a[216:217], v222 offset:8192
    v_exp_f32 v203, v200
    v_add_f32 v196, v196, v202
    v_cvt_pk_bf16_f32 v166, v201, v202
    v_fma_f32 v199, v80, s36, v193
    s_waitcnt lgkmcnt(5)
    v_mfma_f32_32x32x16_bf16 a[48:63], a[220:223], v[132:135], a[48:63]
    ds_read_b64_tr_b16 a[218:219], v222 offset:10240
    v_exp_f32 v204, v198
    v_add_f32 v196, v196, v203
    v_fma_f32 v200, v81, s36, v193
    v_mfma_f32_32x32x16_bf16 a[112:127], a[220:223], v[148:151], a[112:127]
    ds_read_b64_tr_b16 a[220:221], v223 offset:8192
    s_add_u32 m0, s48, 16384
    s_nop 0
    buffer_load_dwordx4 v232, s[12:15], s37 offen offset:3072 lds
    v_exp_f32 v201, v199
    v_add_f32 v196, v196, v204
    s_waitcnt lgkmcnt(5)
    v_mfma_f32_32x32x16_bf16 a[0:15], a[208:211], v[136:139], a[0:15]
    ds_read_b64_tr_b16 a[222:223], v223 offset:10240
    v_cvt_pk_bf16_f32 v167, v203, v204
    v_fma_f32 v198, v82, s36, v193
    v_exp_f32 v202, v200
    v_add_f32 v197, v197, v201
    v_mfma_f32_32x32x16_bf16 a[64:79], a[208:211], v[152:155], a[64:79]
    ds_read_b64_tr_b16 a[208:209], v220 offset:12288
    v_fma_f32 v199, v83, s36, v193
    v_exp_f32 v203, v198
    v_add_f32 v197, v197, v202
    v_cvt_pk_bf16_f32 v176, v201, v202
    s_waitcnt lgkmcnt(5)
    v_mfma_f32_32x32x16_bf16 a[16:31], a[212:215], v[136:139], a[16:31]
    ds_read_b64_tr_b16 a[210:211], v220 offset:14336
    v_fma_f32 v200, v84, s36, v193
    v_exp_f32 v204, v199
    v_add_f32 v197, v197, v203
    v_fma_f32 v198, v85, s36, v193
    v_mfma_f32_32x32x16_bf16 a[80:95], a[212:215], v[152:155], a[80:95]
    ds_read_b64_tr_b16 a[212:213], v221 offset:12288
    v_exp_f32 v201, v200
    v_add_f32 v197, v197, v204
    v_cvt_pk_bf16_f32 v177, v203, v204
    v_fma_f32 v199, v86, s36, v193
    s_waitcnt lgkmcnt(5)
    v_mfma_f32_32x32x16_bf16 a[32:47], a[216:219], v[136:139], a[32:47]
    ds_read_b64_tr_b16 a[214:215], v221 offset:14336
    v_exp_f32 v202, v198
    v_add_f32 v197, v197, v201
    v_fma_f32 v200, v87, s36, v193
    v_mfma_f32_32x32x16_bf16 a[96:111], a[216:219], v[152:155], a[96:111]
    ds_read_b64_tr_b16 a[216:217], v222 offset:12288
    v_exp_f32 v203, v199
    v_add_f32 v197, v197, v202
    v_cvt_pk_bf16_f32 v178, v201, v202
    v_fma_f32 v198, v88, s36, v193
    s_waitcnt lgkmcnt(5)
    v_mfma_f32_32x32x16_bf16 a[48:63], a[220:223], v[136:139], a[48:63]
    ds_read_b64_tr_b16 a[218:219], v222 offset:14336
    v_exp_f32 v204, v200
    v_add_f32 v197, v197, v203
    v_fma_f32 v199, v89, s36, v193
    v_mfma_f32_32x32x16_bf16 a[112:127], a[220:223], v[152:155], a[112:127]
    ds_read_b64_tr_b16 a[220:221], v223 offset:12288
    v_exp_f32 v201, v198
    v_add_f32 v197, v197, v204
    v_cvt_pk_bf16_f32 v179, v203, v204
    v_fma_f32 v200, v90, s36, v193
    s_waitcnt lgkmcnt(5)
    v_mfma_f32_32x32x16_bf16 a[0:15], a[208:211], v[140:143], a[0:15]
    ds_read_b64_tr_b16 a[222:223], v223 offset:14336
    v_exp_f32 v202, v199
    v_add_f32 v197, v197, v201
    v_fma_f32 v198, v91, s36, v193
    v_mfma_f32_32x32x16_bf16 a[64:79], a[208:211], v[156:159], a[64:79]
    v_exp_f32 v203, v200
    v_add_f32 v197, v197, v202
    v_cvt_pk_bf16_f32 v180, v201, v202
    v_fma_f32 v199, v92, s36, v193
    s_waitcnt lgkmcnt(4)
    v_mfma_f32_32x32x16_bf16 a[16:31], a[212:215], v[140:143], a[16:31]
    s_add_u32 s37, s37, 16384
    v_exp_f32 v204, v198
    v_add_f32 v197, v197, v203
    v_fma_f32 v200, v93, s36, v193
    v_exp_f32 v201, v199
    v_mfma_f32_32x32x16_bf16 a[80:95], a[212:215], v[156:159], a[80:95]
    s_waitcnt vmcnt(8) lgkmcnt(0)
    s_barrier
    s_mov_b32 s42, s41
    s_add_u32 s46, s40, 0x8000
    s_and_b32 s46, s46, 0x1ffff
    s_sub_u32 s41, s46, s40
    s_mov_b32 s40, s46
    s_add_u32 s43, s43, 0x8000
    s_and_b32 s43, s43, 0x1ffff
    s_add_u32 s48, s43, s53
    s_lshr_b32 s46, s43, 2
    s_add_u32 s46, s46, s54
    s_add_u32 s49, s46, 0x20000
    s_ashr_i32 s44, s41, 2
    s_ashr_i32 s45, s42, 2
    v_add_u32 v212, s41, v212
    v_add_u32 v213, s41, v213
    v_add_u32 v214, s41, v214
    v_add_f32 v197, v197, v204
    v_mfma_f32_32x32x16_bf16 a[32:47], a[216:219], v[140:143], a[32:47]
    ds_read_b128 a[192:195], v212 offset:0
    ds_read_b128 a[196:199], v213 offset:0
    v_add_u32 v215, s41, v215
    v_add_u32 v216, s41, v216
    v_add_u32 v217, s41, v217
    v_mfma_f32_32x32x16_bf16 a[96:111], a[216:219], v[156:159], a[96:111]
    ds_read_b128 a[200:203], v214 offset:0
    v_add_u32 v218, s41, v218
    v_add_u32 v219, s41, v219
    v_add_u32 v220, s42, v220
    v_add_u32 v221, s42, v221
    v_mfma_f32_32x32x16_bf16 a[48:63], a[220:223], v[140:143], a[48:63]
    v_add_u32 v222, s42, v222
    v_add_u32 v223, s42, v223
    v_add_u32 v224, s45, v224
    v_add_u32 v225, s45, v225
    v_add_u32 v226, s44, v226
    v_add_u32 v227, s44, v227
    v_cvt_pk_bf16_f32 v181, v203, v204
    v_fma_f32 v198, v94, s36, v193
    v_exp_f32 v202, v200
    v_add_f32 v197, v197, v201
    v_fma_f32 v199, v95, s36, v193
    v_exp_f32 v203, v198
    v_add_f32 v197, v197, v202
    v_cvt_pk_bf16_f32 v182, v201, v202
    v_exp_f32 v204, v199
    v_add_f32 v197, v197, v203
    v_add_f32 v197, v197, v204
    v_cvt_pk_bf16_f32 v183, v203, v204
    v_mfma_f32_32x32x16_bf16 a[112:127], a[220:223], v[156:159], a[112:127]
    ds_read_b128 a[204:207], v215 offset:0
    v_fma_f32 v198, v96, s36, v192
    v_fma_f32 v199, v97, s36, v192
    v_exp_f32 v201, v198
    s_waitcnt lgkmcnt(3)
    v_mfma_f32_32x32x16_bf16 v[0:15], a[192:195], a[128:131], 0
    s_add_u32 m0, s48, 0
    s_nop 0
    buffer_load_dwordx4 v228, s[8:11], s37 offen offset:0 lds
    v_fma_f32 v200, v98, s36, v192
    v_exp_f32 v202, v199
    v_add_f32 v196, v196, v201
    v_mfma_f32_32x32x16_bf16 v[16:31], a[192:195], a[160:163], 0
    ds_read_b128 a[192:195], v216 offset:0
    v_fma_f32 v198, v99, s36, v192
    v_exp_f32 v203, v200
    v_add_f32 v196, v196, v202
    s_waitcnt lgkmcnt(3)
    v_mfma_f32_32x32x16_bf16 v[0:15], a[196:199], a[132:135], v[0:15]
    v_cvt_pk_bf16_f32 v168, v201, v202
    v_fma_f32 v199, v100, s36, v192
    v_exp_f32 v204, v198
    v_add_f32 v196, v196, v203
    v_fma_f32 v200, v101, s36, v192
    v_mfma_f32_32x32x16_bf16 v[16:31], a[196:199], a[164:167], v[16:31]
    ds_read_b128 a[196:199], v217 offset:0
    v_exp_f32 v201, v199
    v_add_f32 v196, v196, v204
    v_cvt_pk_bf16_f32 v169, v203, v204
    s_waitcnt lgkmcnt(3)
    v_mfma_f32_32x32x16_bf16 v[0:15], a[200:203], a[136:139], v[0:15]
    v_fma_f32 v198, v102, s36, v192
    v_exp_f32 v202, v200
    v_add_f32 v196, v196, v201
    v_fma_f32 v199, v103, s36, v192
    v_mfma_f32_32x32x16_bf16 v[16:31], a[200:203], a[168:171], v[16:31]
    ds_read_b128 a[200:203], v218 offset:0
    v_exp_f32 v203, v198
    v_add_f32 v196, v196, v202
    v_cvt_pk_bf16_f32 v170, v201, v202
    s_waitcnt lgkmcnt(3)
    v_mfma_f32_32x32x16_bf16 v[0:15], a[204:207], a[140:143], v[0:15]
    s_add_u32 m0, s48, 0
    s_nop 0
    buffer_load_dwordx4 v229, s[8:11], s37 offen offset:1024 lds
    v_fma_f32 v200, v104, s36, v192
    v_exp_f32 v204, v199
    v_add_f32 v196, v196, v203
    v_mfma_f32_32x32x16_bf16 v[16:31], a[204:207], a[172:175], v[16:31]
    ds_read_b128 a[204:207], v219 offset:0
    v_fma_f32 v198, v105, s36, v192
    v_exp_f32 v201, v200
    v_add_f32 v196, v196, v204
    s_waitcnt lgkmcnt(3)
    v_mfma_f32_32x32x16_bf16 v[0:15], a[192:195], a[144:147], v[0:15]
    v_cvt_pk_bf16_f32 v171, v203, v204
    v_fma_f32 v199, v106, s36, v192
    v_exp_f32 v202, v198
    v_add_f32 v196, v196, v201
    v_fma_f32 v200, v107, s36, v192
    v_mfma_f32_32x32x16_bf16 v[16:31], a[192:195], a[176:179], v[16:31]
    ds_read_b128 a[192:195], v212 offset:8192
    v_exp_f32 v203, v199
    v_add_f32 v196, v196, v202
    v_cvt_pk_bf16_f32 v172, v201, v202
    s_waitcnt lgkmcnt(3)
    v_mfma_f32_32x32x16_bf16 v[0:15], a[196:199], a[148:151], v[0:15]
    s_add_u32 m0, s48, 0
    s_nop 0
    buffer_load_dwordx4 v230, s[8:11], s37 offen offset:2048 lds
    v_fma_f32 v198, v108, s36, v192
    v_exp_f32 v204, v200
    v_add_f32 v196, v196, v203
    v_mfma_f32_32x32x16_bf16 v[16:31], a[196:199], a[180:183], v[16:31]
    ds_read_b128 a[196:199], v213 offset:8192
    v_fma_f32 v199, v109, s36, v192
    v_exp_f32 v201, v198
    v_add_f32 v196, v196, v204
    s_waitcnt lgkmcnt(3)
    v_mfma_f32_32x32x16_bf16 v[0:15], a[200:203], a[152:155], v[0:15]
    v_cvt_pk_bf16_f32 v173, v203, v204
    v_fma_f32 v200, v110, s36, v192
    v_exp_f32 v202, v199
    v_add_f32 v196, v196, v201
    v_fma_f32 v198, v111, s36, v192
    v_mfma_f32_32x32x16_bf16 v[16:31], a[200:203], a[184:187], v[16:31]
    ds_read_b128 a[200:203], v214 offset:8192
    v_exp_f32 v203, v200
    v_add_f32 v196, v196, v202
    v_cvt_pk_bf16_f32 v174, v201, v202
    s_waitcnt lgkmcnt(3)
    v_mfma_f32_32x32x16_bf16 v[0:15], a[204:207], a[156:159], v[0:15]
    v_fma_f32 v199, v112, s36, v193
    v_exp_f32 v204, v198
    v_add_f32 v196, v196, v203
    v_fma_f32 v200, v113, s36, v193
    v_mfma_f32_32x32x16_bf16 v[16:31], a[204:207], a[188:191], v[16:31]
    ds_read_b128 a[204:207], v215 offset:8192
    v_exp_f32 v201, v199
    v_add_f32 v196, v196, v204
    v_cvt_pk_bf16_f32 v175, v203, v204
    s_waitcnt lgkmcnt(3)
    v_mfma_f32_32x32x16_bf16 v[32:47], a[192:195], a[128:131], 0
    s_add_u32 m0, s48, 0
    s_nop 0
    buffer_load_dwordx4 v231, s[8:11], s37 offen offset:3072 lds
    v_fma_f32 v198, v114, s36, v193
    v_exp_f32 v202, v200
    v_add_f32 v197, v197, v201
    v_mfma_f32_32x32x16_bf16 v[48:63], a[192:195], a[160:163], 0
    ds_read_b128 a[192:195], v216 offset:8192
    v_fma_f32 v199, v115, s36, v193
    v_exp_f32 v203, v198
    v_add_f32 v197, v197, v202
    s_waitcnt lgkmcnt(3)
    v_mfma_f32_32x32x16_bf16 v[32:47], a[196:199], a[132:135], v[32:47]
    v_cvt_pk_bf16_f32 v184, v201, v202
    v_fma_f32 v200, v116, s36, v193
    v_exp_f32 v204, v199
    v_add_f32 v197, v197, v203
    v_fma_f32 v198, v117, s36, v193
    v_mfma_f32_32x32x16_bf16 v[48:63], a[196:199], a[164:167], v[48:63]
    ds_read_b128 a[196:199], v217 offset:8192
    v_exp_f32 v201, v200
    v_add_f32 v197, v197, v204
    v_cvt_pk_bf16_f32 v185, v203, v204
    s_waitcnt lgkmcnt(3)
    v_mfma_f32_32x32x16_bf16 v[32:47], a[200:203], a[136:139], v[32:47]
    v_fma_f32 v199, v118, s36, v193
    v_exp_f32 v202, v198
    v_add_f32 v197, v197, v201
    v_fma_f32 v200, v119, s36, v193
    v_mfma_f32_32x32x16_bf16 v[48:63], a[200:203], a[168:171], v[48:63]
    ds_read_b128 a[200:203], v218 offset:8192
    v_exp_f32 v203, v199
    v_add_f32 v197, v197, v202
    v_cvt_pk_bf16_f32 v186, v201, v202
    s_waitcnt lgkmcnt(3)
    v_mfma_f32_32x32x16_bf16 v[32:47], a[204:207], a[140:143], v[32:47]
    v_fma_f32 v198, v120, s36, v193
    v_exp_f32 v204, v200
    v_add_f32 v197, v197, v203
    v_fma_f32 v199, v121, s36, v193
    v_mfma_f32_32x32x16_bf16 v[48:63], a[204:207], a[172:175], v[48:63]
    ds_read_b128 a[204:207], v219 offset:8192
    v_exp_f32 v201, v198
    v_add_f32 v197, v197, v204
    v_cvt_pk_bf16_f32 v187, v203, v204
    s_waitcnt lgkmcnt(3)
    v_mfma_f32_32x32x16_bf16 v[32:47], a[192:195], a[144:147], v[32:47]
    v_fma_f32 v200, v122, s36, v193
    v_exp_f32 v202, v199
    v_add_f32 v197, v197, v201
    v_fma_f32 v198, v123, s36, v193
    v_mfma_f32_32x32x16_bf16 v[48:63], a[192:195], a[176:179], v[48:63]
    v_exp_f32 v203, v200
    v_add_f32 v197, v197, v202
    v_cvt_pk_bf16_f32 v188, v201, v202
    v_fma_f32 v199, v124, s36, v193
    s_waitcnt lgkmcnt(2)
    v_mfma_f32_32x32x16_bf16 v[32:47], a[196:199], a[148:151], v[32:47]
    v_exp_f32 v204, v198
    v_add_f32 v197, v197, v203
    v_fma_f32 v200, v125, s36, v193
    v_exp_f32 v201, v199
    v_mfma_f32_32x32x16_bf16 v[48:63], a[196:199], a[180:183], v[48:63]
    ds_read_b64_tr_b16 a[208:209], v220 offset:0
    v_add_f32 v197, v197, v204
    v_cvt_pk_bf16_f32 v189, v203, v204
    v_fma_f32 v198, v126, s36, v193
    s_waitcnt lgkmcnt(2)
    v_mfma_f32_32x32x16_bf16 v[32:47], a[200:203], a[152:155], v[32:47]
    ds_read_b64_tr_b16 a[210:211], v220 offset:2048
    ds_read_b64_tr_b16 a[212:213], v221 offset:0
    v_exp_f32 v202, v200
    v_add_f32 v197, v197, v201
    v_mfma_f32_32x32x16_bf16 v[48:63], a[200:203], a[184:187], v[48:63]
    ds_read_b64_tr_b16 a[214:215], v221 offset:2048
    ds_read_b64_tr_b16 a[216:217], v222 offset:0
    v_fma_f32 v199, v127, s36, v193
    v_exp_f32 v203, v198
    s_waitcnt lgkmcnt(5)
    v_mfma_f32_32x32x16_bf16 v[32:47], a[204:207], a[156:159], v[32:47]
    ds_read_b64_tr_b16 a[218:219], v222 offset:2048
    v_add_f32 v197, v197, v202
    v_cvt_pk_bf16_f32 v190, v201, v202
    v_exp_f32 v204, v199
    v_add_f32 v197, v197, v203
    v_add_f32 v197, v197, v204
    v_cvt_pk_bf16_f32 v191, v203, v204
    v_mfma_f32_32x32x16_bf16 v[48:63], a[204:207], a[188:191], v[48:63]
    v_cmp_lt_f32 vcc, 0x45800000, v196
    v_cmp_lt_f32 s[44:45], s47, v197
    s_or_b64 vcc, vcc, s[44:45]
    s_cbranch_vccnz RARE_A1
    v_add_f32 v194, v194, v196
    v_mov_b32 v196, 0
    v_add_f32 v195, v195, v197
    v_mov_b32 v197, 0
BACK_A1:
    ds_read_b64_tr_b16 a[220:221], v223 offset:0
    v_fma_f32 v198, v0, s36, v192
    v_fma_f32 v199, v1, s36, v192
    v_exp_f32 v201, v198
    v_fma_f32 v200, v2, s36, v192
    s_waitcnt lgkmcnt(5)
    v_mfma_f32_32x32x16_bf16 a[0:15], a[208:211], v[160:163], a[0:15]
    ds_read_b64_tr_b16 a[222:223], v223 offset:2048
    s_add_u32 m0, s48, 16384
    s_nop 0
    buffer_load_dwordx4 v232, s[12:15], s37 offen offset:0 lds
    v_exp_f32 v202, v199
    v_add_f32 v196, v196, v201
    v_mfma_f32_32x32x16_bf16 a[64:79], a[208:211], v[176:179], a[64:79]
    ds_read_b64_tr_b16 a[208:209], v220 offset:4096
    v_fma_f32 v198, v3, s36, v192
    v_exp_f32 v203, v200
    v_add_f32 v196, v196, v202
    v_cvt_pk_bf16_f32 v128, v201, v202
    s_waitcnt lgkmcnt(5)
    v_mfma_f32_32x32x16_bf16 a[16:31], a[212:215], v[160:163], a[16:31]
    ds_read_b64_tr_b16 a[210:211], v220 offset:6144
    v_fma_f32 v199, v4, s36, v192
    v_exp_f32 v204, v198
    v_add_f32 v196, v196, v203
    v_fma_f32 v200, v5, s36, v192
    v_mfma_f32_32x32x16_bf16 a[80:95], a[212:215], v[176:179], a[80:95]
    ds_read_b64_tr_b16 a[212:213], v221 offset:4096
    v_exp_f32 v201, v199
    v_add_f32 v196, v196, v204
    v_cvt_pk_bf16_f32 v129, v203, v204
    v_fma_f32 v198, v6, s36, v192
    s_waitcnt lgkmcnt(5)
    v_mfma_f32_32x32x16_bf16 a[32:47], a[216:219], v[160:163], a[32:47]
    ds_read_b64_tr_b16 a[214:215], v221 offset:6144
    v_exp_f32 v202, v200
    v_add_f32 v196, v196, v201
    v_fma_f32 v199, v7, s36, v192
    v_mfma_f32_32x32x16_bf16 a[96:111], a[216:219], v[176:179], a[96:111]
    ds_read_b64_tr_b16 a[216:217], v222 offset:4096
    s_add_u32 m0, s48, 16384
    s_nop 0
    buffer_load_dwordx4 v232, s[12:15], s37 offen offset:1024 lds
    v_exp_f32 v203, v198
    v_add_f32 v196, v196, v202
    s_waitcnt lgkmcnt(5)
    v_mfma_f32_32x32x16_bf16 a[48:63], a[220:223], v[160:163], a[48:63]
    ds_read_b64_tr_b16 a[218:219], v222 offset:6144
    v_cvt_pk_bf16_f32 v130, v201, v202
    v_fma_f32 v200, v8, s36, v192
    v_exp_f32 v204, v199
    v_add_f32 v196, v196, v203
    v_mfma_f32_32x32x16_bf16 a[112:127], a[220:223], v[176:179], a[112:127]
    ds_read_b64_tr_b16 a[220:221], v223 offset:4096
    v_fma_f32 v198, v9, s36, v192
    v_exp_f32 v201, v200
    v_add_f32 v196, v196, v204
    v_cvt_pk_bf16_f32 v131, v203, v204
    s_waitcnt lgkmcnt(5)
    v_mfma_f32_32x32x16_bf16 a[0:15], a[208:211], v[164:167], a[0:15]
    ds_read_b64_tr_b16 a[222:223], v223 offset:6144
    v_fma_f32 v199, v10, s36, v192
    v_exp_f32 v202, v198
    v_add_f32 v196, v196, v201
    v_fma_f32 v200, v11, s36, v192
    v_mfma_f32_32x32x16_bf16 a[64:79], a[208:211], v[180:183], a[64:79]
    ds_read_b64_tr_b16 a[208:209], v220 offset:8192
    v_exp_f32 v203, v199
    v_add_f32 v196, v196, v202
    v_cvt_pk_bf16_f32 v132, v201, v202
    v_fma_f32 v198, v12, s36, v192
    s_waitcnt lgkmcnt(5)
    v_mfma_f32_32x32x16_bf16 a[16:31], a[212:215], v[164:167], a[16:31]
    ds_read_b64_tr_b16 a[210:211], v220 offset:10240
    s_add_u32 m0, s48, 16384
    s_nop 0
    buffer_load_dwordx4 v232, s[12:15], s37 offen offset:2048 lds
    v_exp_f32 v204, v200
    v_add_f32 v196, v196, v203
    v_mfma_f32_32x32x16_bf16 a[80:95], a[212:215], v[180:183], a[80:95]
    ds_read_b64_tr_b16 a[212:213], v221 offset:8192
    v_fma_f32 v199, v13, s36, v192
    v_exp_f32 v201, v198
    v_add_f32 v196, v196, v204
    v_cvt_pk_bf16_f32 v133, v203, v204
    s_waitcnt lgkmcnt(5)
    v_mfma_f32_32x32x16_bf16 a[32:47], a[216:219], v[164:167], a[32:47]
    ds_read_b64_tr_b16 a[214:215], v221 offset:10240
    v_fma_f32 v200, v14, s36, v192
    v_exp_f32 v202, v199
    v_add_f32 v196, v196, v201
    v_fma_f32 v198, v15, s36, v192
    v_mfma_f32_32x32x16_bf16 a[96:111], a[216:219], v[180:183], a[96:111]
    ds_read_b64_tr_b16 a[216:217], v222 offset:8192
    v_exp_f32 v203, v200
    v_add_f32 v196, v196, v202
    v_cvt_pk_bf16_f32 v134, v201, v202
    v_fma_f32 v199, v16, s36, v193
    s_waitcnt lgkmcnt(5)
    v_mfma_f32_32x32x16_bf16 a[48:63], a[220:223], v[164:167], a[48:63]
    ds_read_b64_tr_b16 a[218:219], v222 offset:10240
    v_exp_f32 v204, v198
    v_add_f32 v196, v196, v203
    v_fma_f32 v200, v17, s36, v193
    v_mfma_f32_32x32x16_bf16 a[112:127], a[220:223], v[180:183], a[112:127]
    ds_read_b64_tr_b16 a[220:221], v223 offset:8192
    s_add_u32 m0, s48, 16384
    s_nop 0
    buffer_load_dwordx4 v232, s[12:15], s37 offen offset:3072 lds
    v_exp_f32 v201, v199
    v_add_f32 v196, v196, v204
    s_waitcnt lgkmcnt(5)
    v_mfma_f32_32x32x16_bf16 a[0:15], a[208:211], v[168:171], a[0:15]
    ds_read_b64_tr_b16 a[222:223], v223 offset:10240
    v_cvt_pk_bf16_f32 v135, v203, v204
    v_fma_f32 v198, v18, s36, v193
    v_exp_f32 v202, v200
    v_add_f32 v197, v197, v201
    v_mfma_f32_32x32x16_bf16 a[64:79], a[208:211], v[184:187], a[64:79]
    ds_read_b64_tr_b16 a[208:209], v220 offset:12288
    v_fma_f32 v199, v19, s36, v193
    v_exp_f32 v203, v198
    v_add_f32 v197, v197, v202
    v_cvt_pk_bf16_f32 v144, v201, v202
    s_waitcnt lgkmcnt(5)
    v_mfma_f32_32x32x16_bf16 a[16:31], a[212:215], v[168:171], a[16:31]
    ds_read_b64_tr_b16 a[210:211], v220 offset:14336
    v_fma_f32 v200, v20, s36, v193
    v_exp_f32 v204, v199
    v_add_f32 v197, v197, v203
    v_fma_f32 v198, v21, s36, v193
    v_mfma_f32_32x32x16_bf16 a[80:95], a[212:215], v[184:187], a[80:95]
    ds_read_b64_tr_b16 a[212:213], v221 offset:12288
    v_exp_f32 v201, v200
    v_add_f32 v197, v197, v204
    v_cvt_pk_bf16_f32 v145, v203, v204
    v_fma_f32 v199, v22, s36, v193
    s_waitcnt lgkmcnt(5)
    v_mfma_f32_32x32x16_bf16 a[32:47], a[216:219], v[168:171], a[32:47]
    ds_read_b64_tr_b16 a[214:215], v221 offset:14336
    v_exp_f32 v202, v198
    v_add_f32 v197, v197, v201
    v_fma_f32 v200, v23, s36, v193
    v_mfma_f32_32x32x16_bf16 a[96:111], a[216:219], v[184:187], a[96:111]
    ds_read_b64_tr_b16 a[216:217], v222 offset:12288
    v_exp_f32 v203, v199
    v_add_f32 v197, v197, v202
    v_cvt_pk_bf16_f32 v146, v201, v202
    v_fma_f32 v198, v24, s36, v193
    s_waitcnt lgkmcnt(5)
    v_mfma_f32_32x32x16_bf16 a[48:63], a[220:223], v[168:171], a[48:63]
    ds_read_b64_tr_b16 a[218:219], v222 offset:14336
    v_exp_f32 v204, v200
    v_add_f32 v197, v197, v203
    v_fma_f32 v199, v25, s36, v193
    v_mfma_f32_32x32x16_bf16 a[112:127], a[220:223], v[184:187], a[112:127]
    ds_read_b64_tr_b16 a[220:221], v223 offset:12288
    v_exp_f32 v201, v198
    v_add_f32 v197, v197, v204
    v_cvt_pk_bf16_f32 v147, v203, v204
    v_fma_f32 v200, v26, s36, v193
    s_waitcnt lgkmcnt(5)
    v_mfma_f32_32x32x16_bf16 a[0:15], a[208:211], v[172:175], a[0:15]
    ds_read_b64_tr_b16 a[222:223], v223 offset:14336
    v_exp_f32 v202, v199
    v_add_f32 v197, v197, v201
    v_fma_f32 v198, v27, s36, v193
    v_mfma_f32_32x32x16_bf16 a[64:79], a[208:211], v[188:191], a[64:79]
    v_exp_f32 v203, v200
    v_add_f32 v197, v197, v202
    v_cvt_pk_bf16_f32 v148, v201, v202
    v_fma_f32 v199, v28, s36, v193
    s_waitcnt lgkmcnt(4)
    v_mfma_f32_32x32x16_bf16 a[16:31], a[212:215], v[172:175], a[16:31]
    s_add_u32 s37, s37, 16384
    v_exp_f32 v204, v198
    v_add_f32 v197, v197, v203
    v_fma_f32 v200, v29, s36, v193
    v_exp_f32 v201, v199
    v_mfma_f32_32x32x16_bf16 a[80:95], a[212:215], v[188:191], a[80:95]
    s_waitcnt vmcnt(8) lgkmcnt(0)
    s_barrier
    s_mov_b32 s42, s41
    s_add_u32 s46, s40, 0x8000
    s_and_b32 s46, s46, 0x1ffff
    s_sub_u32 s41, s46, s40
    s_mov_b32 s40, s46
    s_add_u32 s43, s43, 0x8000
    s_and_b32 s43, s43, 0x1ffff
    s_add_u32 s48, s43, s53
    s_lshr_b32 s46, s43, 2
    s_add_u32 s46, s46, s54
    s_add_u32 s49, s46, 0x20000
    s_ashr_i32 s44, s41, 2
    s_ashr_i32 s45, s42, 2
    v_add_u32 v212, s41, v212
    v_add_u32 v213, s41, v213
    v_add_u32 v214, s41, v214
    v_add_f32 v197, v197, v204
    v_mfma_f32_32x32x16_bf16 a[32:47], a[216:219], v[172:175], a[32:47]
    ds_read_b128 a[192:195], v212 offset:0
    ds_read_b128 a[196:199], v213 offset:0
    v_add_u32 v215, s41, v215
    v_add_u32 v216, s41, v216
    v_add_u32 v217, s41, v217
    v_mfma_f32_32x32x16_bf16 a[96:111], a[216:219], v[188:191], a[96:111]
    ds_read_b128 a[200:203], v214 offset:0
    v_add_u32 v218, s41, v218
    v_add_u32 v219, s41, v219
    v_add_u32 v220, s42, v220
    v_add_u32 v221, s42, v221
    v_mfma_f32_32x32x16_bf16 a[48:63], a[220:223], v[172:175], a[48:63]
    v_add_u32 v222, s42, v222
    v_add_u32 v223, s42, v223
    v_add_u32 v224, s45, v224
    v_add_u32 v225, s45, v225
    v_add_u32 v226, s44, v226
    v_add_u32 v227, s44, v227
    v_cvt_pk_bf16_f32 v149, v203, v204
    v_fma_f32 v198, v30, s36, v193
    v_exp_f32 v202, v200
    v_add_f32 v197, v197, v201
    v_fma_f32 v199, v31, s36, v193
    v_exp_f32 v203, v198
    v_add_f32 v197, v197, v202
    v_cvt_pk_bf16_f32 v150, v201, v202
    v_exp_f32 v204, v199
    v_add_f32 v197, v197, v203
    v_add_f32 v197, v197, v204
    v_cvt_pk_bf16_f32 v151, v203, v204
    v_mfma_f32_32x32x16_bf16 a[112:127], a[220:223], v[188:191], a[112:127]
    s_sub_u32 s38, s38, 1
    s_cmp_lg_u32 s38, 0
    s_cbranch_scc1 LOOP_A
    ds_read_b128 a[204:207], v215 offset:0
    buffer_load_dwordx4 v[244:247], v250, s[76:79], 0 offen
    buffer_load_dword v248, v251, s[76:79], 0 offen
    buffer_load_dword v249, v251, s[76:79], 0 offen offset:8
    v_fma_f32 v198, v32, s36, v192
    s_waitcnt lgkmcnt(3)
    v_mfma_f32_32x32x16_bf16 v[64:79], a[192:195], a[128:131], 0
    s_add_u32 m0, s48, 0
    s_nop 0
    buffer_load_dwordx4 v228, s[8:11], s37 offen offset:0 lds
    v_fma_f32 v199, v33, s36, v192
    v_exp_f32 v201, v198
    v_fma_f32 v200, v34, s36, v192
    v_mfma_f32_32x32x16_bf16 v[80:95], a[192:195], a[160:163], 0
    ds_read_b128 a[192:195], v216 offset:0
    v_exp_f32 v202, v199
    v_add_f32 v196, v196, v201
    v_fma_f32 v198, v35, s36, v192
    s_waitcnt lgkmcnt(3)
    v_mfma_f32_32x32x16_bf16 v[64:79], a[196:199], a[132:135], v[64:79]
    v_exp_f32 v203, v200
    v_add_f32 v196, v196, v202
    v_cvt_pk_bf16_f32 v136, v201, v202
    v_fma_f32 v199, v36, s36, v192
    v_mfma_f32_32x32x16_bf16 v[80:95], a[196:199], a[164:167], v[80:95]
    ds_read_b128 a[196:199], v217 offset:0
    v_exp_f32 v204, v198
    v_add_f32 v196, v196, v203
    v_fma_f32 v200, v37, s36, v192
    s_waitcnt lgkmcnt(3)
    v_mfma_f32_32x32x16_bf16 v[64:79], a[200:203], a[136:139], v[64:79]
    v_exp_f32 v201, v199
    v_add_f32 v196, v196, v204
    v_cvt_pk_bf16_f32 v137, v203, v204
    v_fma_f32 v198, v38, s36, v192
    v_mfma_f32_32x32x16_bf16 v[80:95], a[200:203], a[168:171], v[80:95]
    ds_read_b128 a[200:203], v218 offset:0
    v_exp_f32 v202, v200
    v_add_f32 v196, v196, v201
    v_fma_f32 v199, v39, s36, v192
    s_waitcnt lgkmcnt(3)
    v_mfma_f32_32x32x16_bf16 v[64:79], a[204:207], a[140:143], v[64:79]
    s_add_u32 m0, s48, 0
    s_nop 0
    buffer_load_dwordx4 v229, s[8:11], s37 offen offset:1024 lds
    v_exp_f32 v203, v198
    v_add_f32 v196, v196, v202
    v_cvt_pk_bf16_f32 v138, v201, v202
    v_mfma_f32_32x32x16_bf16 v[80:95], a[204:207], a[172:175], v[80:95]
    ds_read_b128 a[204:207], v219 offset:0
    v_fma_f32 v200, v40, s36, v192
    v_exp_f32 v204, v199
    v_add_f32 v196, v196, v203
    s_waitcnt lgkmcnt(3)
    v_mfma_f32_32x32x16_bf16 v[64:79], a[192:195], a[144:147], v[64:79]
    v_fma_f32 v198, v41, s36, v192
    v_exp_f32 v201, v200
    v_add_f32 v196, v196, v204
    v_cvt_pk_bf16_f32 v139, v203, v204
    v_fma_f32 v199, v42, s36, v192
    v_mfma_f32_32x32x16_bf16 v[80:95], a[192:195], a[176:179], v[80:95]
    ds_read_b128 a[192:195], v212 offset:8192
    v_exp_f32 v202, v198
    v_add_f32 v196, v196, v201
    v_fma_f32 v200, v43, s36, v192
    s_waitcnt lgkmcnt(3)
    v_mfma_f32_32x32x16_bf16 v[64:79], a[196:199], a[148:151], v[64:79]
    s_add_u32 m0, s48, 0
    s_nop 0
    buffer_load_dwordx4 v230, s[8:11], s37 offen offset:2048 lds
    v_exp_f32 v203, v199
    v_add_f32 v196, v196, v202
    v_cvt_pk_bf16_f32 v140, v201, v202
    v_mfma_f32_32x32x16_bf16 v[80:95], a[196:199], a[180:183], v[80:95]
    ds_read_b128 a[196:199], v213 offset:8192
    v_fma_f32 v198, v44, s36, v192
    v_exp_f32 v204, v200
    v_add_f32 v196, v196, v203
    s_waitcnt lgkmcnt(3)
    v_mfma_f32_32x32x16_bf16 v[64:79], a[200:203], a[152:155], v[64:79]
    v_fma_f32 v199, v45, s36, v192
    v_exp_f32 v201, v198
    v_add_f32 v196, v196, v204
    v_cvt_pk_bf16_f32 v141, v203, v204
    v_fma_f32 v200, v46, s36, v192
    v_mfma_f32_32x32x16_bf16 v[80:95], a[200:203], a[184:187], v[80:95]
    ds_read_b128 a[200:203], v214 offset:8192
    v_exp_f32 v202, v199
    v_add_f32 v196, v196, v201
    v_fma_f32 v198, v47, s36, v192
    s_waitcnt lgkmcnt(3)
    v_mfma_f32_32x32x16_bf16 v[64:79], a[204:207], a[156:159], v[64:79]
    v_exp_f32 v203, v200
    v_add_f32 v196, v196, v202
    v_cvt_pk_bf16_f32 v142, v201, v202
    v_fma_f32 v199, v48, s36, v193
    v_mfma_f32_32x32x16_bf16 v[80:95], a[204:207], a[188:191], v[80:95]
    ds_read_b128 a[204:207], v215 offset:8192
    v_exp_f32 v204, v198
    v_add_f32 v196, v196, v203
    v_fma_f32 v200, v49, s36, v193
    s_waitcnt lgkmcnt(3)
    v_mfma_f32_32x32x16_bf16 v[96:111], a[192:195], a[128:131], 0
    s_add_u32 m0, s48, 0
    s_nop 0
    buffer_load_dwordx4 v231, s[8:11], s37 offen offset:3072 lds
    v_exp_f32 v201, v199
    v_add_f32 v196, v196, v204
    v_cvt_pk_bf16_f32 v143, v203, v204
    v_mfma_f32_32x32x16_bf16 v[112:127], a[192:195], a[160:163], 0
    ds_read_b128 a[192:195], v216 offset:8192
    v_fma_f32 v198, v50, s36, v193
    v_exp_f32 v202, v200
    v_add_f32 v197, v197, v201
    s_waitcnt lgkmcnt(3)
    v_mfma_f32_32x32x16_bf16 v[96:111], a[196:199], a[132:135], v[96:111]
    v_fma_f32 v199, v51, s36, v193
    v_exp_f32 v203, v198
    v_add_f32 v197, v197, v202
    v_cvt_pk_bf16_f32 v152, v201, v202
    v_fma_f32 v200, v52, s36, v193
    v_mfma_f32_32x32x16_bf16 v[112:127], a[196:199], a[164:167], v[112:127]
    ds_read_b128 a[196:199], v217 offset:8192
    v_exp_f32 v204, v199
    v_add_f32 v197, v197, v203
    v_fma_f32 v198, v53, s36, v193
    s_waitcnt lgkmcnt(3)
    v_mfma_f32_32x32x16_bf16 v[96:111], a[200:203], a[136:139], v[96:111]
    v_exp_f32 v201, v200
    v_add_f32 v197, v197, v204
    v_cvt_pk_bf16_f32 v153, v203, v204
    v_fma_f32 v199, v54, s36, v193
    v_mfma_f32_32x32x16_bf16 v[112:127], a[200:203], a[168:171], v[112:127]
    ds_read_b128 a[200:203], v218 offset:8192
    v_exp_f32 v202, v198
    v_add_f32 v197, v197, v201
    v_fma_f32 v200, v55, s36, v193
    s_waitcnt lgkmcnt(3)
    v_mfma_f32_32x32x16_bf16 v[96:111], a[204:207], a[140:143], v[96:111]
    v_exp_f32 v203, v199
    v_add_f32 v197, v197, v202
    v_cvt_pk_bf16_f32 v154, v201, v202
    v_fma_f32 v198, v56, s36, v193
    v_mfma_f32_32x32x16_bf16 v[112:127], a[204:207], a[172:175], v[112:127]
    ds_read_b128 a[204:207], v219 offset:8192
    v_exp_f32 v204, v200
    v_add_f32 v197, v197, v203
    v_fma_f32 v199, v57, s36, v193
    s_waitcnt lgkmcnt(3)
    v_mfma_f32_32x32x16_bf16 v[96:111], a[192:195], a[144:147], v[96:111]
    v_exp_f32 v201, v198
    v_add_f32 v197, v197, v204
    v_cvt_pk_bf16_f32 v155, v203, v204
    v_fma_f32 v200, v58, s36, v193
    v_mfma_f32_32x32x16_bf16 v[112:127], a[192:195], a[176:179], v[112:127]
    v_exp_f32 v202, v199
    v_add_f32 v197, v197, v201
    v_fma_f32 v198, v59, s36, v193
    v_exp_f32 v203, v200
    s_waitcnt lgkmcnt(2)
    v_mfma_f32_32x32x16_bf16 v[96:111], a[196:199], a[148:151], v[96:111]
    v_add_f32 v197, v197, v202
    v_cvt_pk_bf16_f32 v156, v201, v202
    v_fma_f32 v199, v60, s36, v193
    v_exp_f32 v204, v198
    v_add_f32 v197, v197, v203
    v_mfma_f32_32x32x16_bf16 v[112:127], a[196:199], a[180:183], v[112:127]
    ds_read_b64_tr_b16 a[208:209], v220 offset:0
    v_fma_f32 v200, v61, s36, v193
    v_exp_f32 v201, v199
    v_add_f32 v197, v197, v204
    s_waitcnt lgkmcnt(2)
    v_mfma_f32_32x32x16_bf16 v[96:111], a[200:203], a[152:155], v[96:111]
    ds_read_b64_tr_b16 a[210:211], v220 offset:2048
    ds_read_b64_tr_b16 a[212:213], v221 offset:0
    v_cvt_pk_bf16_f32 v157, v203, v204
    v_fma_f32 v198, v62, s36, v193
    v_mfma_f32_32x32x16_bf16 v[112:127], a[200:203], a[184:187], v[112:127]
    ds_read_b64_tr_b16 a[214:215], v221 offset:2048
    ds_read_b64_tr_b16 a[216:217], v222 offset:0
    v_exp_f32 v202, v200
    v_add_f32 v197, v197, v201
    s_waitcnt lgkmcnt(5)
    v_mfma_f32_32x32x16_bf16 v[96:111], a[204:207], a[156:159], v[96:111]
    ds_read_b64_tr_b16 a[218:219], v222 offset:2048
    v_fma_f32 v199, v63, s36, v193
    v_exp_f32 v203, v198
    v_add_f32 v197, v197, v202
    v_cvt_pk_bf16_f32 v158, v201, v202
    v_exp_f32 v204, v199
    v_add_f32 v197, v197, v203
    v_add_f32 v197, v197, v204
    v_cvt_pk_bf16_f32 v159, v203, v204
    v_mfma_f32_32x32x16_bf16 v[112:127], a[204:207], a[188:191], v[112:127]
    v_cmp_lt_f32 vcc, 0x45800000, v196
    v_cmp_lt_f32 s[44:45], s47, v197
    s_or_b64 vcc, vcc, s[44:45]
    s_cbranch_vccnz RARE_X28
    v_add_f32 v194, v194, v196
    v_mov_b32 v196, 0
    v_add_f32 v195, v195, v197
    v_mov_b32 v197, 0
BACK_X28:
    ds_read_b64_tr_b16 a[220:221], v223 offset:0
    v_fma_f32 v198, v64, s36, v192
    v_fma_f32 v199, v65, s36, v192
    v_exp_f32 v201, v198
    v_fma_f32 v200, v66, s36, v192
    s_waitcnt lgkmcnt(5)
    v_mfma_f32_32x32x16_bf16 a[0:15], a[208:211], v[128:131], a[0:15]
    ds_read_b64_tr_b16 a[222:223], v223 offset:2048
    s_add_u32 m0, s48, 16384
    s_nop 0
    buffer_load_dwordx4 v232, s[12:15], s37 offen offset:0 lds
    v_exp_f32 v202, v199
    v_add_f32 v196, v196, v201
    v_fma_f32 v198, v67, s36, v192
    v_mfma_f32_32x32x16_bf16 a[64:79], a[208:211], v[144:147], a[64:79]
    ds_read_b64_tr_b16 a[208:209], v220 offset:4096
    v_exp_f32 v203, v200
    v_add_f32 v196, v196, v202
    v_cvt_pk_bf16_f32 v160, v201, v202
    v_fma_f32 v199, v68, s36, v192
    s_waitcnt lgkmcnt(5)
    v_mfma_f32_32x32x16_bf16 a[16:31], a[212:215], v[128:131], a[16:31]
    ds_read_b64_tr_b16 a[210:211], v220 offset:6144
    v_exp_f32 v204, v198
    v_add_f32 v196, v196, v203
    v_fma_f32 v200, v69, s36, v192
    v_mfma_f32_32x32x16_bf16 a[80:95], a[212:215], v[144:147], a[80:95]
    ds_read_b64_tr_b16 a[212:213], v221 offset:4096
    v_exp_f32 v201, v199
    v_add_f32 v196, v196, v204
    v_cvt_pk_bf16_f32 v161, v203, v204
    v_fma_f32 v198, v70, s36, v192
    s_waitcnt lgkmcnt(5)
    v_mfma_f32_32x32x16_bf16 a[32:47], a[216:219], v[128:131], a[32:47]
    ds_read_b64_tr_b16 a[214:215], v221 offset:6144
    v_exp_f32 v202, v200
    v_add_f32 v196, v196, v201
    v_fma_f32 v199, v71, s36, v192
    v_mfma_f32_32x32x16_bf16 a[96:111], a[216:219], v[144:147], a[96:111]
    ds_read_b64_tr_b16 a[216:217], v222 offset:4096
    s_add_u32 m0, s48, 16384
    s_nop 0
    buffer_load_dwordx4 v232, s[12:15], s37 offen offset:1024 lds
    v_exp_f32 v203, v198
    v_add_f32 v196, v196, v202
    v_cvt_pk_bf16_f32 v162, v201, v202
    s_waitcnt lgkmcnt(5)
    v_mfma_f32_32x32x16_bf16 a[48:63], a[220:223], v[128:131], a[48:63]
    ds_read_b64_tr_b16 a[218:219], v222 offset:6144
    v_fma_f32 v200, v72, s36, v192
    v_exp_f32 v204, v199
    v_add_f32 v196, v196, v203
    v_fma_f32 v198, v73, s36, v192
    v_mfma_f32_32x32x16_bf16 a[112:127], a[220:223], v[144:147], a[112:127]
    ds_read_b64_tr_b16 a[220:221], v223 offset:4096
    v_exp_f32 v201, v200
    v_add_f32 v196, v196, v204
    v_cvt_pk_bf16_f32 v163, v203, v204
    v_fma_f32 v199, v74, s36, v192
    s_waitcnt lgkmcnt(5)
    v_mfma_f32_32x32x16_bf16 a[0:15], a[208:211], v[132:135], a[0:15]
    ds_read_b64_tr_b16 a[222:223], v223 offset:6144
    v_exp_f32 v202, v198
    v_add_f32 v196, v196, v201
    v_fma_f32 v200, v75, s36, v192
    v_mfma_f32_32x32x16_bf16 a[64:79], a[208:211], v[148:151], a[64:79]
    ds_read_b64_tr_b16 a[208:209], v220 offset:8192
    v_exp_f32 v203, v199
    v_add_f32 v196, v196, v202
    v_cvt_pk_bf16_f32 v164, v201, v202
    v_fma_f32 v198, v76, s36, v192
    s_waitcnt lgkmcnt(5)
    v_mfma_f32_32x32x16_bf16 a[16:31], a[212:215], v[132:135], a[16:31]
    ds_read_b64_tr_b16 a[210:211], v220 offset:10240
    s_add_u32 m0, s48, 16384
    s_nop 0
    buffer_load_dwordx4 v232, s[12:15], s37 offen offset:2048 lds
    v_exp_f32 v204, v200
    v_add_f32 v196, v196, v203
    v_fma_f32 v199, v77, s36, v192
    v_mfma_f32_32x32x16_bf16 a[80:95], a[212:215], v[148:151], a[80:95]
    ds_read_b64_tr_b16 a[212:213], v221 offset:8192
    v_exp_f32 v201, v198
    v_add_f32 v196, v196, v204
    v_cvt_pk_bf16_f32 v165, v203, v204
    v_fma_f32 v200, v78, s36, v192
    s_waitcnt lgkmcnt(5)
    v_mfma_f32_32x32x16_bf16 a[32:47], a[216:219], v[132:135], a[32:47]
    ds_read_b64_tr_b16 a[214:215], v221 offset:10240
    v_exp_f32 v202, v199
    v_add_f32 v196, v196, v201
    v_fma_f32 v198, v79, s36, v192
    v_mfma_f32_32x32x16_bf16 a[96:111], a[216:219], v[148:151], a[96:111]
    ds_read_b64_tr_b16 a[216:217], v222 offset:8192
    v_exp_f32 v203, v200
    v_add_f32 v196, v196, v202
    v_cvt_pk_bf16_f32 v166, v201, v202
    v_fma_f32 v199, v80, s36, v193
    s_waitcnt lgkmcnt(5)
    v_mfma_f32_32x32x16_bf16 a[48:63], a[220:223], v[132:135], a[48:63]
    ds_read_b64_tr_b16 a[218:219], v222 offset:10240
    v_exp_f32 v204, v198
    v_add_f32 v196, v196, v203
    v_fma_f32 v200, v81, s36, v193
    v_mfma_f32_32x32x16_bf16 a[112:127], a[220:223], v[148:151], a[112:127]
    ds_read_b64_tr_b16 a[220:221], v223 offset:8192
    s_add_u32 m0, s48, 16384
    s_nop 0
    buffer_load_dwordx4 v232, s[12:15], s37 offen offset:3072 lds
    v_exp_f32 v201, v199
    v_add_f32 v196, v196, v204
    v_cvt_pk_bf16_f32 v167, v203, v204
    s_waitcnt lgkmcnt(5)
    v_mfma_f32_32x32x16_bf16 a[0:15], a[208:211], v[136:139], a[0:15]
    ds_read_b64_tr_b16 a[222:223], v223 offset:10240
    v_fma_f32 v198, v82, s36, v193
    v_exp_f32 v202, v200
    v_add_f32 v197, v197, v201
    v_fma_f32 v199, v83, s36, v193
    v_mfma_f32_32x32x16_bf16 a[64:79], a[208:211], v[152:155], a[64:79]
    ds_read_b64_tr_b16 a[208:209], v220 offset:12288
    v_exp_f32 v203, v198
    v_add_f32 v197, v197, v202
    v_cvt_pk_bf16_f32 v176, v201, v202
    v_fma_f32 v200, v84, s36, v193
    s_waitcnt lgkmcnt(5)
    v_mfma_f32_32x32x16_bf16 a[16:31], a[212:215], v[136:139], a[16:31]
    ds_read_b64_tr_b16 a[210:211], v220 offset:14336
    v_exp_f32 v204, v199
    v_add_f32 v197, v197, v203
    v_fma_f32 v198, v85, s36, v193
    v_mfma_f32_32x32x16_bf16 a[80:95], a[212:215], v[152:155], a[80:95]
    ds_read_b64_tr_b16 a[212:213], v221 offset:12288
    v_exp_f32 v201, v200
    v_add_f32 v197, v197, v204
    v_cvt_pk_bf16_f32 v177, v203, v204
    v_fma_f32 v199, v86, s36, v193
    s_waitcnt lgkmcnt(5)
    v_mfma_f32_32x32x16_bf16 a[32:47], a[216:219], v[136:139], a[32:47]
    ds_read_b64_tr_b16 a[214:215], v221 offset:14336
    v_exp_f32 v202, v198
    v_add_f32 v197, v197, v201
    v_fma_f32 v200, v87, s36, v193
    v_mfma_f32_32x32x16_bf16 a[96:111], a[216:219], v[152:155], a[96:111]
    ds_read_b64_tr_b16 a[216:217], v222 offset:12288
    v_exp_f32 v203, v199
    v_add_f32 v197, v197, v202
    v_cvt_pk_bf16_f32 v178, v201, v202
    v_fma_f32 v198, v88, s36, v193
    s_waitcnt lgkmcnt(5)
    v_mfma_f32_32x32x16_bf16 a[48:63], a[220:223], v[136:139], a[48:63]
    ds_read_b64_tr_b16 a[218:219], v222 offset:14336
    v_exp_f32 v204, v200
    v_add_f32 v197, v197, v203
    v_fma_f32 v199, v89, s36, v193
    v_mfma_f32_32x32x16_bf16 a[112:127], a[220:223], v[152:155], a[112:127]
    ds_read_b64_tr_b16 a[220:221], v223 offset:12288
    s_waitcnt vmcnt(10)
    v_and_b32 v252, 0x7ff, v244
    v_lshl_add_u32 v228, v252, 8, v236
    v_lshl_add_u32 v232, v252, 8, v240
    v_and_b32 v252, 0x7ff, v245
    v_lshl_add_u32 v229, v252, 8, v237
    v_lshl_add_u32 v233, v252, 8, v240
    v_and_b32 v252, 0x7ff, v246
    v_lshl_add_u32 v230, v252, 8, v238
    v_lshl_add_u32 v234, v252, 8, v240
    v_and_b32 v252, 0x7ff, v247
    v_lshl_add_u32 v231, v252, 8, v239
    v_lshl_add_u32 v235, v252, 8, v240
    s_waitcnt lgkmcnt(5)
    v_mfma_f32_32x32x16_bf16 a[0:15], a[208:211], v[140:143], a[0:15]
    ds_read_b64_tr_b16 a[222:223], v223 offset:14336
    v_exp_f32 v201, v198
    v_add_f32 v197, v197, v204
    v_cvt_pk_bf16_f32 v179, v203, v204
    v_fma_f32 v200, v90, s36, v193
    v_mfma_f32_32x32x16_bf16 a[64:79], a[208:211], v[156:159], a[64:79]
    s_waitcnt vmcnt(9)
    v_lshl_add_u32 v241, v248, 12, v243
    s_waitcnt vmcnt(8)
    v_lshl_add_u32 v242, v249, 12, v243
    v_add_u32 v250, 0x100, v250
    v_add_u32 v251, 0x100, v251
    v_exp_f32 v202, v199
    v_add_f32 v197, v197, v201
    s_waitcnt lgkmcnt(4)
    v_mfma_f32_32x32x16_bf16 a[16:31], a[212:215], v[140:143], a[16:31]
    s_add_u32 s37, s37, 16384
    v_fma_f32 v198, v91, s36, v193
    v_exp_f32 v203, v200
    v_add_f32 v197, v197, v202
    v_cvt_pk_bf16_f32 v180, v201, v202
    v_fma_f32 v199, v92, s36, v193
    v_mfma_f32_32x32x16_bf16 a[80:95], a[212:215], v[156:159], a[80:95]
    s_waitcnt lgkmcnt(0)
    s_barrier
    s_mov_b32 s42, s41
    s_add_u32 s46, s40, 0x8000
    s_and_b32 s46, s46, 0x1ffff
    s_sub_u32 s41, s46, s40
    s_mov_b32 s40, s46
    s_add_u32 s43, s43, 0x8000
    s_and_b32 s43, s43, 0x1ffff
    s_add_u32 s48, s43, s53
    s_lshr_b32 s46, s43, 2
    s_add_u32 s46, s46, s54
    s_add_u32 s49, s46, 0x20000
    s_ashr_i32 s44, s41, 2
    s_ashr_i32 s45, s42, 2
    v_add_u32 v212, s41, v212
    v_add_u32 v213, s41, v213
    v_add_u32 v214, s41, v214
    v_mfma_f32_32x32x16_bf16 a[32:47], a[216:219], v[140:143], a[32:47]
    ds_read_b128 a[192:195], v212 offset:0
    ds_read_b128 a[196:199], v213 offset:0
    v_add_u32 v215, s41, v215
    v_add_u32 v216, s41, v216
    v_add_u32 v217, s41, v217
    v_mfma_f32_32x32x16_bf16 a[96:111], a[216:219], v[156:159], a[96:111]
    ds_read_b128 a[200:203], v214 offset:0
    v_add_u32 v218, s41, v218
    v_add_u32 v219, s41, v219
    v_add_u32 v220, s42, v220
    v_add_u32 v221, s42, v221
    v_mfma_f32_32x32x16_bf16 a[48:63], a[220:223], v[140:143], a[48:63]
    v_add_u32 v222, s42, v222
    v_add_u32 v223, s42, v223
    v_add_u32 v224, s45, v224
    v_add_u32 v225, s45, v225
    v_add_u32 v226, s44, v226
    v_add_u32 v227, s44, v227
    v_exp_f32 v204, v198
    v_add_f32 v197, v197, v203
    v_fma_f32 v200, v93, s36, v193
    v_exp_f32 v201, v199
    v_add_f32 v197, v197, v204
    v_cvt_pk_bf16_f32 v181, v203, v204
    v_fma_f32 v198, v94, s36, v193
    v_exp_f32 v202, v200
    v_add_f32 v197, v197, v201
    v_fma_f32 v199, v95, s36, v193
    v_exp_f32 v203, v198
    v_add_f32 v197, v197, v202
    v_cvt_pk_bf16_f32 v182, v201, v202
    v_exp_f32 v204, v199
    v_add_f32 v197, v197, v203
    v_add_f32 v197, v197, v204
    v_cvt_pk_bf16_f32 v183, v203, v204
    v_mfma_f32_32x32x16_bf16 a[112:127], a[220:223], v[156:159], a[112:127]
    ds_read_b128 a[204:207], v215 offset:0
    buffer_load_dwordx4 v[244:247], v250, s[76:79], 0 offen
    buffer_load_dword v248, v251, s[76:79], 0 offen
    buffer_load_dword v249, v251, s[76:79], 0 offen offset:8
    v_fma_f32 v198, v96, s36, v192
    s_waitcnt lgkmcnt(3)
    v_mfma_f32_32x32x16_bf16 v[0:15], a[192:195], a[128:131], 0
    s_add_u32 m0, s48, 0
    s_nop 0
    buffer_load_dwordx4 v228, s[16:19], 0 offen lds
    v_fma_f32 v199, v97, s36, v192
    v_exp_f32 v201, v198
    v_fma_f32 v200, v98, s36, v192
    v_mfma_f32_32x32x16_bf16 v[16:31], a[192:195], a[160:163], 0
    ds_read_b128 a[192:195], v216 offset:0
    v_exp_f32 v202, v199
    v_add_f32 v196, v196, v201
    v_fma_f32 v198, v99, s36, v192
    s_waitcnt lgkmcnt(3)
    v_mfma_f32_32x32x16_bf16 v[0:15], a[196:199], a[132:135], v[0:15]
    v_exp_f32 v203, v200
    v_add_f32 v196, v196, v202
    v_cvt_pk_bf16_f32 v168, v201, v202
    v_fma_f32 v199, v100, s36, v192
    v_mfma_f32_32x32x16_bf16 v[16:31], a[196:199], a[164:167], v[16:31]
    ds_read_b128 a[196:199], v217 offset:0
    v_exp_f32 v204, v198
    v_add_f32 v196, v196, v203
    v_fma_f32 v200, v101, s36, v192
    s_waitcnt lgkmcnt(3)
    v_mfma_f32_32x32x16_bf16 v[0:15], a[200:203], a[136:139], v[0:15]
    v_exp_f32 v201, v199
    v_add_f32 v196, v196, v204
    v_cvt_pk_bf16_f32 v169, v203, v204
    v_fma_f32 v198, v102, s36, v192
    v_mfma_f32_32x32x16_bf16 v[16:31], a[200:203], a[168:171], v[16:31]
    ds_read_b128 a[200:203], v218 offset:0
    v_exp_f32 v202, v200
    v_add_f32 v196, v196, v201
    v_fma_f32 v199, v103, s36, v192
    s_waitcnt lgkmcnt(3)
    v_mfma_f32_32x32x16_bf16 v[0:15], a[204:207], a[140:143], v[0:15]
    s_add_u32 m0, s48, 1024
    s_nop 0
    buffer_load_dwordx4 v229, s[16:19], 0 offen lds
    v_exp_f32 v203, v198
    v_add_f32 v196, v196, v202
    v_cvt_pk_bf16_f32 v170, v201, v202
    v_mfma_f32_32x32x16_bf16 v[16:31], a[204:207], a[172:175], v[16:31]
    ds_read_b128 a[204:207], v219 offset:0
    v_fma_f32 v200, v104, s36, v192
    v_exp_f32 v204, v199
    v_add_f32 v196, v196, v203
    s_waitcnt lgkmcnt(3)
    v_mfma_f32_32x32x16_bf16 v[0:15], a[192:195], a[144:147], v[0:15]
    v_fma_f32 v198, v105, s36, v192
    v_exp_f32 v201, v200
    v_add_f32 v196, v196, v204
    v_cvt_pk_bf16_f32 v171, v203, v204
    v_fma_f32 v199, v106, s36, v192
    v_mfma_f32_32x32x16_bf16 v[16:31], a[192:195], a[176:179], v[16:31]
    ds_read_b128 a[192:195], v212 offset:8192
    v_exp_f32 v202, v198
    v_add_f32 v196, v196, v201
    v_fma_f32 v200, v107, s36, v192
    s_waitcnt lgkmcnt(3)
    v_mfma_f32_32x32x16_bf16 v[0:15], a[196:199], a[148:151], v[0:15]
    s_add_u32 m0, s48, 2048
    s_nop 0
    buffer_load_dwordx4 v230, s[16:19], 0 offen lds
    v_exp_f32 v203, v199
    v_add_f32 v196, v196, v202
    v_cvt_pk_bf16_f32 v172, v201, v202
    v_mfma_f32_32x32x16_bf16 v[16:31], a[196:199], a[180:183], v[16:31]
    ds_read_b128 a[196:199], v213 offset:8192
    v_fma_f32 v198, v108, s36, v192
    v_exp_f32 v204, v200
    v_add_f32 v196, v196, v203
    s_waitcnt lgkmcnt(3)
    v_mfma_f32_32x32x16_bf16 v[0:15], a[200:203], a[152:155], v[0:15]
    v_fma_f32 v199, v109, s36, v192
    v_exp_f32 v201, v198
    v_add_f32 v196, v196, v204
    v_cvt_pk_bf16_f32 v173, v203, v204
    v_fma_f32 v200, v110, s36, v192
    v_mfma_f32_32x32x16_bf16 v[16:31], a[200:203], a[184:187], v[16:31]
    ds_read_b128 a[200:203], v214 offset:8192
    v_exp_f32 v202, v199
    v_add_f32 v196, v196, v201
    v_fma_f32 v198, v111, s36, v192
    s_waitcnt lgkmcnt(3)
    v_mfma_f32_32x32x16_bf16 v[0:15], a[204:207], a[156:159], v[0:15]
    v_exp_f32 v203, v200
    v_add_f32 v196, v196, v202
    v_cvt_pk_bf16_f32 v174, v201, v202
    v_fma_f32 v199, v112, s36, v193
    v_mfma_f32_32x32x16_bf16 v[16:31], a[204:207], a[188:191], v[16:31]
    ds_read_b128 a[204:207], v215 offset:8192
    v_exp_f32 v204, v198
    v_add_f32 v196, v196, v203
    v_fma_f32 v200, v113, s36, v193
    s_waitcnt lgkmcnt(3)
    v_mfma_f32_32x32x16_bf16 v[32:47], a[192:195], a[128:131], 0
    s_add_u32 m0, s48, 3072
    s_nop 0
    buffer_load_dwordx4 v231, s[16:19], 0 offen lds
    v_exp_f32 v201, v199
    v_add_f32 v196, v196, v204
    v_cvt_pk_bf16_f32 v175, v203, v204
    v_mfma_f32_32x32x16_bf16 v[48:63], a[192:195], a[160:163], 0
    ds_read_b128 a[192:195], v216 offset:8192
    v_fma_f32 v198, v114, s36, v193
    v_exp_f32 v202, v200
    v_add_f32 v197, v197, v201
    s_waitcnt lgkmcnt(3)
    v_mfma_f32_32x32x16_bf16 v[32:47], a[196:199], a[132:135], v[32:47]
    v_fma_f32 v199, v115, s36, v193
    v_exp_f32 v203, v198
    v_add_f32 v197, v197, v202
    v_cvt_pk_bf16_f32 v184, v201, v202
    v_fma_f32 v200, v116, s36, v193
    v_mfma_f32_32x32x16_bf16 v[48:63], a[196:199], a[164:167], v[48:63]
    ds_read_b128 a[196:199], v217 offset:8192
    v_exp_f32 v204, v199
    v_add_f32 v197, v197, v203
    v_fma_f32 v198, v117, s36, v193
    s_waitcnt lgkmcnt(3)
    v_mfma_f32_32x32x16_bf16 v[32:47], a[200:203], a[136:139], v[32:47]
    s_add_u32 m0, s48, 16384
    s_nop 0
    buffer_load_dwordx4 v232, s[20:23], 0 offen lds
    v_exp_f32 v201, v200
    v_add_f32 v197, v197, v204
    v_cvt_pk_bf16_f32 v185, v203, v204
    v_mfma_f32_32x32x16_bf16 v[48:63], a[200:203], a[168:171], v[48:63]
    ds_read_b128 a[200:203], v218 offset:8192
    v_fma_f32 v199, v118, s36, v193
    v_exp_f32 v202, v198
    v_add_f32 v197, v197, v201
    s_waitcnt lgkmcnt(3)
    v_mfma_f32_32x32x16_bf16 v[32:47], a[204:207], a[140:143], v[32:47]
    v_fma_f32 v200, v119, s36, v193
    v_exp_f32 v203, v199
    v_add_f32 v197, v197, v202
    v_cvt_pk_bf16_f32 v186, v201, v202
    v_fma_f32 v198, v120, s36, v193
    v_mfma_f32_32x32x16_bf16 v[48:63], a[204:207], a[172:175], v[48:63]
    ds_read_b128 a[204:207], v219 offset:8192
    v_exp_f32 v204, v200
    v_add_f32 v197, v197, v203
    v_fma_f32 v199, v121, s36, v193
    s_waitcnt lgkmcnt(3)
    v_mfma_f32_32x32x16_bf16 v[32:47], a[192:195], a[144:147], v[32:47]
    v_exp_f32 v201, v198
    v_add_f32 v197, v197, v204
    v_cvt_pk_bf16_f32 v187, v203, v204
    v_fma_f32 v200, v122, s36, v193
    v_mfma_f32_32x32x16_bf16 v[48:63], a[192:195], a[176:179], v[48:63]
    v_exp_f32 v202, v199
    v_add_f32 v197, v197, v201
    v_fma_f32 v198, v123, s36, v193
    v_exp_f32 v203, v200
    s_waitcnt lgkmcnt(2)
    v_mfma_f32_32x32x16_bf16 v[32:47], a[196:199], a[148:151], v[32:47]
    v_add_f32 v197, v197, v202
    v_cvt_pk_bf16_f32 v188, v201, v202
    v_fma_f32 v199, v124, s36, v193
    v_exp_f32 v204, v198
    v_add_f32 v197, v197, v203
    v_mfma_f32_32x32x16_bf16 v[48:63], a[196:199], a[180:183], v[48:63]
    ds_read_b64_tr_b16 a[208:209], v220 offset:0
    v_fma_f32 v200, v125, s36, v193
    v_exp_f32 v201, v199
    v_add_f32 v197, v197, v204
    s_waitcnt lgkmcnt(2)
    v_mfma_f32_32x32x16_bf16 v[32:47], a[200:203], a[152:155], v[32:47]
    ds_read_b64_tr_b16 a[210:211], v220 offset:2048
    ds_read_b64_tr_b16 a[212:213], v221 offset:0
    v_cvt_pk_bf16_f32 v189, v203, v204
    v_fma_f32 v198, v126, s36, v193
    v_mfma_f32_32x32x16_bf16 v[48:63], a[200:203], a[184:187], v[48:63]
    ds_read_b64_tr_b16 a[214:215], v221 offset:2048
    ds_read_b64_tr_b16 a[216:217], v222 offset:0
    v_exp_f32 v202, v200
    v_add_f32 v197, v197, v201
    s_waitcnt lgkmcnt(5)
    v_mfma_f32_32x32x16_bf16 v[32:47], a[204:207], a[156:159], v[32:47]
    ds_read_b64_tr_b16 a[218:219], v222 offset:2048
    v_fma_f32 v199, v127, s36, v193
    v_exp_f32 v203, v198
    v_add_f32 v197, v197, v202
    v_cvt_pk_bf16_f32 v190, v201, v202
    v_exp_f32 v204, v199
    v_add_f32 v197, v197, v203
    v_add_f32 v197, v197, v204
    v_cvt_pk_bf16_f32 v191, v203, v204
    v_mfma_f32_32x32x16_bf16 v[48:63], a[204:207], a[188:191], v[48:63]
    v_cmp_lt_f32 vcc, 0x45800000, v196
    v_cmp_lt_f32 s[44:45], s47, v197
    s_or_b64 vcc, vcc, s[44:45]
    s_cbranch_vccnz RARE_X29
    v_add_f32 v194, v194, v196
    v_mov_b32 v196, 0
    v_add_f32 v195, v195, v197
    v_mov_b32 v197, 0
BACK_X29:
    ds_read_b64_tr_b16 a[220:221], v223 offset:0
    v_fma_f32 v198, v0, s36, v192
    v_fma_f32 v199, v1, s36, v192
    v_exp_f32 v201, v198
    v_fma_f32 v200, v2, s36, v192
    s_waitcnt lgkmcnt(5)
    v_mfma_f32_32x32x16_bf16 a[0:15], a[208:211], v[160:163], a[0:15]
    ds_read_b64_tr_b16 a[222:223], v223 offset:2048
    s_add_u32 m0, s48, 17408
    s_nop 0
    buffer_load_dwordx4 v233, s[20:23], 0 offen lds
    v_exp_f32 v202, v199
    v_add_f32 v196, v196, v201
    v_fma_f32 v198, v3, s36, v192
    v_mfma_f32_32x32x16_bf16 a[64:79], a[208:211], v[176:179], a[64:79]
    ds_read_b64_tr_b16 a[208:209], v220 offset:4096
    v_exp_f32 v203, v200
    v_add_f32 v196, v196, v202
    v_cvt_pk_bf16_f32 v128, v201, v202
    v_fma_f32 v199, v4, s36, v192
    s_waitcnt lgkmcnt(5)
    v_mfma_f32_32x32x16_bf16 a[16:31], a[212:215], v[160:163], a[16:31]
    ds_read_b64_tr_b16 a[210:211], v220 offset:6144
    v_exp_f32 v204, v198
    v_add_f32 v196, v196, v203
    v_fma_f32 v200, v5, s36, v192
    v_mfma_f32_32x32x16_bf16 a[80:95], a[212:215], v[176:179], a[80:95]
    ds_read_b64_tr_b16 a[212:213], v221 offset:4096
    v_exp_f32 v201, v199
    v_add_f32 v196, v196, v204
    v_cvt_pk_bf16_f32 v129, v203, v204
    v_fma_f32 v198, v6, s36, v192
    s_waitcnt lgkmcnt(5)
    v_mfma_f32_32x32x16_bf16 a[32:47], a[216:219], v[160:163], a[32:47]
    ds_read_b64_tr_b16 a[214:215], v221 offset:6144
    v_exp_f32 v202, v200
    v_add_f32 v196, v196, v201
    v_fma_f32 v199, v7, s36, v192
    v_mfma_f32_32x32x16_bf16 a[96:111], a[216:219], v[176:179], a[96:111]
    ds_read_b64_tr_b16 a[216:217], v222 offset:4096
    s_add_u32 m0, s48, 18432
    s_nop 0
    buffer_load_dwordx4 v234, s[20:23], 0 offen lds
    v_exp_f32 v203, v198
    v_add_f32 v196, v196, v202
    v_cvt_pk_bf16_f32 v130, v201, v202
    s_waitcnt lgkmcnt(5)
    v_mfma_f32_32x32x16_bf16 a[48:63], a[220:223], v[160:163], a[48:63]
    ds_read_b64_tr_b16 a[218:219], v222 offset:6144
    v_fma_f32 v200, v8, s36, v192
    v_exp_f32 v204, v199
    v_add_f32 v196, v196, v203
    v_fma_f32 v198, v9, s36, v192
    v_mfma_f32_32x32x16_bf16 a[112:127], a[220:223], v[176:179], a[112:127]
    ds_read_b64_tr_b16 a[220:221], v223 offset:4096
    v_exp_f32 v201, v200
    v_add_f32 v196, v196, v204
    v_cvt_pk_bf16_f32 v131, v203, v204
    v_fma_f32 v199, v10, s36, v192
    s_waitcnt lgkmcnt(5)
    v_mfma_f32_32x32x16_bf16 a[0:15], a[208:211], v[164:167], a[0:15]
    ds_read_b64_tr_b16 a[222:223], v223 offset:6144
    v_exp_f32 v202, v198
    v_add_f32 v196, v196, v201
    v_fma_f32 v200, v11, s36, v192
    v_mfma_f32_32x32x16_bf16 a[64:79], a[208:211], v[180:183], a[64:79]
    ds_read_b64_tr_b16 a[208:209], v220 offset:8192
    v_exp_f32 v203, v199
    v_add_f32 v196, v196, v202
    v_cvt_pk_bf16_f32 v132, v201, v202
    v_fma_f32 v198, v12, s36, v192
    s_waitcnt lgkmcnt(5)
    v_mfma_f32_32x32x16_bf16 a[16:31], a[212:215], v[164:167], a[16:31]
    ds_read_b64_tr_b16 a[210:211], v220 offset:10240
    s_add_u32 m0, s48, 19456
    s_nop 0
    buffer_load_dwordx4 v235, s[20:23], 0 offen lds
    v_exp_f32 v204, v200
    v_add_f32 v196, v196, v203
    v_fma_f32 v199, v13, s36, v192
    v_mfma_f32_32x32x16_bf16 a[80:95], a[212:215], v[180:183], a[80:95]
    ds_read_b64_tr_b16 a[212:213], v221 offset:8192
    v_exp_f32 v201, v198
    v_add_f32 v196, v196, v204
    v_cvt_pk_bf16_f32 v133, v203, v204
    v_fma_f32 v200, v14, s36, v192
    s_waitcnt lgkmcnt(5)
    v_mfma_f32_32x32x16_bf16 a[32:47], a[216:219], v[164:167], a[32:47]
    ds_read_b64_tr_b16 a[214:215], v221 offset:10240
    v_exp_f32 v202, v199
    v_add_f32 v196, v196, v201
    v_fma_f32 v198, v15, s36, v192
    v_mfma_f32_32x32x16_bf16 a[96:111], a[216:219], v[180:183], a[96:111]
    ds_read_b64_tr_b16 a[216:217], v222 offset:8192
    v_exp_f32 v203, v200
    v_add_f32 v196, v196, v202
    v_cvt_pk_bf16_f32 v134, v201, v202
    v_fma_f32 v199, v16, s36, v193
    s_waitcnt lgkmcnt(5)
    v_mfma_f32_32x32x16_bf16 a[48:63], a[220:223], v[164:167], a[48:63]
    ds_read_b64_tr_b16 a[218:219], v222 offset:10240
    v_exp_f32 v204, v198
    v_add_f32 v196, v196, v203
    v_fma_f32 v200, v17, s36, v193
    v_mfma_f32_32x32x16_bf16 a[112:127], a[220:223], v[180:183], a[112:127]
    ds_read_b64_tr_b16 a[220:221], v223 offset:8192
    s_add_u32 m0, s49, 0
    s_nop 0
    buffer_load_dwordx4 v241, s[24:27], 0 offen lds
    v_exp_f32 v201, v199
    v_add_f32 v196, v196, v204
    v_cvt_pk_bf16_f32 v135, v203, v204
    s_waitcnt lgkmcnt(5)
    v_mfma_f32_32x32x16_bf16 a[0:15], a[208:211], v[168:171], a[0:15]
    ds_read_b64_tr_b16 a[222:223], v223 offset:10240
    v_fma_f32 v198, v18, s36, v193
    v_exp_f32 v202, v200
    v_add_f32 v197, v197, v201
    v_fma_f32 v199, v19, s36, v193
    v_mfma_f32_32x32x16_bf16 a[64:79], a[208:211], v[184:187], a[64:79]
    ds_read_b64_tr_b16 a[208:209], v220 offset:12288
    v_exp_f32 v203, v198
    v_add_f32 v197, v197, v202
    v_cvt_pk_bf16_f32 v144, v201, v202
    v_fma_f32 v200, v20, s36, v193
    s_waitcnt lgkmcnt(5)
    v_mfma_f32_32x32x16_bf16 a[16:31], a[212:215], v[168:171], a[16:31]
    ds_read_b64_tr_b16 a[210:211], v220 offset:14336
    v_exp_f32 v204, v199
    v_add_f32 v197, v197, v203
    v_fma_f32 v198, v21, s36, v193
    v_mfma_f32_32x32x16_bf16 a[80:95], a[212:215], v[184:187], a[80:95]
    ds_read_b64_tr_b16 a[212:213], v221 offset:12288
    v_exp_f32 v201, v200
    v_add_f32 v197, v197, v204
    v_cvt_pk_bf16_f32 v145, v203, v204
    v_fma_f32 v199, v22, s36, v193
    s_waitcnt lgkmcnt(5)
    v_mfma_f32_32x32x16_bf16 a[32:47], a[216:219], v[168:171], a[32:47]
    ds_read_b64_tr_b16 a[214:215], v221 offset:14336
    s_add_u32 m0, s49, 1024
    s_nop 0
    buffer_load_dwordx4 v242, s[24:27], 0 offen lds
    v_exp_f32 v202, v198
    v_add_f32 v197, v197, v201
    v_fma_f32 v200, v23, s36, v193
    v_mfma_f32_32x32x16_bf16 a[96:111], a[216:219], v[184:187], a[96:111]
    ds_read_b64_tr_b16 a[216:217], v222 offset:12288
    v_exp_f32 v203, v199
    v_add_f32 v197, v197, v202
    v_cvt_pk_bf16_f32 v146, v201, v202
    v_fma_f32 v198, v24, s36, v193
    s_waitcnt lgkmcnt(5)
    v_mfma_f32_32x32x16_bf16 a[48:63], a[220:223], v[168:171], a[48:63]
    ds_read_b64_tr_b16 a[218:219], v222 offset:14336
    v_exp_f32 v204, v200
    v_add_f32 v197, v197, v203
    v_fma_f32 v199, v25, s36, v193
    v_mfma_f32_32x32x16_bf16 a[112:127], a[220:223], v[184:187], a[112:127]
    ds_read_b64_tr_b16 a[220:221], v223 offset:12288
    s_waitcnt vmcnt(12)
    v_and_b32 v252, 0x7ff, v244
    v_lshl_add_u32 v228, v252, 8, v236
    v_lshl_add_u32 v232, v252, 8, v240
    v_and_b32 v252, 0x7ff, v245
    v_lshl_add_u32 v229, v252, 8, v237
    v_lshl_add_u32 v233, v252, 8, v240
    v_and_b32 v252, 0x7ff, v246
    v_lshl_add_u32 v230, v252, 8, v238
    v_lshl_add_u32 v234, v252, 8, v240
    v_and_b32 v252, 0x7ff, v247
    v_lshl_add_u32 v231, v252, 8, v239
    v_lshl_add_u32 v235, v252, 8, v240
    s_waitcnt lgkmcnt(5)
    v_mfma_f32_32x32x16_bf16 a[0:15], a[208:211], v[172:175], a[0:15]
    ds_read_b64_tr_b16 a[222:223], v223 offset:14336
    v_exp_f32 v201, v198
    v_add_f32 v197, v197, v204
    v_cvt_pk_bf16_f32 v147, v203, v204
    v_fma_f32 v200, v26, s36, v193
    v_mfma_f32_32x32x16_bf16 a[64:79], a[208:211], v[188:191], a[64:79]
    s_waitcnt vmcnt(11)
    v_lshl_add_u32 v241, v248, 12, v243
    s_waitcnt vmcnt(10)
    v_lshl_add_u32 v242, v249, 12, v243
    v_add_u32 v250, 0x100, v250
    v_add_u32 v251, 0x100, v251
    v_exp_f32 v202, v199
    v_add_f32 v197, v197, v201
    s_waitcnt lgkmcnt(4)
    v_mfma_f32_32x32x16_bf16 a[16:31], a[212:215], v[172:175], a[16:31]
    v_fma_f32 v198, v27, s36, v193
    v_exp_f32 v203, v200
    v_add_f32 v197, v197, v202
    v_cvt_pk_bf16_f32 v148, v201, v202
    v_fma_f32 v199, v28, s36, v193
    v_mfma_f32_32x32x16_bf16 a[80:95], a[212:215], v[188:191], a[80:95]
    s_waitcnt lgkmcnt(0)
    s_barrier
    s_mov_b32 s42, s41
    s_add_u32 s46, s40, 0x8000
    s_and_b32 s46, s46, 0x1ffff
    s_sub_u32 s41, s46, s40
    s_mov_b32 s40, s46
    s_add_u32 s43, s43, 0x8000
    s_and_b32 s43, s43, 0x1ffff
    s_add_u32 s48, s43, s53
    s_lshr_b32 s46, s43, 2
    s_add_u32 s46, s46, s54
    s_add_u32 s49, s46, 0x20000
    s_ashr_i32 s44, s41, 2
    s_ashr_i32 s45, s42, 2
    v_add_u32 v212, s41, v212
    v_add_u32 v213, s41, v213
    v_add_u32 v214, s41, v214
    v_mfma_f32_32x32x16_bf16 a[32:47], a[216:219], v[172:175], a[32:47]
    ds_read_b128 a[192:195], v212 offset:0
    ds_read_b128 a[196:199], v213 offset:0
    v_add_u32 v215, s41, v215
    v_add_u32 v216, s41, v216
    v_add_u32 v217, s41, v217
    v_mfma_f32_32x32x16_bf16 a[96:111], a[216:219], v[188:191], a[96:111]
    ds_read_b128 a[200:203], v214 offset:0
    v_add_u32 v218, s41, v218
    v_add_u32 v219, s41, v219
    v_add_u32 v220, s42, v220
    v_add_u32 v221, s42, v221
    v_mfma_f32_32x32x16_bf16 a[48:63], a[220:223], v[172:175], a[48:63]
    v_add_u32 v222, s42, v222
    v_add_u32 v223, s42, v223
    v_add_u32 v224, s45, v224
    v_add_u32 v225, s45, v225
    v_add_u32 v226, s44, v226
    v_add_u32 v227, s44, v227
    v_exp_f32 v204, v198
    v_add_f32 v197, v197, v203
    v_fma_f32 v200, v29, s36, v193
    v_exp_f32 v201, v199
    v_add_f32 v197, v197, v204
    v_cvt_pk_bf16_f32 v149, v203, v204
    v_fma_f32 v198, v30, s36, v193
    v_exp_f32 v202, v200
    v_add_f32 v197, v197, v201
    v_fma_f32 v199, v31, s36, v193
    v_exp_f32 v203, v198
    v_add_f32 v197, v197, v202
    v_cvt_pk_bf16_f32 v150, v201, v202
    v_exp_f32 v204, v199
    v_add_f32 v197, v197, v203
    v_add_f32 v197, v197, v204
    v_cvt_pk_bf16_f32 v151, v203, v204
    v_mfma_f32_32x32x16_bf16 a[112:127], a[220:223], v[188:191], a[112:127]
    ds_read_b128 a[204:207], v215 offset:0
    buffer_load_dwordx4 v[244:247], v250, s[76:79], 0 offen
    buffer_load_dword v248, v251, s[76:79], 0 offen
    buffer_load_dword v249, v251, s[76:79], 0 offen offset:8
    v_fma_f32 v198, v32, s36, v192
    s_waitcnt lgkmcnt(3)
    v_mfma_f32_32x32x16_bf16 v[64:79], a[192:195], a[128:131], 0
    s_add_u32 m0, s48, 0
    s_nop 0
    buffer_load_dwordx4 v228, s[16:19], 0 offen lds
    v_fma_f32 v199, v33, s36, v192
    v_exp_f32 v201, v198
    v_fma_f32 v200, v34, s36, v192
    v_mfma_f32_32x32x16_bf16 v[80:95], a[192:195], a[160:163], 0
    ds_read_b128 a[192:195], v216 offset:0
    v_exp_f32 v202, v199
    v_add_f32 v196, v196, v201
    v_fma_f32 v198, v35, s36, v192
    s_waitcnt lgkmcnt(3)
    v_mfma_f32_32x32x16_bf16 v[64:79], a[196:199], a[132:135], v[64:79]
    v_exp_f32 v203, v200
    v_add_f32 v196, v196, v202
    v_cvt_pk_bf16_f32 v136, v201, v202
    v_fma_f32 v199, v36, s36, v192
    v_mfma_f32_32x32x16_bf16 v[80:95], a[196:199], a[164:167], v[80:95]
    ds_read_b128 a[196:199], v217 offset:0
    v_exp_f32 v204, v198
    v_add_f32 v196, v196, v203
    v_fma_f32 v200, v37, s36, v192
    s_waitcnt lgkmcnt(3)
    v_mfma_f32_32x32x16_bf16 v[64:79], a[200:203], a[136:139], v[64:79]
    v_exp_f32 v201, v199
    v_add_f32 v196, v196, v204
    v_cvt_pk_bf16_f32 v137, v203, v204
    v_fma_f32 v198, v38, s36, v192
    v_mfma_f32_32x32x16_bf16 v[80:95], a[200:203], a[168:171], v[80:95]
    ds_read_b128 a[200:203], v218 offset:0
    v_exp_f32 v202, v200
    v_add_f32 v196, v196, v201
    v_fma_f32 v199, v39, s36, v192
    s_waitcnt lgkmcnt(3)
    v_mfma_f32_32x32x16_bf16 v[64:79], a[204:207], a[140:143], v[64:79]
    s_add_u32 m0, s48, 1024
    s_nop 0
    buffer_load_dwordx4 v229, s[16:19], 0 offen lds
    v_exp_f32 v203, v198
    v_add_f32 v196, v196, v202
    v_cvt_pk_bf16_f32 v138, v201, v202
    v_mfma_f32_32x32x16_bf16 v[80:95], a[204:207], a[172:175], v[80:95]
    ds_read_b128 a[204:207], v219 offset:0
    v_fma_f32 v200, v40, s36, v192
    v_exp_f32 v204, v199
    v_add_f32 v196, v196, v203
    s_waitcnt lgkmcnt(3)
    v_mfma_f32_32x32x16_bf16 v[64:79], a[192:195], a[144:147], v[64:79]
    v_fma_f32 v198, v41, s36, v192
    v_exp_f32 v201, v200
    v_add_f32 v196, v196, v204
    v_cvt_pk_bf16_f32 v139, v203, v204
    v_fma_f32 v199, v42, s36, v192
    v_mfma_f32_32x32x16_bf16 v[80:95], a[192:195], a[176:179], v[80:95]
    ds_read_b128 a[192:195], v212 offset:8192
    v_exp_f32 v202, v198
    v_add_f32 v196, v196, v201
    v_fma_f32 v200, v43, s36, v192
    s_waitcnt lgkmcnt(3)
    v_mfma_f32_32x32x16_bf16 v[64:79], a[196:199], a[148:151], v[64:79]
    s_add_u32 m0, s48, 2048
    s_nop 0
    buffer_load_dwordx4 v230, s[16:19], 0 offen lds
    v_exp_f32 v203, v199
    v_add_f32 v196, v196, v202
    v_cvt_pk_bf16_f32 v140, v201, v202
    v_mfma_f32_32x32x16_bf16 v[80:95], a[196:199], a[180:183], v[80:95]
    ds_read_b128 a[196:199], v213 offset:8192
    v_fma_f32 v198, v44, s36, v192
    v_exp_f32 v204, v200
    v_add_f32 v196, v196, v203
    s_waitcnt lgkmcnt(3)
    v_mfma_f32_32x32x16_bf16 v[64:79], a[200:203], a[152:155], v[64:79]
    v_fma_f32 v199, v45, s36, v192
    v_exp_f32 v201, v198
    v_add_f32 v196, v196, v204
    v_cvt_pk_bf16_f32 v141, v203, v204
    v_fma_f32 v200, v46, s36, v192
    v_mfma_f32_32x32x16_bf16 v[80:95], a[200:203], a[184:187], v[80:95]
    ds_read_b128 a[200:203], v214 offset:8192
    v_exp_f32 v202, v199
    v_add_f32 v196, v196, v201
    v_fma_f32 v198, v47, s36, v192
    s_waitcnt lgkmcnt(3)
    v_mfma_f32_32x32x16_bf16 v[64:79], a[204:207], a[156:159], v[64:79]
    v_exp_f32 v203, v200
    v_add_f32 v196, v196, v202
    v_cvt_pk_bf16_f32 v142, v201, v202
    v_fma_f32 v199, v48, s36, v193
    v_mfma_f32_32x32x16_bf16 v[80:95], a[204:207], a[188:191], v[80:95]
    ds_read_b128 a[204:207], v215 offset:8192
    v_exp_f32 v204, v198
    v_add_f32 v196, v196, v203
    v_fma_f32 v200, v49, s36, v193
    s_waitcnt lgkmcnt(3)
    v_mfma_f32_32x32x16_bf16 v[96:111], a[192:195], a[128:131], 0
    s_add_u32 m0, s48, 3072
    s_nop 0
    buffer_load_dwordx4 v231, s[16:19], 0 offen lds
    v_exp_f32 v201, v199
    v_add_f32 v196, v196, v204
    v_cvt_pk_bf16_f32 v143, v203, v204
    v_mfma_f32_32x32x16_bf16 v[112:127], a[192:195], a[160:163], 0
    ds_read_b128 a[192:195], v216 offset:8192
    v_fma_f32 v198, v50, s36, v193
    v_exp_f32 v202, v200
    v_add_f32 v197, v197, v201
    s_waitcnt lgkmcnt(3)
    v_mfma_f32_32x32x16_bf16 v[96:111], a[196:199], a[132:135], v[96:111]
    v_fma_f32 v199, v51, s36, v193
    v_exp_f32 v203, v198
    v_add_f32 v197, v197, v202
    v_cvt_pk_bf16_f32 v152, v201, v202
    v_fma_f32 v200, v52, s36, v193
    v_mfma_f32_32x32x16_bf16 v[112:127], a[196:199], a[164:167], v[112:127]
    ds_read_b128 a[196:199], v217 offset:8192
    v_exp_f32 v204, v199
    v_add_f32 v197, v197, v203
    v_fma_f32 v198, v53, s36, v193
    s_waitcnt lgkmcnt(3)
    v_mfma_f32_32x32x16_bf16 v[96:111], a[200:203], a[136:139], v[96:111]
    s_add_u32 m0, s48, 16384
    s_nop 0
    buffer_load_dwordx4 v232, s[20:23], 0 offen lds
    v_exp_f32 v201, v200
    v_add_f32 v197, v197, v204
    v_cvt_pk_bf16_f32 v153, v203, v204
    v_mfma_f32_32x32x16_bf16 v[112:127], a[200:203], a[168:171], v[112:127]
    ds_read_b128 a[200:203], v218 offset:8192
    v_fma_f32 v199, v54, s36, v193
    v_exp_f32 v202, v198
    v_add_f32 v197, v197, v201
    s_waitcnt lgkmcnt(3)
    v_mfma_f32_32x32x16_bf16 v[96:111], a[204:207], a[140:143], v[96:111]
    v_fma_f32 v200, v55, s36, v193
    v_exp_f32 v203, v199
    v_add_f32 v197, v197, v202
    v_cvt_pk_bf16_f32 v154, v201, v202
    v_fma_f32 v198, v56, s36, v193
    v_mfma_f32_32x32x16_bf16 v[112:127], a[204:207], a[172:175], v[112:127]
    ds_read_b128 a[204:207], v219 offset:8192
    v_exp_f32 v204, v200
    v_add_f32 v197, v197, v203
    v_fma_f32 v199, v57, s36, v193
    s_waitcnt lgkmcnt(3)
    v_mfma_f32_32x32x16_bf16 v[96:111], a[192:195], a[144:147], v[96:111]
    v_exp_f32 v201, v198
    v_add_f32 v197, v197, v204
    v_cvt_pk_bf16_f32 v155, v203, v204
    v_fma_f32 v200, v58, s36, v193
    v_mfma_f32_32x32x16_bf16 v[112:127], a[192:195], a[176:179], v[112:127]
    v_exp_f32 v202, v199
    v_add_f32 v197, v197, v201
    v_fma_f32 v198, v59, s36, v193
    v_exp_f32 v203, v200
    s_waitcnt lgkmcnt(2)
    v_mfma_f32_32x32x16_bf16 v[96:111], a[196:199], a[148:151], v[96:111]
    v_add_f32 v197, v197, v202
    v_cvt_pk_bf16_f32 v156, v201, v202
    v_fma_f32 v199, v60, s36, v193
    v_exp_f32 v204, v198
    v_add_f32 v197, v197, v203
    v_mfma_f32_32x32x16_bf16 v[112:127], a[196:199], a[180:183], v[112:127]
    ds_read_b64_tr_b16 a[208:209], v220 offset:0
    v_fma_f32 v200, v61, s36, v193
    v_exp_f32 v201, v199
    v_add_f32 v197, v197, v204
    s_waitcnt lgkmcnt(2)
    v_mfma_f32_32x32x16_bf16 v[96:111], a[200:203], a[152:155], v[96:111]
    ds_read_b64_tr_b16 a[210:211], v220 offset:2048
    ds_read_b64_tr_b16 a[212:213], v221 offset:0
    v_cvt_pk_bf16_f32 v157, v203, v204
    v_fma_f32 v198, v62, s36, v193
    v_mfma_f32_32x32x16_bf16 v[112:127], a[200:203], a[184:187], v[112:127]
    ds_read_b64_tr_b16 a[214:215], v221 offset:2048
    ds_read_b64_tr_b16 a[216:217], v222 offset:0
    v_exp_f32 v202, v200
    v_add_f32 v197, v197, v201
    s_waitcnt lgkmcnt(5)
    v_mfma_f32_32x32x16_bf16 v[96:111], a[204:207], a[156:159], v[96:111]
    ds_read_b64_tr_b16 a[218:219], v222 offset:2048
    v_fma_f32 v199, v63, s36, v193
    v_exp_f32 v203, v198
    v_add_f32 v197, v197, v202
    v_cvt_pk_bf16_f32 v158, v201, v202
    v_exp_f32 v204, v199
    v_add_f32 v197, v197, v203
    v_add_f32 v197, v197, v204
    v_cvt_pk_bf16_f32 v159, v203, v204
    v_mfma_f32_32x32x16_bf16 v[112:127], a[204:207], a[188:191], v[112:127]
    v_cmp_lt_f32 vcc, 0x45800000, v196
    v_cmp_lt_f32 s[44:45], s47, v197
    s_or_b64 vcc, vcc, s[44:45]
    s_cbranch_vccnz RARE_X30
    v_add_f32 v194, v194, v196
    v_mov_b32 v196, 0
    v_add_f32 v195, v195, v197
    v_mov_b32 v197, 0
BACK_X30:
    ds_read_b64_tr_b16 a[220:221], v223 offset:0
    v_fma_f32 v198, v64, s36, v192
    v_fma_f32 v199, v65, s36, v192
    v_exp_f32 v201, v198
    v_fma_f32 v200, v66, s36, v192
    s_waitcnt lgkmcnt(5)
    v_mfma_f32_32x32x16_bf16 a[0:15], a[208:211], v[128:131], a[0:15]
    ds_read_b64_tr_b16 a[222:223], v223 offset:2048
    s_add_u32 m0, s48, 17408
    s_nop 0
    buffer_load_dwordx4 v233, s[20:23], 0 offen lds
    v_exp_f32 v202, v199
    v_add_f32 v196, v196, v201
    v_fma_f32 v198, v67, s36, v192
    v_mfma_f32_32x32x16_bf16 a[64:79], a[208:211], v[144:147], a[64:79]
    ds_read_b64_tr_b16 a[208:209], v220 offset:4096
    v_exp_f32 v203, v200
    v_add_f32 v196, v196, v202
    v_cvt_pk_bf16_f32 v160, v201, v202
    v_fma_f32 v199, v68, s36, v192
    s_waitcnt lgkmcnt(5)
    v_mfma_f32_32x32x16_bf16 a[16:31], a[212:215], v[128:131], a[16:31]
    ds_read_b64_tr_b16 a[210:211], v220 offset:6144
    v_exp_f32 v204, v198
    v_add_f32 v196, v196, v203
    v_fma_f32 v200, v69, s36, v192
    v_mfma_f32_32x32x16_bf16 a[80:95], a[212:215], v[144:147], a[80:95]
    ds_read_b64_tr_b16 a[212:213], v221 offset:4096
    v_exp_f32 v201, v199
    v_add_f32 v196, v196, v204
    v_cvt_pk_bf16_f32 v161, v203, v204
    v_fma_f32 v198, v70, s36, v192
    s_waitcnt lgkmcnt(5)
    v_mfma_f32_32x32x16_bf16 a[32:47], a[216:219], v[128:131], a[32:47]
    ds_read_b64_tr_b16 a[214:215], v221 offset:6144
    v_exp_f32 v202, v200
    v_add_f32 v196, v196, v201
    v_fma_f32 v199, v71, s36, v192
    v_mfma_f32_32x32x16_bf16 a[96:111], a[216:219], v[144:147], a[96:111]
    ds_read_b64_tr_b16 a[216:217], v222 offset:4096
    s_add_u32 m0, s48, 18432
    s_nop 0
    buffer_load_dwordx4 v234, s[20:23], 0 offen lds
    v_exp_f32 v203, v198
    v_add_f32 v196, v196, v202
    v_cvt_pk_bf16_f32 v162, v201, v202
    s_waitcnt lgkmcnt(5)
    v_mfma_f32_32x32x16_bf16 a[48:63], a[220:223], v[128:131], a[48:63]
    ds_read_b64_tr_b16 a[218:219], v222 offset:6144
    v_fma_f32 v200, v72, s36, v192
    v_exp_f32 v204, v199
    v_add_f32 v196, v196, v203
    v_fma_f32 v198, v73, s36, v192
    v_mfma_f32_32x32x16_bf16 a[112:127], a[220:223], v[144:147], a[112:127]
    ds_read_b64_tr_b16 a[220:221], v223 offset:4096
    v_exp_f32 v201, v200
    v_add_f32 v196, v196, v204
    v_cvt_pk_bf16_f32 v163, v203, v204
    v_fma_f32 v199, v74, s36, v192
    s_waitcnt lgkmcnt(5)
    v_mfma_f32_32x32x16_bf16 a[0:15], a[208:211], v[132:135], a[0:15]
    ds_read_b64_tr_b16 a[222:223], v223 offset:6144
    v_exp_f32 v202, v198
    v_add_f32 v196, v196, v201
    v_fma_f32 v200, v75, s36, v192
    v_mfma_f32_32x32x16_bf16 a[64:79], a[208:211], v[148:151], a[64:79]
    ds_read_b64_tr_b16 a[208:209], v220 offset:8192
    v_exp_f32 v203, v199
    v_add_f32 v196, v196, v202
    v_cvt_pk_bf16_f32 v164, v201, v202
    v_fma_f32 v198, v76, s36, v192
    s_waitcnt lgkmcnt(5)
    v_mfma_f32_32x32x16_bf16 a[16:31], a[212:215], v[132:135], a[16:31]
    ds_read_b64_tr_b16 a[210:211], v220 offset:10240
    s_add_u32 m0, s48, 19456
    s_nop 0
    buffer_load_dwordx4 v235, s[20:23], 0 offen lds
    v_exp_f32 v204, v200
    v_add_f32 v196, v196, v203
    v_fma_f32 v199, v77, s36, v192
    v_mfma_f32_32x32x16_bf16 a[80:95], a[212:215], v[148:151], a[80:95]
    ds_read_b64_tr_b16 a[212:213], v221 offset:8192
    v_exp_f32 v201, v198
    v_add_f32 v196, v196, v204
    v_cvt_pk_bf16_f32 v165, v203, v204
    v_fma_f32 v200, v78, s36, v192
    s_waitcnt lgkmcnt(5)
    v_mfma_f32_32x32x16_bf16 a[32:47], a[216:219], v[132:135], a[32:47]
    ds_read_b64_tr_b16 a[214:215], v221 offset:10240
    v_exp_f32 v202, v199
    v_add_f32 v196, v196, v201
    v_fma_f32 v198, v79, s36, v192
    v_mfma_f32_32x32x16_bf16 a[96:111], a[216:219], v[148:151], a[96:111]
    ds_read_b64_tr_b16 a[216:217], v222 offset:8192
    v_exp_f32 v203, v200
    v_add_f32 v196, v196, v202
    v_cvt_pk_bf16_f32 v166, v201, v202
    v_fma_f32 v199, v80, s36, v193
    s_waitcnt lgkmcnt(5)
    v_mfma_f32_32x32x16_bf16 a[48:63], a[220:223], v[132:135], a[48:63]
    ds_read_b64_tr_b16 a[218:219], v222 offset:10240
    v_exp_f32 v204, v198
    v_add_f32 v196, v196, v203
    v_fma_f32 v200, v81, s36, v193
    v_mfma_f32_32x32x16_bf16 a[112:127], a[220:223], v[148:151], a[112:127]
    ds_read_b64_tr_b16 a[220:221], v223 offset:8192
    s_add_u32 m0, s49, 0
    s_nop 0
    buffer_load_dwordx4 v241, s[24:27], 0 offen lds
    v_exp_f32 v201, v199
    v_add_f32 v196, v196, v204
    v_cvt_pk_bf16_f32 v167, v203, v204
    s_waitcnt lgkmcnt(5)
    v_mfma_f32_32x32x16_bf16 a[0:15], a[208:211], v[136:139], a[0:15]
    ds_read_b64_tr_b16 a[222:223], v223 offset:10240
    v_fma_f32 v198, v82, s36, v193
    v_exp_f32 v202, v200
    v_add_f32 v197, v197, v201
    v_fma_f32 v199, v83, s36, v193
    v_mfma_f32_32x32x16_bf16 a[64:79], a[208:211], v[152:155], a[64:79]
    ds_read_b64_tr_b16 a[208:209], v220 offset:12288
    v_exp_f32 v203, v198
    v_add_f32 v197, v197, v202
    v_cvt_pk_bf16_f32 v176, v201, v202
    v_fma_f32 v200, v84, s36, v193
    s_waitcnt lgkmcnt(5)
    v_mfma_f32_32x32x16_bf16 a[16:31], a[212:215], v[136:139], a[16:31]
    ds_read_b64_tr_b16 a[210:211], v220 offset:14336
    v_exp_f32 v204, v199
    v_add_f32 v197, v197, v203
    v_fma_f32 v198, v85, s36, v193
    v_mfma_f32_32x32x16_bf16 a[80:95], a[212:215], v[152:155], a[80:95]
    ds_read_b64_tr_b16 a[212:213], v221 offset:12288
    v_exp_f32 v201, v200
    v_add_f32 v197, v197, v204
    v_cvt_pk_bf16_f32 v177, v203, v204
    v_fma_f32 v199, v86, s36, v193
    s_waitcnt lgkmcnt(5)
    v_mfma_f32_32x32x16_bf16 a[32:47], a[216:219], v[136:139], a[32:47]
    ds_read_b64_tr_b16 a[214:215], v221 offset:14336
    s_add_u32 m0, s49, 1024
    s_nop 0
    buffer_load_dwordx4 v242, s[24:27], 0 offen lds
    v_exp_f32 v202, v198
    v_add_f32 v197, v197, v201
    v_fma_f32 v200, v87, s36, v193
    v_mfma_f32_32x32x16_bf16 a[96:111], a[216:219], v[152:155], a[96:111]
    ds_read_b64_tr_b16 a[216:217], v222 offset:12288
    v_exp_f32 v203, v199
    v_add_f32 v197, v197, v202
    v_cvt_pk_bf16_f32 v178, v201, v202
    v_fma_f32 v198, v88, s36, v193
    s_waitcnt lgkmcnt(5)
    v_mfma_f32_32x32x16_bf16 a[48:63], a[220:223], v[136:139], a[48:63]
    ds_read_b64_tr_b16 a[218:219], v222 offset:14336
    v_exp_f32 v204, v200
    v_add_f32 v197, v197, v203
    v_fma_f32 v199, v89, s36, v193
    v_mfma_f32_32x32x16_bf16 a[112:127], a[220:223], v[152:155], a[112:127]
    ds_read_b64_tr_b16 a[220:221], v223 offset:12288
    s_waitcnt vmcnt(12)
    v_and_b32 v252, 0x7ff, v244
    v_lshl_add_u32 v228, v252, 8, v236
    v_lshl_add_u32 v232, v252, 8, v240
    v_and_b32 v252, 0x7ff, v245
    v_lshl_add_u32 v229, v252, 8, v237
    v_lshl_add_u32 v233, v252, 8, v240
    v_and_b32 v252, 0x7ff, v246
    v_lshl_add_u32 v230, v252, 8, v238
    v_lshl_add_u32 v234, v252, 8, v240
    v_and_b32 v252, 0x7ff, v247
    v_lshl_add_u32 v231, v252, 8, v239
    v_lshl_add_u32 v235, v252, 8, v240
    s_waitcnt lgkmcnt(5)
    v_mfma_f32_32x32x16_bf16 a[0:15], a[208:211], v[140:143], a[0:15]
    ds_read_b64_tr_b16 a[222:223], v223 offset:14336
    v_exp_f32 v201, v198
    v_add_f32 v197, v197, v204
    v_cvt_pk_bf16_f32 v179, v203, v204
    v_fma_f32 v200, v90, s36, v193
    v_mfma_f32_32x32x16_bf16 a[64:79], a[208:211], v[156:159], a[64:79]
    s_waitcnt vmcnt(11)
    v_lshl_add_u32 v241, v248, 12, v243
    s_waitcnt vmcnt(10)
    v_lshl_add_u32 v242, v249, 12, v243
    v_add_u32 v250, 0x100, v250
    v_add_u32 v251, 0x100, v251
    v_exp_f32 v202, v199
    v_add_f32 v197, v197, v201
    s_waitcnt lgkmcnt(4)
    v_mfma_f32_32x32x16_bf16 a[16:31], a[212:215], v[140:143], a[16:31]
    v_fma_f32 v198, v91, s36, v193
    v_exp_f32 v203, v200
    v_add_f32 v197, v197, v202
    v_cvt_pk_bf16_f32 v180, v201, v202
    v_fma_f32 v199, v92, s36, v193
    v_mfma_f32_32x32x16_bf16 a[80:95], a[212:215], v[156:159], a[80:95]
    s_waitcnt lgkmcnt(0)
    s_barrier
    s_mov_b32 s42, s41
    s_add_u32 s46, s40, 0x8000
    s_and_b32 s46, s46, 0x1ffff
    s_sub_u32 s41, s46, s40
    s_mov_b32 s40, s46
    s_add_u32 s43, s43, 0x8000
    s_and_b32 s43, s43, 0x1ffff
    s_add_u32 s48, s43, s53
    s_lshr_b32 s46, s43, 2
    s_add_u32 s46, s46, s54
    s_add_u32 s49, s46, 0x20000
    s_ashr_i32 s44, s41, 2
    s_ashr_i32 s45, s42, 2
    v_add_u32 v212, s41, v212
    v_add_u32 v213, s41, v213
    v_add_u32 v214, s41, v214
    v_mfma_f32_32x32x16_bf16 a[32:47], a[216:219], v[140:143], a[32:47]
    ds_read_b128 a[192:195], v212 offset:0
    ds_read_b128 a[196:199], v213 offset:0
    v_add_u32 v215, s41, v215
    v_add_u32 v216, s41, v216
    v_add_u32 v217, s41, v217
    v_mfma_f32_32x32x16_bf16 a[96:111], a[216:219], v[156:159], a[96:111]
    ds_read_b128 a[200:203], v214 offset:0
    v_add_u32 v218, s41, v218
    v_add_u32 v219, s41, v219
    v_add_u32 v220, s42, v220
    v_add_u32 v221, s42, v221
    v_mfma_f32_32x32x16_bf16 a[48:63], a[220:223], v[140:143], a[48:63]
    v_add_u32 v222, s42, v222
    v_add_u32 v223, s42, v223
    v_add_u32 v224, s45, v224
    v_add_u32 v225, s45, v225
    v_add_u32 v226, s44, v226
    v_add_u32 v227, s44, v227
    v_exp_f32 v204, v198
    v_add_f32 v197, v197, v203
    v_fma_f32 v200, v93, s36, v193
    v_exp_f32 v201, v199
    v_add_f32 v197, v197, v204
    v_cvt_pk_bf16_f32 v181, v203, v204
    v_fma_f32 v198, v94, s36, v193
    v_exp_f32 v202, v200
    v_add_f32 v197, v197, v201
    v_fma_f32 v199, v95, s36, v193
    v_exp_f32 v203, v198
    v_add_f32 v197, v197, v202
    v_cvt_pk_bf16_f32 v182, v201, v202
    v_exp_f32 v204, v199
    v_add_f32 v197, v197, v203
    v_add_f32 v197, v197, v204
    v_cvt_pk_bf16_f32 v183, v203, v204
    v_mfma_f32_32x32x16_bf16 a[112:127], a[220:223], v[156:159], a[112:127]
    ds_read_b128 a[204:207], v215 offset:0
    buffer_load_dwordx4 v[244:247], v250, s[76:79], 0 offen
    buffer_load_dword v248, v251, s[76:79], 0 offen
    buffer_load_dword v249, v251, s[76:79], 0 offen offset:8
    v_fma_f32 v198, v96, s36, v192
    s_waitcnt lgkmcnt(3)
    v_mfma_f32_32x32x16_bf16 v[0:15], a[192:195], a[128:131], 0
    s_add_u32 m0, s48, 0
    s_nop 0
    buffer_load_dwordx4 v228, s[16:19], 0 offen lds
    v_fma_f32 v199, v97, s36, v192
    v_exp_f32 v201, v198
    v_fma_f32 v200, v98, s36, v192
    v_mfma_f32_32x32x16_bf16 v[16:31], a[192:195], a[160:163], 0
    ds_read_b128 a[192:195], v216 offset:0
    v_exp_f32 v202, v199
    v_add_f32 v196, v196, v201
    v_fma_f32 v198, v99, s36, v192
    s_waitcnt lgkmcnt(3)
    v_mfma_f32_32x32x16_bf16 v[0:15], a[196:199], a[132:135], v[0:15]
    v_exp_f32 v203, v200
    v_add_f32 v196, v196, v202
    v_cvt_pk_bf16_f32 v168, v201, v202
    v_fma_f32 v199, v100, s36, v192
    v_mfma_f32_32x32x16_bf16 v[16:31], a[196:199], a[164:167], v[16:31]
    ds_read_b128 a[196:199], v217 offset:0
    v_exp_f32 v204, v198
    v_add_f32 v196, v196, v203
    v_fma_f32 v200, v101, s36, v192
    s_waitcnt lgkmcnt(3)
    v_mfma_f32_32x32x16_bf16 v[0:15], a[200:203], a[136:139], v[0:15]
    v_exp_f32 v201, v199
    v_add_f32 v196, v196, v204
    v_cvt_pk_bf16_f32 v169, v203, v204
    v_fma_f32 v198, v102, s36, v192
    v_mfma_f32_32x32x16_bf16 v[16:31], a[200:203], a[168:171], v[16:31]
    ds_read_b128 a[200:203], v218 offset:0
    v_exp_f32 v202, v200
    v_add_f32 v196, v196, v201
    v_fma_f32 v199, v103, s36, v192
    s_waitcnt lgkmcnt(3)
    v_mfma_f32_32x32x16_bf16 v[0:15], a[204:207], a[140:143], v[0:15]
    s_add_u32 m0, s48, 1024
    s_nop 0
    buffer_load_dwordx4 v229, s[16:19], 0 offen lds
    v_exp_f32 v203, v198
    v_add_f32 v196, v196, v202
    v_cvt_pk_bf16_f32 v170, v201, v202
    v_mfma_f32_32x32x16_bf16 v[16:31], a[204:207], a[172:175], v[16:31]
    ds_read_b128 a[204:207], v219 offset:0
    v_fma_f32 v200, v104, s36, v192
    v_exp_f32 v204, v199
    v_add_f32 v196, v196, v203
    s_waitcnt lgkmcnt(3)
    v_mfma_f32_32x32x16_bf16 v[0:15], a[192:195], a[144:147], v[0:15]
    v_fma_f32 v198, v105, s36, v192
    v_exp_f32 v201, v200
    v_add_f32 v196, v196, v204
    v_cvt_pk_bf16_f32 v171, v203, v204
    v_fma_f32 v199, v106, s36, v192
    v_mfma_f32_32x32x16_bf16 v[16:31], a[192:195], a[176:179], v[16:31]
    ds_read_b128 a[192:195], v212 offset:8192
    v_exp_f32 v202, v198
    v_add_f32 v196, v196, v201
    v_fma_f32 v200, v107, s36, v192
    s_waitcnt lgkmcnt(3)
    v_mfma_f32_32x32x16_bf16 v[0:15], a[196:199], a[148:151], v[0:15]
    s_add_u32 m0, s48, 2048
    s_nop 0
    buffer_load_dwordx4 v230, s[16:19], 0 offen lds
    v_exp_f32 v203, v199
    v_add_f32 v196, v196, v202
    v_cvt_pk_bf16_f32 v172, v201, v202
    v_mfma_f32_32x32x16_bf16 v[16:31], a[196:199], a[180:183], v[16:31]
    ds_read_b128 a[196:199], v213 offset:8192
    v_fma_f32 v198, v108, s36, v192
    v_exp_f32 v204, v200
    v_add_f32 v196, v196, v203
    s_waitcnt lgkmcnt(3)
    v_mfma_f32_32x32x16_bf16 v[0:15], a[200:203], a[152:155], v[0:15]
    v_fma_f32 v199, v109, s36, v192
    v_exp_f32 v201, v198
    v_add_f32 v196, v196, v204
    v_cvt_pk_bf16_f32 v173, v203, v204
    v_fma_f32 v200, v110, s36, v192
    v_mfma_f32_32x32x16_bf16 v[16:31], a[200:203], a[184:187], v[16:31]
    ds_read_b128 a[200:203], v214 offset:8192
    v_exp_f32 v202, v199
    v_add_f32 v196, v196, v201
    v_fma_f32 v198, v111, s36, v192
    s_waitcnt lgkmcnt(3)
    v_mfma_f32_32x32x16_bf16 v[0:15], a[204:207], a[156:159], v[0:15]
    v_exp_f32 v203, v200
    v_add_f32 v196, v196, v202
    v_cvt_pk_bf16_f32 v174, v201, v202
    v_fma_f32 v199, v112, s36, v193
    v_mfma_f32_32x32x16_bf16 v[16:31], a[204:207], a[188:191], v[16:31]
    ds_read_b128 a[204:207], v215 offset:8192
    v_exp_f32 v204, v198
    v_add_f32 v196, v196, v203
    v_fma_f32 v200, v113, s36, v193
    s_waitcnt lgkmcnt(3)
    v_mfma_f32_32x32x16_bf16 v[32:47], a[192:195], a[128:131], 0
    s_add_u32 m0, s48, 3072
    s_nop 0
    buffer_load_dwordx4 v231, s[16:19], 0 offen lds
    v_exp_f32 v201, v199
    v_add_f32 v196, v196, v204
    v_cvt_pk_bf16_f32 v175, v203, v204
    v_mfma_f32_32x32x16_bf16 v[48:63], a[192:195], a[160:163], 0
    ds_read_b128 a[192:195], v216 offset:8192
    v_fma_f32 v198, v114, s36, v193
    v_exp_f32 v202, v200
    v_add_f32 v197, v197, v201
    s_waitcnt lgkmcnt(3)
    v_mfma_f32_32x32x16_bf16 v[32:47], a[196:199], a[132:135], v[32:47]
    v_fma_f32 v199, v115, s36, v193
    v_exp_f32 v203, v198
    v_add_f32 v197, v197, v202
    v_cvt_pk_bf16_f32 v184, v201, v202
    v_fma_f32 v200, v116, s36, v193
    v_mfma_f32_32x32x16_bf16 v[48:63], a[196:199], a[164:167], v[48:63]
    ds_read_b128 a[196:199], v217 offset:8192
    v_exp_f32 v204, v199
    v_add_f32 v197, v197, v203
    v_fma_f32 v198, v117, s36, v193
    s_waitcnt lgkmcnt(3)
    v_mfma_f32_32x32x16_bf16 v[32:47], a[200:203], a[136:139], v[32:47]
    s_add_u32 m0, s48, 16384
    s_nop 0
    buffer_load_dwordx4 v232, s[20:23], 0 offen lds
    v_exp_f32 v201, v200
    v_add_f32 v197, v197, v204
    v_cvt_pk_bf16_f32 v185, v203, v204
    v_mfma_f32_32x32x16_bf16 v[48:63], a[200:203], a[168:171], v[48:63]
    ds_read_b128 a[200:203], v218 offset:8192
    v_fma_f32 v199, v118, s36, v193
    v_exp_f32 v202, v198
    v_add_f32 v197, v197, v201
    s_waitcnt lgkmcnt(3)
    v_mfma_f32_32x32x16_bf16 v[32:47], a[204:207], a[140:143], v[32:47]
    v_fma_f32 v200, v119, s36, v193
    v_exp_f32 v203, v199
    v_add_f32 v197, v197, v202
    v_cvt_pk_bf16_f32 v186, v201, v202
    v_fma_f32 v198, v120, s36, v193
    v_mfma_f32_32x32x16_bf16 v[48:63], a[204:207], a[172:175], v[48:63]
    ds_read_b128 a[204:207], v219 offset:8192
    v_exp_f32 v204, v200
    v_add_f32 v197, v197, v203
    v_fma_f32 v199, v121, s36, v193
    s_waitcnt lgkmcnt(3)
    v_mfma_f32_32x32x16_bf16 v[32:47], a[192:195], a[144:147], v[32:47]
    v_exp_f32 v201, v198
    v_add_f32 v197, v197, v204
    v_cvt_pk_bf16_f32 v187, v203, v204
    v_fma_f32 v200, v122, s36, v193
    v_mfma_f32_32x32x16_bf16 v[48:63], a[192:195], a[176:179], v[48:63]
    v_exp_f32 v202, v199
    v_add_f32 v197, v197, v201
    v_fma_f32 v198, v123, s36, v193
    v_exp_f32 v203, v200
    s_waitcnt lgkmcnt(2)
    v_mfma_f32_32x32x16_bf16 v[32:47], a[196:199], a[148:151], v[32:47]
    v_add_f32 v197, v197, v202
    v_cvt_pk_bf16_f32 v188, v201, v202
    v_fma_f32 v199, v124, s36, v193
    v_exp_f32 v204, v198
    v_add_f32 v197, v197, v203
    v_mfma_f32_32x32x16_bf16 v[48:63], a[196:199], a[180:183], v[48:63]
    ds_read_b64_tr_b16 a[208:209], v220 offset:0
    v_fma_f32 v200, v125, s36, v193
    v_exp_f32 v201, v199
    v_add_f32 v197, v197, v204
    s_waitcnt lgkmcnt(2)
    v_mfma_f32_32x32x16_bf16 v[32:47], a[200:203], a[152:155], v[32:47]
    ds_read_b64_tr_b16 a[210:211], v220 offset:2048
    ds_read_b64_tr_b16 a[212:213], v221 offset:0
    v_cvt_pk_bf16_f32 v189, v203, v204
    v_fma_f32 v198, v126, s36, v193
    v_mfma_f32_32x32x16_bf16 v[48:63], a[200:203], a[184:187], v[48:63]
    ds_read_b64_tr_b16 a[214:215], v221 offset:2048
    ds_read_b64_tr_b16 a[216:217], v222 offset:0
    v_exp_f32 v202, v200
    v_add_f32 v197, v197, v201
    s_waitcnt lgkmcnt(5)
    v_mfma_f32_32x32x16_bf16 v[32:47], a[204:207], a[156:159], v[32:47]
    ds_read_b64_tr_b16 a[218:219], v222 offset:2048
    v_fma_f32 v199, v127, s36, v193
    v_exp_f32 v203, v198
    v_add_f32 v197, v197, v202
    v_cvt_pk_bf16_f32 v190, v201, v202
    v_exp_f32 v204, v199
    v_add_f32 v197, v197, v203
    v_add_f32 v197, v197, v204
    v_cvt_pk_bf16_f32 v191, v203, v204
    v_mfma_f32_32x32x16_bf16 v[48:63], a[204:207], a[188:191], v[48:63]
    v_cmp_lt_f32 vcc, 0x45800000, v196
    v_cmp_lt_f32 s[44:45], s47, v197
    s_or_b64 vcc, vcc, s[44:45]
    s_cbranch_vccnz RARE_X31
    v_add_f32 v194, v194, v196
    v_mov_b32 v196, 0
    v_add_f32 v195, v195, v197
    v_mov_b32 v197, 0
BACK_X31:
    ds_read_b64_tr_b16 a[220:221], v223 offset:0
    ds_read_b64_tr_b16 v[206:207], v226 offset:0
    ds_read_b64_tr_b16 v[208:209], v226 offset:1024
    ds_read_b64_tr_b16 v[210:211], v226 offset:2048
    s_waitcnt lgkmcnt(2)
    v_lshlrev_b32 v205, 16, v206
    v_add_f32 v0, v0, v205
    v_and_b32 v205, 0xffff0000, v206
    v_add_f32 v1, v1, v205
    v_mfma_f32_32x32x16_bf16 a[0:15], a[208:211], v[160:163], a[0:15]
    ds_read_b64_tr_b16 a[222:223], v223 offset:2048
    s_add_u32 m0, s48, 17408
    s_nop 0
    buffer_load_dwordx4 v233, s[20:23], 0 offen lds
    v_fma_f32 v198, v0, s36, v192
    v_lshlrev_b32 v205, 16, v207
    v_add_f32 v2, v2, v205
    v_fma_f32 v199, v1, s36, v192
    v_exp_f32 v201, v198
    v_mfma_f32_32x32x16_bf16 a[64:79], a[208:211], v[176:179], a[64:79]
    ds_read_b64_tr_b16 a[208:209], v220 offset:4096
    v_and_b32 v205, 0xffff0000, v207
    v_add_f32 v3, v3, v205
    v_fma_f32 v200, v2, s36, v192
    v_exp_f32 v202, v199
    v_add_f32 v196, v196, v201
    s_waitcnt lgkmcnt(3)
    v_lshlrev_b32 v205, 16, v208
    v_add_f32 v4, v4, v205
    v_mfma_f32_32x32x16_bf16 a[16:31], a[212:215], v[160:163], a[16:31]
    ds_read_b64_tr_b16 a[210:211], v220 offset:6144
    v_fma_f32 v198, v3, s36, v192
    v_exp_f32 v203, v200
    v_add_f32 v196, v196, v202
    v_cvt_pk_bf16_f32 v128, v201, v202
    v_and_b32 v205, 0xffff0000, v208
    v_add_f32 v5, v5, v205
    v_fma_f32 v199, v4, s36, v192
    v_mfma_f32_32x32x16_bf16 a[80:95], a[212:215], v[176:179], a[80:95]
    ds_read_b64_tr_b16 a[212:213], v221 offset:4096
    v_exp_f32 v204, v198
    v_add_f32 v196, v196, v203
    ds_read_b64_tr_b16 v[206:207], v226 offset:3072
    v_lshlrev_b32 v205, 16, v209
    v_add_f32 v6, v6, v205
    v_fma_f32 v200, v5, s36, v192
    v_mfma_f32_32x32x16_bf16 a[32:47], a[216:219], v[160:163], a[32:47]
    ds_read_b64_tr_b16 a[214:215], v221 offset:6144
    v_exp_f32 v201, v199
    v_add_f32 v196, v196, v204
    v_cvt_pk_bf16_f32 v129, v203, v204
    v_and_b32 v205, 0xffff0000, v209
    v_add_f32 v7, v7, v205
    v_fma_f32 v198, v6, s36, v192
    v_mfma_f32_32x32x16_bf16 a[96:111], a[216:219], v[176:179], a[96:111]
    ds_read_b64_tr_b16 a[216:217], v222 offset:4096
    s_add_u32 m0, s48, 18432
    s_nop 0
    buffer_load_dwordx4 v234, s[20:23], 0 offen lds
    v_exp_f32 v202, v200
    v_add_f32 v196, v196, v201
    s_waitcnt lgkmcnt(7)
    v_lshlrev_b32 v205, 16, v210
    v_add_f32 v8, v8, v205
    v_fma_f32 v199, v7, s36, v192
    s_waitcnt lgkmcnt(6)
    v_mfma_f32_32x32x16_bf16 a[48:63], a[220:223], v[160:163], a[48:63]
    ds_read_b64_tr_b16 a[218:219], v222 offset:6144
    v_exp_f32 v203, v198
    v_add_f32 v196, v196, v202
    v_cvt_pk_bf16_f32 v130, v201, v202
    v_and_b32 v205, 0xffff0000, v210
    v_add_f32 v9, v9, v205
    v_fma_f32 v200, v8, s36, v192
    v_mfma_f32_32x32x16_bf16 a[112:127], a[220:223], v[176:179], a[112:127]
    ds_read_b64_tr_b16 a[220:221], v223 offset:4096
    v_exp_f32 v204, v199
    v_add_f32 v196, v196, v203
    ds_read_b64_tr_b16 v[208:209], v227 offset:0
    v_lshlrev_b32 v205, 16, v211
    v_add_f32 v10, v10, v205
    v_fma_f32 v198, v9, s36, v192
    s_waitcnt lgkmcnt(7)
    v_mfma_f32_32x32x16_bf16 a[0:15], a[208:211], v[164:167], a[0:15]
    ds_read_b64_tr_b16 a[222:223], v223 offset:6144
    v_exp_f32 v201, v200
    v_add_f32 v196, v196, v204
    v_cvt_pk_bf16_f32 v131, v203, v204
    v_and_b32 v205, 0xffff0000, v211
    v_add_f32 v11, v11, v205
    v_fma_f32 v199, v10, s36, v192
    v_mfma_f32_32x32x16_bf16 a[64:79], a[208:211], v[180:183], a[64:79]
    ds_read_b64_tr_b16 a[208:209], v220 offset:8192
    v_exp_f32 v202, v198
    v_add_f32 v196, v196, v201
    s_waitcnt lgkmcnt(7)
    v_lshlrev_b32 v205, 16, v206
    v_add_f32 v12, v12, v205
    v_fma_f32 v200, v11, s36, v192
    v_exp_f32 v203, v199
    s_waitcnt lgkmcnt(6)
    v_mfma_f32_32x32x16_bf16 a[16:31], a[212:215], v[164:167], a[16:31]
    ds_read_b64_tr_b16 a[210:211], v220 offset:10240
    s_add_u32 m0, s48, 19456
    s_nop 0
    buffer_load_dwordx4 v235, s[20:23], 0 offen lds
    v_add_f32 v196, v196, v202
    v_cvt_pk_bf16_f32 v132, v201, v202
    v_and_b32 v205, 0xffff0000, v206
    v_add_f32 v13, v13, v205
    v_fma_f32 v198, v12, s36, v192
    v_mfma_f32_32x32x16_bf16 a[80:95], a[212:215], v[180:183], a[80:95]
    ds_read_b64_tr_b16 a[212:213], v221 offset:8192
    v_exp_f32 v204, v200
    v_add_f32 v196, v196, v203
    ds_read_b64_tr_b16 v[210:211], v227 offset:1024
    v_lshlrev_b32 v205, 16, v207
    v_add_f32 v14, v14, v205
    v_fma_f32 v199, v13, s36, v192
    s_waitcnt lgkmcnt(7)
    v_mfma_f32_32x32x16_bf16 a[32:47], a[216:219], v[164:167], a[32:47]
    ds_read_b64_tr_b16 a[214:215], v221 offset:10240
    v_exp_f32 v201, v198
    v_add_f32 v196, v196, v204
    v_cvt_pk_bf16_f32 v133, v203, v204
    v_and_b32 v205, 0xffff0000, v207
    v_add_f32 v15, v15, v205
    v_fma_f32 v200, v14, s36, v192
    v_mfma_f32_32x32x16_bf16 a[96:111], a[216:219], v[180:183], a[96:111]
    ds_read_b64_tr_b16 a[216:217], v222 offset:8192
    v_exp_f32 v202, v199
    v_add_f32 v196, v196, v201
    s_waitcnt lgkmcnt(7)
    v_lshlrev_b32 v205, 16, v208
    v_add_f32 v16, v16, v205
    v_fma_f32 v198, v15, s36, v192
    v_exp_f32 v203, v200
    s_waitcnt lgkmcnt(6)
    v_mfma_f32_32x32x16_bf16 a[48:63], a[220:223], v[164:167], a[48:63]
    ds_read_b64_tr_b16 a[218:219], v222 offset:10240
    v_add_f32 v196, v196, v202
    v_cvt_pk_bf16_f32 v134, v201, v202
    v_and_b32 v205, 0xffff0000, v208
    v_add_f32 v17, v17, v205
    v_fma_f32 v199, v16, s36, v193
    v_exp_f32 v204, v198
    v_add_f32 v196, v196, v203
    v_mfma_f32_32x32x16_bf16 a[112:127], a[220:223], v[180:183], a[112:127]
    ds_read_b64_tr_b16 a[220:221], v223 offset:8192
    s_add_u32 m0, s49, 0
    s_nop 0
    buffer_load_dwordx4 v241, s[24:27], 0 offen lds
    ds_read_b64_tr_b16 v[206:207], v227 offset:2048
    v_lshlrev_b32 v205, 16, v209
    v_add_f32 v18, v18, v205
    v_fma_f32 v200, v17, s36, v193
    v_exp_f32 v201, v199
    s_waitcnt lgkmcnt(7)
    v_mfma_f32_32x32x16_bf16 a[0:15], a[208:211], v[168:171], a[0:15]
    ds_read_b64_tr_b16 a[222:223], v223 offset:10240
    v_add_f32 v196, v196, v204
    v_cvt_pk_bf16_f32 v135, v203, v204
    v_and_b32 v205, 0xffff0000, v209
    v_add_f32 v19, v19, v205
    v_fma_f32 v198, v18, s36, v193
    v_exp_f32 v202, v200
    v_add_f32 v197, v197, v201
    v_mfma_f32_32x32x16_bf16 a[64:79], a[208:211], v[184:187], a[64:79]
    ds_read_b64_tr_b16 a[208:209], v220 offset:12288
    s_waitcnt lgkmcnt(7)
    v_lshlrev_b32 v205, 16, v210
    v_add_f32 v20, v20, v205
    v_fma_f32 v199, v19, s36, v193
    v_exp_f32 v203, v198
    v_add_f32 v197, v197, v202
    v_cvt_pk_bf16_f32 v144, v201, v202
    v_and_b32 v205, 0xffff0000, v210
    s_waitcnt lgkmcnt(6)
    v_mfma_f32_32x32x16_bf16 a[16:31], a[212:215], v[168:171], a[16:31]
    ds_read_b64_tr_b16 a[210:211], v220 offset:14336
    v_add_f32 v21, v21, v205
    v_fma_f32 v200, v20, s36, v193
    v_exp_f32 v204, v199
    v_add_f32 v197, v197, v203
    ds_read_b64_tr_b16 v[208:209], v227 offset:3072
    v_lshlrev_b32 v205, 16, v211
    v_add_f32 v22, v22, v205
    v_mfma_f32_32x32x16_bf16 a[80:95], a[212:215], v[184:187], a[80:95]
    ds_read_b64_tr_b16 a[212:213], v221 offset:12288
    v_fma_f32 v198, v21, s36, v193
    v_exp_f32 v201, v200
    v_add_f32 v197, v197, v204
    v_cvt_pk_bf16_f32 v145, v203, v204
    v_and_b32 v205, 0xffff0000, v211
    v_add_f32 v23, v23, v205
    v_fma_f32 v199, v22, s36, v193
    s_waitcnt lgkmcnt(7)
    v_mfma_f32_32x32x16_bf16 a[32:47], a[216:219], v[168:171], a[32:47]
    ds_read_b64_tr_b16 a[214:215], v221 offset:14336
    s_add_u32 m0, s49, 1024
    s_nop 0
    buffer_load_dwordx4 v242, s[24:27], 0 offen lds
    v_exp_f32 v202, v198
    v_add_f32 v197, v197, v201
    s_waitcnt lgkmcnt(6)
    v_lshlrev_b32 v205, 16, v206
    v_add_f32 v24, v24, v205
    v_fma_f32 v200, v23, s36, v193
    v_mfma_f32_32x32x16_bf16 a[96:111], a[216:219], v[184:187], a[96:111]
    ds_read_b64_tr_b16 a[216:217], v222 offset:12288
    v_exp_f32 v203, v199
    v_add_f32 v197, v197, v202
    v_cvt_pk_bf16_f32 v146, v201, v202
    v_and_b32 v205, 0xffff0000, v206
    v_add_f32 v25, v25, v205
    v_fma_f32 v198, v24, s36, v193
    s_waitcnt lgkmcnt(6)
    v_mfma_f32_32x32x16_bf16 a[48:63], a[220:223], v[168:171], a[48:63]
    ds_read_b64_tr_b16 a[218:219], v222 offset:14336
    v_exp_f32 v204, v200
    v_add_f32 v197, v197, v203
    v_lshlrev_b32 v205, 16, v207
    v_add_f32 v26, v26, v205
    v_fma_f32 v199, v25, s36, v193
    v_exp_f32 v201, v198
    v_mfma_f32_32x32x16_bf16 a[112:127], a[220:223], v[184:187], a[112:127]
    ds_read_b64_tr_b16 a[220:221], v223 offset:12288
    s_waitcnt vmcnt(12)
    v_and_b32 v252, 0x7ff, v244
    v_lshl_add_u32 v228, v252, 8, v236
    v_lshl_add_u32 v232, v252, 8, v240
    v_and_b32 v252, 0x7ff, v245
    v_lshl_add_u32 v229, v252, 8, v237
    v_lshl_add_u32 v233, v252, 8, v240
    v_and_b32 v252, 0x7ff, v246
    v_lshl_add_u32 v230, v252, 8, v238
    v_lshl_add_u32 v234, v252, 8, v240
    v_and_b32 v252, 0x7ff, v247
    v_lshl_add_u32 v231, v252, 8, v239
    v_lshl_add_u32 v235, v252, 8, v240
    s_waitcnt lgkmcnt(6)
    v_mfma_f32_32x32x16_bf16 a[0:15], a[208:211], v[172:175], a[0:15]
    ds_read_b64_tr_b16 a[222:223], v223 offset:14336
    v_add_f32 v197, v197, v204
    v_cvt_pk_bf16_f32 v147, v203, v204
    v_and_b32 v205, 0xffff0000, v207
    v_add_f32 v27, v27, v205
    v_fma_f32 v200, v26, s36, v193
    v_exp_f32 v202, v199
    v_add_f32 v197, v197, v201
    v_mfma_f32_32x32x16_bf16 a[64:79], a[208:211], v[188:191], a[64:79]
    s_waitcnt vmcnt(11)
    v_lshl_add_u32 v241, v248, 12, v243
    s_waitcnt vmcnt(10)
    v_lshl_add_u32 v242, v249, 12, v243
    v_add_u32 v250, 0x100, v250
    v_add_u32 v251, 0x100, v251
    s_waitcnt lgkmcnt(6)
    v_lshlrev_b32 v205, 16, v208
    v_add_f32 v28, v28, v205
    v_fma_f32 v198, v27, s36, v193
    v_exp_f32 v203, v200
    v_add_f32 v197, v197, v202
    s_waitcnt lgkmcnt(4)
    v_mfma_f32_32x32x16_bf16 a[16:31], a[212:215], v[172:175], a[16:31]
    v_cvt_pk_bf16_f32 v148, v201, v202
    v_and_b32 v205, 0xffff0000, v208
    v_add_f32 v29, v29, v205
    v_fma_f32 v199, v28, s36, v193
    v_exp_f32 v204, v198
    v_add_f32 v197, v197, v203
    v_lshlrev_b32 v205, 16, v209
    v_add_f32 v30, v30, v205
    v_fma_f32 v200, v29, s36, v193
    v_mfma_f32_32x32x16_bf16 a[80:95], a[212:215], v[188:191], a[80:95]
    s_waitcnt lgkmcnt(0)
    s_barrier
    s_mov_b32 s42, s41
    s_add_u32 s46, s40, 0x8000
    s_and_b32 s46, s46, 0x1ffff
    s_sub_u32 s41, s46, s40
    s_mov_b32 s40, s46
    s_add_u32 s43, s43, 0x8000
    s_and_b32 s43, s43, 0x1ffff
    s_add_u32 s48, s43, s53
    s_lshr_b32 s46, s43, 2
    s_add_u32 s46, s46, s54
    s_add_u32 s49, s46, 0x20000
    s_ashr_i32 s44, s41, 2
    s_ashr_i32 s45, s42, 2
    v_add_u32 v212, s41, v212
    v_add_u32 v213, s41, v213
    v_add_u32 v214, s41, v214
    v_mfma_f32_32x32x16_bf16 a[32:47], a[216:219], v[172:175], a[32:47]
    ds_read_b128 a[192:195], v212 offset:0
    ds_read_b128 a[196:199], v213 offset:0
    v_add_u32 v215, s41, v215
    v_add_u32 v216, s41, v216
    v_add_u32 v217, s41, v217
    v_mfma_f32_32x32x16_bf16 a[96:111], a[216:219], v[188:191], a[96:111]
    ds_read_b128 a[200:203], v214 offset:0
    v_add_u32 v218, s41, v218
    v_add_u32 v219, s41, v219
    v_add_u32 v220, s42, v220
    v_add_u32 v221, s42, v221
    v_mfma_f32_32x32x16_bf16 a[48:63], a[220:223], v[172:175], a[48:63]
    v_add_u32 v222, s42, v222
    v_add_u32 v223, s42, v223
    v_add_u32 v224, s45, v224
    v_add_u32 v225, s45, v225
    v_add_u32 v226, s44, v226
    v_add_u32 v227, s44, v227
    v_exp_f32 v201, v199
    v_add_f32 v197, v197, v204
    v_cvt_pk_bf16_f32 v149, v203, v204
    v_and_b32 v205, 0xffff0000, v209
    v_add_f32 v31, v31, v205
    v_fma_f32 v198, v30, s36, v193
    v_exp_f32 v202, v200
    v_add_f32 v197, v197, v201
    v_fma_f32 v199, v31, s36, v193
    v_exp_f32 v203, v198
    v_add_f32 v197, v197, v202
    v_cvt_pk_bf16_f32 v150, v201, v202
    v_exp_f32 v204, v199
    v_add_f32 v197, v197, v203
    v_add_f32 v197, v197, v204
    v_cvt_pk_bf16_f32 v151, v203, v204
    v_mfma_f32_32x32x16_bf16 a[112:127], a[220:223], v[188:191], a[112:127]
    s_cmp_eq_u32 s39, 0
    s_cbranch_scc1 EPI
LOOP_E:
    ds_read_b128 a[204:207], v215 offset:0
    ds_read_b64_tr_b16 v[206:207], v224 offset:4096
    ds_read_b64_tr_b16 v[208:209], v224 offset:5120
    ds_read_b64_tr_b16 v[210:211], v224 offset:6144
    s_waitcnt lgkmcnt(2)
    v_lshlrev_b32 v205, 16, v206
    v_add_f32 v32, v32, v205
    v_and_b32 v205, 0xffff0000, v206
    v_mfma_f32_32x32x16_bf16 v[64:79], a[192:195], a[128:131], 0
    s_add_u32 m0, s48, 0
    s_nop 0
    buffer_load_dwordx4 v228, s[16:19], 0 offen lds
    buffer_load_dwordx4 v[244:247], v250, s[76:79], 0 offen
    buffer_load_dword v248, v251, s[76:79], 0 offen
    buffer_load_dword v249, v251, s[76:79], 0 offen offset:8
    v_add_f32 v33, v33, v205
    v_fma_f32 v198, v32, s36, v192
    v_lshlrev_b32 v205, 16, v207
    v_mfma_f32_32x32x16_bf16 v[80:95], a[192:195], a[160:163], 0
    ds_read_b128 a[192:195], v216 offset:0
    v_add_f32 v34, v34, v205
    v_fma_f32 v199, v33, s36, v192
    v_exp_f32 v201, v198
    v_and_b32 v205, 0xffff0000, v207
    v_add_f32 v35, v35, v205
    v_mfma_f32_32x32x16_bf16 v[64:79], a[196:199], a[132:135], v[64:79]
    v_fma_f32 v200, v34, s36, v192
    v_exp_f32 v202, v199
    v_add_f32 v196, v196, v201
    s_waitcnt lgkmcnt(2)
    v_lshlrev_b32 v205, 16, v208
    v_add_f32 v36, v36, v205
    v_fma_f32 v198, v35, s36, v192
    v_mfma_f32_32x32x16_bf16 v[80:95], a[196:199], a[164:167], v[80:95]
    ds_read_b128 a[196:199], v217 offset:0
    v_exp_f32 v203, v200
    v_add_f32 v196, v196, v202
    v_cvt_pk_bf16_f32 v136, v201, v202
    v_and_b32 v205, 0xffff0000, v208
    v_add_f32 v37, v37, v205
    v_mfma_f32_32x32x16_bf16 v[64:79], a[200:203], a[136:139], v[64:79]
    v_fma_f32 v199, v36, s36, v192
    v_exp_f32 v204, v198
    v_add_f32 v196, v196, v203
    ds_read_b64_tr_b16 v[206:207], v224 offset:7168
    v_lshlrev_b32 v205, 16, v209
    v_add_f32 v38, v38, v205
    v_mfma_f32_32x32x16_bf16 v[80:95], a[200:203], a[168:171], v[80:95]
    ds_read_b128 a[200:203], v218 offset:0
    v_fma_f32 v200, v37, s36, v192
    v_exp_f32 v201, v199
    v_add_f32 v196, v196, v204
    v_cvt_pk_bf16_f32 v137, v203, v204
    v_and_b32 v205, 0xffff0000, v209
    v_mfma_f32_32x32x16_bf16 v[64:79], a[204:207], a[140:143], v[64:79]
    s_add_u32 m0, s48, 1024
    s_nop 0
    buffer_load_dwordx4 v229, s[16:19], 0 offen lds
    v_add_f32 v39, v39, v205
    v_fma_f32 v198, v38, s36, v192
    v_exp_f32 v202, v200
    v_add_f32 v196, v196, v201
    s_waitcnt lgkmcnt(4)
    v_lshlrev_b32 v205, 16, v210
    v_mfma_f32_32x32x16_bf16 v[80:95], a[204:207], a[172:175], v[80:95]
    ds_read_b128 a[204:207], v219 offset:0
    v_add_f32 v40, v40, v205
    v_fma_f32 v199, v39, s36, v192
    v_exp_f32 v203, v198
    v_add_f32 v196, v196, v202
    v_cvt_pk_bf16_f32 v138, v201, v202
    s_waitcnt lgkmcnt(4)
    v_mfma_f32_32x32x16_bf16 v[64:79], a[192:195], a[144:147], v[64:79]
    v_and_b32 v205, 0xffff0000, v210
    v_add_f32 v41, v41, v205
    v_fma_f32 v200, v40, s36, v192
    v_exp_f32 v204, v199
    v_add_f32 v196, v196, v203
    ds_read_b64_tr_b16 v[208:209], v225 offset:4096
    v_mfma_f32_32x32x16_bf16 v[80:95], a[192:195], a[176:179], v[80:95]
    ds_read_b128 a[192:195], v212 offset:8192
    v_lshlrev_b32 v205, 16, v211
    v_add_f32 v42, v42, v205
    v_fma_f32 v198, v41, s36, v192
    v_exp_f32 v201, v200
    v_add_f32 v196, v196, v204
    s_waitcnt lgkmcnt(5)
    v_mfma_f32_32x32x16_bf16 v[64:79], a[196:199], a[148:151], v[64:79]
    s_add_u32 m0, s48, 2048
    s_nop 0
    buffer_load_dwordx4 v230, s[16:19], 0 offen lds
    v_cvt_pk_bf16_f32 v139, v203, v204
    v_and_b32 v205, 0xffff0000, v211
    v_add_f32 v43, v43, v205
    v_fma_f32 v199, v42, s36, v192
    v_exp_f32 v202, v198
    v_mfma_f32_32x32x16_bf16 v[80:95], a[196:199], a[180:183], v[80:95]
    ds_read_b128 a[196:199], v213 offset:8192
    v_add_f32 v196, v196, v201
    s_waitcnt lgkmcnt(5)
    v_lshlrev_b32 v205, 16, v206
    v_add_f32 v44, v44, v205
    v_fma_f32 v200, v43, s36, v192
    v_exp_f32 v203, v199
    s_waitcnt lgkmcnt(4)
    v_mfma_f32_32x32x16_bf16 v[64:79], a[200:203], a[152:155], v[64:79]
    v_add_f32 v196, v196, v202
    v_cvt_pk_bf16_f32 v140, v201, v202
    v_and_b32 v205, 0xffff0000, v206
    v_add_f32 v45, v45, v205
    v_fma_f32 v198, v44, s36, v192
    v_exp_f32 v204, v200
    v_mfma_f32_32x32x16_bf16 v[80:95], a[200:203], a[184:187], v[80:95]
    ds_read_b128 a[200:203], v214 offset:8192
    v_add_f32 v196, v196, v203
    ds_read_b64_tr_b16 v[210:211], v225 offset:5120
    v_lshlrev_b32 v205, 16, v207
    v_add_f32 v46, v46, v205
    v_fma_f32 v199, v45, s36, v192
    s_waitcnt lgkmcnt(5)
    v_mfma_f32_32x32x16_bf16 v[64:79], a[204:207], a[156:159], v[64:79]
    v_exp_f32 v201, v198
    v_add_f32 v196, v196, v204
    v_cvt_pk_bf16_f32 v141, v203, v204
    v_and_b32 v205, 0xffff0000, v207
    v_add_f32 v47, v47, v205
    v_fma_f32 v200, v46, s36, v192
    v_mfma_f32_32x32x16_bf16 v[80:95], a[204:207], a[188:191], v[80:95]
    ds_read_b128 a[204:207], v215 offset:8192
    v_exp_f32 v202, v199
    v_add_f32 v196, v196, v201
    s_waitcnt lgkmcnt(5)
    v_lshlrev_b32 v205, 16, v208
    v_add_f32 v48, v48, v205
    v_fma_f32 v198, v47, s36, v192
    s_waitcnt lgkmcnt(4)
    v_mfma_f32_32x32x16_bf16 v[96:111], a[192:195], a[128:131], 0
    s_add_u32 m0, s48, 3072
    s_nop 0
    buffer_load_dwordx4 v231, s[16:19], 0 offen lds
    v_exp_f32 v203, v200
    v_add_f32 v196, v196, v202
    v_cvt_pk_bf16_f32 v142, v201, v202
    v_and_b32 v205, 0xffff0000, v208
    v_add_f32 v49, v49, v205
    v_mfma_f32_32x32x16_bf16 v[112:127], a[192:195], a[160:163], 0
    ds_read_b128 a[192:195], v216 offset:8192
    v_fma_f32 v199, v48, s36, v193
    v_exp_f32 v204, v198
    v_add_f32 v196, v196, v203
    ds_read_b64_tr_b16 v[206:207], v225 offset:6144
    v_lshlrev_b32 v205, 16, v209
    s_waitcnt lgkmcnt(5)
    v_mfma_f32_32x32x16_bf16 v[96:111], a[196:199], a[132:135], v[96:111]
    v_add_f32 v50, v50, v205
    v_fma_f32 v200, v49, s36, v193
    v_exp_f32 v201, v199
    v_add_f32 v196, v196, v204
    v_cvt_pk_bf16_f32 v143, v203, v204
    v_and_b32 v205, 0xffff0000, v209
    v_mfma_f32_32x32x16_bf16 v[112:127], a[196:199], a[164:167], v[112:127]
    ds_read_b128 a[196:199], v217 offset:8192
    v_add_f32 v51, v51, v205
    v_fma_f32 v198, v50, s36, v193
    v_exp_f32 v202, v200
    v_add_f32 v197, v197, v201
    s_waitcnt lgkmcnt(4)
    v_lshlrev_b32 v205, 16, v210
    v_mfma_f32_32x32x16_bf16 v[96:111], a[200:203], a[136:139], v[96:111]
    s_add_u32 m0, s48, 16384
    s_nop 0
    buffer_load_dwordx4 v232, s[20:23], 0 offen lds
    v_add_f32 v52, v52, v205
    v_fma_f32 v199, v51, s36, v193
    v_exp_f32 v203, v198
    v_add_f32 v197, v197, v202
    v_cvt_pk_bf16_f32 v152, v201, v202
    v_mfma_f32_32x32x16_bf16 v[112:127], a[200:203], a[168:171], v[112:127]
    ds_read_b128 a[200:203], v218 offset:8192
    v_and_b32 v205, 0xffff0000, v210
    v_add_f32 v53, v53, v205
    v_fma_f32 v200, v52, s36, v193
    v_exp_f32 v204, v199
    v_add_f32 v197, v197, v203
    s_waitcnt lgkmcnt(4)
    v_mfma_f32_32x32x16_bf16 v[96:111], a[204:207], a[140:143], v[96:111]
    ds_read_b64_tr_b16 v[208:209], v225 offset:7168
    v_lshlrev_b32 v205, 16, v211
    v_add_f32 v54, v54, v205
    v_fma_f32 v198, v53, s36, v193
    v_exp_f32 v201, v200
    v_add_f32 v197, v197, v204
    v_mfma_f32_32x32x16_bf16 v[112:127], a[204:207], a[172:175], v[112:127]
    ds_read_b128 a[204:207], v219 offset:8192
    v_cvt_pk_bf16_f32 v153, v203, v204
    v_and_b32 v205, 0xffff0000, v211
    v_add_f32 v55, v55, v205
    v_fma_f32 v199, v54, s36, v193
    v_exp_f32 v202, v198
    s_waitcnt lgkmcnt(5)
    v_mfma_f32_32x32x16_bf16 v[96:111], a[192:195], a[144:147], v[96:111]
    v_add_f32 v197, v197, v201
    s_waitcnt lgkmcnt(4)
    v_lshlrev_b32 v205, 16, v206
    v_add_f32 v56, v56, v205
    v_fma_f32 v200, v55, s36, v193
    v_exp_f32 v203, v199
    v_add_f32 v197, v197, v202
    v_mfma_f32_32x32x16_bf16 v[112:127], a[192:195], a[176:179], v[112:127]
    v_cvt_pk_bf16_f32 v154, v201, v202
    v_and_b32 v205, 0xffff0000, v206
    v_add_f32 v57, v57, v205
    v_fma_f32 v198, v56, s36, v193
    v_exp_f32 v204, v200
    v_add_f32 v197, v197, v203
    s_waitcnt lgkmcnt(3)
    v_mfma_f32_32x32x16_bf16 v[96:111], a[196:199], a[148:151], v[96:111]
    v_lshlrev_b32 v205, 16, v207
    v_add_f32 v58, v58, v205
    v_fma_f32 v199, v57, s36, v193
    v_exp_f32 v201, v198
    v_add_f32 v197, v197, v204
    v_cvt_pk_bf16_f32 v155, v203, v204
    v_mfma_f32_32x32x16_bf16 v[112:127], a[196:199], a[180:183], v[112:127]
    ds_read_b64_tr_b16 a[208:209], v220 offset:0
    v_and_b32 v205, 0xffff0000, v207
    v_add_f32 v59, v59, v205
    v_fma_f32 v200, v58, s36, v193
    v_exp_f32 v202, v199
    v_add_f32 v197, v197, v201
    s_waitcnt lgkmcnt(3)
    v_mfma_f32_32x32x16_bf16 v[96:111], a[200:203], a[152:155], v[96:111]
    ds_read_b64_tr_b16 a[210:211], v220 offset:2048
    ds_read_b64_tr_b16 a[212:213], v221 offset:0
    s_waitcnt lgkmcnt(4)
    v_lshlrev_b32 v205, 16, v208
    v_add_f32 v60, v60, v205
    v_fma_f32 v198, v59, s36, v193
    v_mfma_f32_32x32x16_bf16 v[112:127], a[200:203], a[184:187], v[112:127]
    ds_read_b64_tr_b16 a[214:215], v221 offset:2048
    ds_read_b64_tr_b16 a[216:217], v222 offset:0
    v_exp_f32 v203, v200
    v_add_f32 v197, v197, v202
    v_cvt_pk_bf16_f32 v156, v201, v202
    s_waitcnt lgkmcnt(5)
    v_mfma_f32_32x32x16_bf16 v[96:111], a[204:207], a[156:159], v[96:111]
    ds_read_b64_tr_b16 a[218:219], v222 offset:2048
    v_and_b32 v205, 0xffff0000, v208
    v_add_f32 v61, v61, v205
    v_fma_f32 v199, v60, s36, v193
    v_exp_f32 v204, v198
    v_add_f32 v197, v197, v203
    v_lshlrev_b32 v205, 16, v209
    v_add_f32 v62, v62, v205
    v_fma_f32 v200, v61, s36, v193
    v_exp_f32 v201, v199
    v_add_f32 v197, v197, v204
    v_cvt_pk_bf16_f32 v157, v203, v204
    v_and_b32 v205, 0xffff0000, v209
    v_add_f32 v63, v63, v205
    v_fma_f32 v198, v62, s36, v193
    v_exp_f32 v202, v200
    v_add_f32 v197, v197, v201
    v_fma_f32 v199, v63, s36, v193
    v_exp_f32 v203, v198
    v_add_f32 v197, v197, v202
    v_cvt_pk_bf16_f32 v158, v201, v202
    v_exp_f32 v204, v199
    v_add_f32 v197, v197, v203
    v_add_f32 v197, v197, v204
    v_cvt_pk_bf16_f32 v159, v203, v204
    v_mfma_f32_32x32x16_bf16 v[112:127], a[204:207], a[188:191], v[112:127]
    v_cmp_lt_f32 vcc, 0x45800000, v196
    v_cmp_lt_f32 s[44:45], s47, v197
    s_or_b64 vcc, vcc, s[44:45]
    s_cbranch_vccnz RARE_E0
    v_add_f32 v194, v194, v196
    v_mov_b32 v196, 0
    v_add_f32 v195, v195, v197
    v_mov_b32 v197, 0
BACK_E0:
    ds_read_b64_tr_b16 a[220:221], v223 offset:0
    ds_read_b64_tr_b16 v[206:207], v226 offset:0
    ds_read_b64_tr_b16 v[208:209], v226 offset:1024
    ds_read_b64_tr_b16 v[210:211], v226 offset:2048
    s_waitcnt lgkmcnt(2)
    v_lshlrev_b32 v205, 16, v206
    v_add_f32 v64, v64, v205
    v_and_b32 v205, 0xffff0000, v206
    v_add_f32 v65, v65, v205
    v_mfma_f32_32x32x16_bf16 a[0:15], a[208:211], v[128:131], a[0:15]
    ds_read_b64_tr_b16 a[222:223], v223 offset:2048
    s_add_u32 m0, s48, 17408
    s_nop 0
    buffer_load_dwordx4 v233, s[20:23], 0 offen lds
    v_fma_f32 v198, v64, s36, v192
    v_lshlrev_b32 v205, 16, v207
    v_add_f32 v66, v66, v205
    v_fma_f32 v199, v65, s36, v192
    v_exp_f32 v201, v198
    v_mfma_f32_32x32x16_bf16 a[64:79], a[208:211], v[144:147], a[64:79]
    ds_read_b64_tr_b16 a[208:209], v220 offset:4096
    v_and_b32 v205, 0xffff0000, v207
    v_add_f32 v67, v67, v205
    v_fma_f32 v200, v66, s36, v192
    v_exp_f32 v202, v199
    v_add_f32 v196, v196, v201
    s_waitcnt lgkmcnt(3)
    v_lshlrev_b32 v205, 16, v208
    v_add_f32 v68, v68, v205
    v_mfma_f32_32x32x16_bf16 a[16:31], a[212:215], v[128:131], a[16:31]
    ds_read_b64_tr_b16 a[210:211], v220 offset:6144
    v_fma_f32 v198, v67, s36, v192
    v_exp_f32 v203, v200
    v_add_f32 v196, v196, v202
    v_cvt_pk_bf16_f32 v160, v201, v202
    v_and_b32 v205, 0xffff0000, v208
    v_add_f32 v69, v69, v205
    v_fma_f32 v199, v68, s36, v192
    v_mfma_f32_32x32x16_bf16 a[80:95], a[212:215], v[144:147], a[80:95]
    ds_read_b64_tr_b16 a[212:213], v221 offset:4096
    v_exp_f32 v204, v198
    v_add_f32 v196, v196, v203
    ds_read_b64_tr_b16 v[206:207], v226 offset:3072
    v_lshlrev_b32 v205, 16, v209
    v_add_f32 v70, v70, v205
    v_fma_f32 v200, v69, s36, v192
    v_mfma_f32_32x32x16_bf16 a[32:47], a[216:219], v[128:131], a[32:47]
    ds_read_b64_tr_b16 a[214:215], v221 offset:6144
    v_exp_f32 v201, v199
    v_add_f32 v196, v196, v204
    v_cvt_pk_bf16_f32 v161, v203, v204
    v_and_b32 v205, 0xffff0000, v209
    v_add_f32 v71, v71, v205
    v_fma_f32 v198, v70, s36, v192
    v_mfma_f32_32x32x16_bf16 a[96:111], a[216:219], v[144:147], a[96:111]
    ds_read_b64_tr_b16 a[216:217], v222 offset:4096
    s_add_u32 m0, s48, 18432
    s_nop 0
    buffer_load_dwordx4 v234, s[20:23], 0 offen lds
    v_exp_f32 v202, v200
    v_add_f32 v196, v196, v201
    s_waitcnt lgkmcnt(7)
    v_lshlrev_b32 v205, 16, v210
    v_add_f32 v72, v72, v205
    v_fma_f32 v199, v71, s36, v192
    s_waitcnt lgkmcnt(6)
    v_mfma_f32_32x32x16_bf16 a[48:63], a[220:223], v[128:131], a[48:63]
    ds_read_b64_tr_b16 a[218:219], v222 offset:6144
    v_exp_f32 v203, v198
    v_add_f32 v196, v196, v202
    v_cvt_pk_bf16_f32 v162, v201, v202
    v_and_b32 v205, 0xffff0000, v210
    v_add_f32 v73, v73, v205
    v_fma_f32 v200, v72, s36, v192
    v_mfma_f32_32x32x16_bf16 a[112:127], a[220:223], v[144:147], a[112:127]
    ds_read_b64_tr_b16 a[220:221], v223 offset:4096
    v_exp_f32 v204, v199
    v_add_f32 v196, v196, v203
    ds_read_b64_tr_b16 v[208:209], v227 offset:0
    v_lshlrev_b32 v205, 16, v211
    v_add_f32 v74, v74, v205
    v_fma_f32 v198, v73, s36, v192
    s_waitcnt lgkmcnt(7)
    v_mfma_f32_32x32x16_bf16 a[0:15], a[208:211], v[132:135], a[0:15]
    ds_read_b64_tr_b16 a[222:223], v223 offset:6144
    v_exp_f32 v201, v200
    v_add_f32 v196, v196, v204
    v_cvt_pk_bf16_f32 v163, v203, v204
    v_and_b32 v205, 0xffff0000, v211
    v_add_f32 v75, v75, v205
    v_fma_f32 v199, v74, s36, v192
    v_mfma_f32_32x32x16_bf16 a[64:79], a[208:211], v[148:151], a[64:79]
    ds_read_b64_tr_b16 a[208:209], v220 offset:8192
    v_exp_f32 v202, v198
    v_add_f32 v196, v196, v201
    s_waitcnt lgkmcnt(7)
    v_lshlrev_b32 v205, 16, v206
    v_add_f32 v76, v76, v205
    v_fma_f32 v200, v75, s36, v192
    v_exp_f32 v203, v199
    s_waitcnt lgkmcnt(6)
    v_mfma_f32_32x32x16_bf16 a[16:31], a[212:215], v[132:135], a[16:31]
    ds_read_b64_tr_b16 a[210:211], v220 offset:10240
    s_add_u32 m0, s48, 19456
    s_nop 0
    buffer_load_dwordx4 v235, s[20:23], 0 offen lds
    v_add_f32 v196, v196, v202
    v_cvt_pk_bf16_f32 v164, v201, v202
    v_and_b32 v205, 0xffff0000, v206
    v_add_f32 v77, v77, v205
    v_fma_f32 v198, v76, s36, v192
    v_mfma_f32_32x32x16_bf16 a[80:95], a[212:215], v[148:151], a[80:95]
    ds_read_b64_tr_b16 a[212:213], v221 offset:8192
    v_exp_f32 v204, v200
    v_add_f32 v196, v196, v203
    ds_read_b64_tr_b16 v[210:211], v227 offset:1024
    v_lshlrev_b32 v205, 16, v207
    v_add_f32 v78, v78, v205
    v_fma_f32 v199, v77, s36, v192
    s_waitcnt lgkmcnt(7)
    v_mfma_f32_32x32x16_bf16 a[32:47], a[216:219], v[132:135], a[32:47]
    ds_read_b64_tr_b16 a[214:215], v221 offset:10240
    v_exp_f32 v201, v198
    v_add_f32 v196, v196, v204
    v_cvt_pk_bf16_f32 v165, v203, v204
    v_and_b32 v205, 0xffff0000, v207
    v_add_f32 v79, v79, v205
    v_fma_f32 v200, v78, s36, v192
    v_mfma_f32_32x32x16_bf16 a[96:111], a[216:219], v[148:151], a[96:111]
    ds_read_b64_tr_b16 a[216:217], v222 offset:8192
    v_exp_f32 v202, v199
    v_add_f32 v196, v196, v201
    s_waitcnt lgkmcnt(7)
    v_lshlrev_b32 v205, 16, v208
    v_add_f32 v80, v80, v205
    v_fma_f32 v198, v79, s36, v192
    v_exp_f32 v203, v200
    s_waitcnt lgkmcnt(6)
    v_mfma_f32_32x32x16_bf16 a[48:63], a[220:223], v[132:135], a[48:63]
    ds_read_b64_tr_b16 a[218:219], v222 offset:10240
    v_add_f32 v196, v196, v202
    v_cvt_pk_bf16_f32 v166, v201, v202
    v_and_b32 v205, 0xffff0000, v208
    v_add_f32 v81, v81, v205
    v_fma_f32 v199, v80, s36, v193
    v_exp_f32 v204, v198
    v_add_f32 v196, v196, v203
    v_mfma_f32_32x32x16_bf16 a[112:127], a[220:223], v[148:151], a[112:127]
    ds_read_b64_tr_b16 a[220:221], v223 offset:8192
    s_add_u32 m0, s49, 0
    s_nop 0
    buffer_load_dwordx4 v241, s[24:27], 0 offen lds
    ds_read_b64_tr_b16 v[206:207], v227 offset:2048
    v_lshlrev_b32 v205, 16, v209
    v_add_f32 v82, v82, v205
    v_fma_f32 v200, v81, s36, v193
    v_exp_f32 v201, v199
    s_waitcnt lgkmcnt(7)
    v_mfma_f32_32x32x16_bf16 a[0:15], a[208:211], v[136:139], a[0:15]
    ds_read_b64_tr_b16 a[222:223], v223 offset:10240
    v_add_f32 v196, v196, v204
    v_cvt_pk_bf16_f32 v167, v203, v204
    v_and_b32 v205, 0xffff0000, v209
    v_add_f32 v83, v83, v205
    v_fma_f32 v198, v82, s36, v193
    v_exp_f32 v202, v200
    v_add_f32 v197, v197, v201
    v_mfma_f32_32x32x16_bf16 a[64:79], a[208:211], v[152:155], a[64:79]
    ds_read_b64_tr_b16 a[208:209], v220 offset:12288
    s_waitcnt lgkmcnt(7)
    v_lshlrev_b32 v205, 16, v210
    v_add_f32 v84, v84, v205
    v_fma_f32 v199, v83, s36, v193
    v_exp_f32 v203, v198
    v_add_f32 v197, v197, v202
    v_cvt_pk_bf16_f32 v176, v201, v202
    v_and_b32 v205, 0xffff0000, v210
    s_waitcnt lgkmcnt(6)
    v_mfma_f32_32x32x16_bf16 a[16:31], a[212:215], v[136:139], a[16:31]
    ds_read_b64_tr_b16 a[210:211], v220 offset:14336
    v_add_f32 v85, v85, v205
    v_fma_f32 v200, v84, s36, v193
    v_exp_f32 v204, v199
    v_add_f32 v197, v197, v203
    ds_read_b64_tr_b16 v[208:209], v227 offset:3072
    v_lshlrev_b32 v205, 16, v211
    v_add_f32 v86, v86, v205
    v_mfma_f32_32x32x16_bf16 a[80:95], a[212:215], v[152:155], a[80:95]
    ds_read_b64_tr_b16 a[212:213], v221 offset:12288
    v_fma_f32 v198, v85, s36, v193
    v_exp_f32 v201, v200
    v_add_f32 v197, v197, v204
    v_cvt_pk_bf16_f32 v177, v203, v204
    v_and_b32 v205, 0xffff0000, v211
    v_add_f32 v87, v87, v205
    v_fma_f32 v199, v86, s36, v193
    s_waitcnt lgkmcnt(7)
    v_mfma_f32_32x32x16_bf16 a[32:47], a[216:219], v[136:139], a[32:47]
    ds_read_b64_tr_b16 a[214:215], v221 offset:14336
    s_add_u32 m0, s49, 1024
    s_nop 0
    buffer_load_dwordx4 v242, s[24:27], 0 offen lds
    v_exp_f32 v202, v198
    v_add_f32 v197, v197, v201
    s_waitcnt lgkmcnt(6)
    v_lshlrev_b32 v205, 16, v206
    v_add_f32 v88, v88, v205
    v_fma_f32 v200, v87, s36, v193
    v_mfma_f32_32x32x16_bf16 a[96:111], a[216:219], v[152:155], a[96:111]
    ds_read_b64_tr_b16 a[216:217], v222 offset:12288
    v_exp_f32 v203, v199
    v_add_f32 v197, v197, v202
    v_cvt_pk_bf16_f32 v178, v201, v202
    v_and_b32 v205, 0xffff0000, v206
    v_add_f32 v89, v89, v205
    v_fma_f32 v198, v88, s36, v193
    s_waitcnt lgkmcnt(6)
    v_mfma_f32_32x32x16_bf16 a[48:63], a[220:223], v[136:139], a[48:63]
    ds_read_b64_tr_b16 a[218:219], v222 offset:14336
    v_exp_f32 v204, v200
    v_add_f32 v197, v197, v203
    v_lshlrev_b32 v205, 16, v207
    v_add_f32 v90, v90, v205
    v_fma_f32 v199, v89, s36, v193
    v_exp_f32 v201, v198
    v_mfma_f32_32x32x16_bf16 a[112:127], a[220:223], v[152:155], a[112:127]
    ds_read_b64_tr_b16 a[220:221], v223 offset:12288
    s_waitcnt vmcnt(11)
    v_and_b32 v252, 0x7ff, v244
    v_lshl_add_u32 v228, v252, 8, v236
    v_lshl_add_u32 v232, v252, 8, v240
    v_and_b32 v252, 0x7ff, v245
    v_lshl_add_u32 v229, v252, 8, v237
    v_lshl_add_u32 v233, v252, 8, v240
    v_and_b32 v252, 0x7ff, v246
    v_lshl_add_u32 v230, v252, 8, v238
    v_lshl_add_u32 v234, v252, 8, v240
    v_and_b32 v252, 0x7ff, v247
    v_lshl_add_u32 v231, v252, 8, v239
    v_lshl_add_u32 v235, v252, 8, v240
    s_waitcnt lgkmcnt(6)
    v_mfma_f32_32x32x16_bf16 a[0:15], a[208:211], v[140:143], a[0:15]
    ds_read_b64_tr_b16 a[222:223], v223 offset:14336
    v_add_f32 v197, v197, v204
    v_cvt_pk_bf16_f32 v179, v203, v204
    v_and_b32 v205, 0xffff0000, v207
    v_add_f32 v91, v91, v205
    v_fma_f32 v200, v90, s36, v193
    v_exp_f32 v202, v199
    v_add_f32 v197, v197, v201
    v_mfma_f32_32x32x16_bf16 a[64:79], a[208:211], v[156:159], a[64:79]
    s_waitcnt vmcnt(10)
    v_lshl_add_u32 v241, v248, 12, v243
    s_waitcnt vmcnt(9)
    v_lshl_add_u32 v242, v249, 12, v243
    v_add_u32 v250, 0x100, v250
    v_add_u32 v251, 0x100, v251
    s_waitcnt lgkmcnt(6)
    v_lshlrev_b32 v205, 16, v208
    v_add_f32 v92, v92, v205
    v_fma_f32 v198, v91, s36, v193
    v_exp_f32 v203, v200
    v_add_f32 v197, v197, v202
    s_waitcnt lgkmcnt(4)
    v_mfma_f32_32x32x16_bf16 a[16:31], a[212:215], v[140:143], a[16:31]
    v_cvt_pk_bf16_f32 v180, v201, v202
    v_and_b32 v205, 0xffff0000, v208
    v_add_f32 v93, v93, v205
    v_fma_f32 v199, v92, s36, v193
    v_exp_f32 v204, v198
    v_add_f32 v197, v197, v203
    v_lshlrev_b32 v205, 16, v209
    v_add_f32 v94, v94, v205
    v_fma_f32 v200, v93, s36, v193
    v_mfma_f32_32x32x16_bf16 a[80:95], a[212:215], v[156:159], a[80:95]
    s_waitcnt lgkmcnt(0)
    s_barrier
    s_mov_b32 s42, s41
    s_add_u32 s46, s40, 0x8000
    s_and_b32 s46, s46, 0x1ffff
    s_sub_u32 s41, s46, s40
    s_mov_b32 s40, s46
    s_add_u32 s43, s43, 0x8000
    s_and_b32 s43, s43, 0x1ffff
    s_add_u32 s48, s43, s53
    s_lshr_b32 s46, s43, 2
    s_add_u32 s46, s46, s54
    s_add_u32 s49, s46, 0x20000
    s_ashr_i32 s44, s41, 2
    s_ashr_i32 s45, s42, 2
    v_add_u32 v212, s41, v212
    v_add_u32 v213, s41, v213
    v_add_u32 v214, s41, v214
    v_mfma_f32_32x32x16_bf16 a[32:47], a[216:219], v[140:143], a[32:47]
    ds_read_b128 a[192:195], v212 offset:0
    ds_read_b128 a[196:199], v213 offset:0
    v_add_u32 v215, s41, v215
    v_add_u32 v216, s41, v216
    v_add_u32 v217, s41, v217
    v_mfma_f32_32x32x16_bf16 a[96:111], a[216:219], v[156:159], a[96:111]
    ds_read_b128 a[200:203], v214 offset:0
    v_add_u32 v218, s41, v218
    v_add_u32 v219, s41, v219
    v_add_u32 v220, s42, v220
    v_add_u32 v221, s42, v221
    v_mfma_f32_32x32x16_bf16 a[48:63], a[220:223], v[140:143], a[48:63]
    v_add_u32 v222, s42, v222
    v_add_u32 v223, s42, v223
    v_add_u32 v224, s45, v224
    v_add_u32 v225, s45, v225
    v_add_u32 v226, s44, v226
    v_add_u32 v227, s44, v227
    v_exp_f32 v201, v199
    v_add_f32 v197, v197, v204
    v_cvt_pk_bf16_f32 v181, v203, v204
    v_and_b32 v205, 0xffff0000, v209
    v_add_f32 v95, v95, v205
    v_fma_f32 v198, v94, s36, v193
    v_exp_f32 v202, v200
    v_add_f32 v197, v197, v201
    v_fma_f32 v199, v95, s36, v193
    v_exp_f32 v203, v198
    v_add_f32 v197, v197, v202
    v_cvt_pk_bf16_f32 v182, v201, v202
    v_exp_f32 v204, v199
    v_add_f32 v197, v197, v203
    v_add_f32 v197, v197, v204
    v_cvt_pk_bf16_f32 v183, v203, v204
    v_mfma_f32_32x32x16_bf16 a[112:127], a[220:223], v[156:159], a[112:127]
    s_sub_u32 s39, s39, 1
    s_cmp_eq_u32 s39, 0
    s_cbranch_scc1 EPI
    ds_read_b128 a[204:207], v215 offset:0
    ds_read_b64_tr_b16 v[206:207], v224 offset:4096
    ds_read_b64_tr_b16 v[208:209], v224 offset:5120
    ds_read_b64_tr_b16 v[210:211], v224 offset:6144
    s_waitcnt lgkmcnt(2)
    v_lshlrev_b32 v205, 16, v206
    v_add_f32 v96, v96, v205
    v_and_b32 v205, 0xffff0000, v206
    v_mfma_f32_32x32x16_bf16 v[0:15], a[192:195], a[128:131], 0
    s_add_u32 m0, s48, 0
    s_nop 0
    buffer_load_dwordx4 v228, s[16:19], 0 offen lds
    buffer_load_dwordx4 v[244:247], v250, s[76:79], 0 offen
    buffer_load_dword v248, v251, s[76:79], 0 offen
    buffer_load_dword v249, v251, s[76:79], 0 offen offset:8
    v_add_f32 v97, v97, v205
    v_fma_f32 v198, v96, s36, v192
    v_lshlrev_b32 v205, 16, v207
    v_mfma_f32_32x32x16_bf16 v[16:31], a[192:195], a[160:163], 0
    ds_read_b128 a[192:195], v216 offset:0
    v_add_f32 v98, v98, v205
    v_fma_f32 v199, v97, s36, v192
    v_exp_f32 v201, v198
    v_and_b32 v205, 0xffff0000, v207
    v_add_f32 v99, v99, v205
    v_mfma_f32_32x32x16_bf16 v[0:15], a[196:199], a[132:135], v[0:15]
    v_fma_f32 v200, v98, s36, v192
    v_exp_f32 v202, v199
    v_add_f32 v196, v196, v201
    s_waitcnt lgkmcnt(2)
    v_lshlrev_b32 v205, 16, v208
    v_add_f32 v100, v100, v205
    v_fma_f32 v198, v99, s36, v192
    v_mfma_f32_32x32x16_bf16 v[16:31], a[196:199], a[164:167], v[16:31]
    ds_read_b128 a[196:199], v217 offset:0
    v_exp_f32 v203, v200
    v_add_f32 v196, v196, v202
    v_cvt_pk_bf16_f32 v168, v201, v202
    v_and_b32 v205, 0xffff0000, v208
    v_add_f32 v101, v101, v205
    v_mfma_f32_32x32x16_bf16 v[0:15], a[200:203], a[136:139], v[0:15]
    v_fma_f32 v199, v100, s36, v192
    v_exp_f32 v204, v198
    v_add_f32 v196, v196, v203
    ds_read_b64_tr_b16 v[206:207], v224 offset:7168
    v_lshlrev_b32 v205, 16, v209
    v_add_f32 v102, v102, v205
    v_mfma_f32_32x32x16_bf16 v[16:31], a[200:203], a[168:171], v[16:31]
    ds_read_b128 a[200:203], v218 offset:0
    v_fma_f32 v200, v101, s36, v192
    v_exp_f32 v201, v199
    v_add_f32 v196, v196, v204
    v_cvt_pk_bf16_f32 v169, v203, v204
    v_and_b32 v205, 0xffff0000, v209
    v_mfma_f32_32x32x16_bf16 v[0:15], a[204:207], a[140:143], v[0:15]
    s_add_u32 m0, s48, 1024
    s_nop 0
    buffer_load_dwordx4 v229, s[16:19], 0 offen lds
    v_add_f32 v103, v103, v205
    v_fma_f32 v198, v102, s36, v192
    v_exp_f32 v202, v200
    v_add_f32 v196, v196, v201
    s_waitcnt lgkmcnt(4)
    v_lshlrev_b32 v205, 16, v210
    v_mfma_f32_32x32x16_bf16 v[16:31], a[204:207], a[172:175], v[16:31]
    ds_read_b128 a[204:207], v219 offset:0
    v_add_f32 v104, v104, v205
    v_fma_f32 v199, v103, s36, v192
    v_exp_f32 v203, v198
    v_add_f32 v196, v196, v202
    v_cvt_pk_bf16_f32 v170, v201, v202
    s_waitcnt lgkmcnt(4)
    v_mfma_f32_32x32x16_bf16 v[0:15], a[192:195], a[144:147], v[0:15]
    v_and_b32 v205, 0xffff0000, v210
    v_add_f32 v105, v105, v205
    v_fma_f32 v200, v104, s36, v192
    v_exp_f32 v204, v199
    v_add_f32 v196, v196, v203
    ds_read_b64_tr_b16 v[208:209], v225 offset:4096
    v_mfma_f32_32x32x16_bf16 v[16:31], a[192:195], a[176:179], v[16:31]
    ds_read_b128 a[192:195], v212 offset:8192
    v_lshlrev_b32 v205, 16, v211
    v_add_f32 v106, v106, v205
    v_fma_f32 v198, v105, s36, v192
    v_exp_f32 v201, v200
    v_add_f32 v196, v196, v204
    s_waitcnt lgkmcnt(5)
    v_mfma_f32_32x32x16_bf16 v[0:15], a[196:199], a[148:151], v[0:15]
    s_add_u32 m0, s48, 2048
    s_nop 0
    buffer_load_dwordx4 v230, s[16:19], 0 offen lds
    v_cvt_pk_bf16_f32 v171, v203, v204
    v_and_b32 v205, 0xffff0000, v211
    v_add_f32 v107, v107, v205
    v_fma_f32 v199, v106, s36, v192
    v_exp_f32 v202, v198
    v_mfma_f32_32x32x16_bf16 v[16:31], a[196:199], a[180:183], v[16:31]
    ds_read_b128 a[196:199], v213 offset:8192
    v_add_f32 v196, v196, v201
    s_waitcnt lgkmcnt(5)
    v_lshlrev_b32 v205, 16, v206
    v_add_f32 v108, v108, v205
    v_fma_f32 v200, v107, s36, v192
    v_exp_f32 v203, v199
    s_waitcnt lgkmcnt(4)
    v_mfma_f32_32x32x16_bf16 v[0:15], a[200:203], a[152:155], v[0:15]
    v_add_f32 v196, v196, v202
    v_cvt_pk_bf16_f32 v172, v201, v202
    v_and_b32 v205, 0xffff0000, v206
    v_add_f32 v109, v109, v205
    v_fma_f32 v198, v108, s36, v192
    v_exp_f32 v204, v200
    v_mfma_f32_32x32x16_bf16 v[16:31], a[200:203], a[184:187], v[16:31]
    ds_read_b128 a[200:203], v214 offset:8192
    v_add_f32 v196, v196, v203
    ds_read_b64_tr_b16 v[210:211], v225 offset:5120
    v_lshlrev_b32 v205, 16, v207
    v_add_f32 v110, v110, v205
    v_fma_f32 v199, v109, s36, v192
    s_waitcnt lgkmcnt(5)
    v_mfma_f32_32x32x16_bf16 v[0:15], a[204:207], a[156:159], v[0:15]
    v_exp_f32 v201, v198
    v_add_f32 v196, v196, v204
    v_cvt_pk_bf16_f32 v173, v203, v204
    v_and_b32 v205, 0xffff0000, v207
    v_add_f32 v111, v111, v205
    v_fma_f32 v200, v110, s36, v192
    v_mfma_f32_32x32x16_bf16 v[16:31], a[204:207], a[188:191], v[16:31]
    ds_read_b128 a[204:207], v215 offset:8192
    v_exp_f32 v202, v199
    v_add_f32 v196, v196, v201
    s_waitcnt lgkmcnt(5)
    v_lshlrev_b32 v205, 16, v208
    v_add_f32 v112, v112, v205
    v_fma_f32 v198, v111, s36, v192
    s_waitcnt lgkmcnt(4)
    v_mfma_f32_32x32x16_bf16 v[32:47], a[192:195], a[128:131], 0
    s_add_u32 m0, s48, 3072
    s_nop 0
    buffer_load_dwordx4 v231, s[16:19], 0 offen lds
    v_exp_f32 v203, v200
    v_add_f32 v196, v196, v202
    v_cvt_pk_bf16_f32 v174, v201, v202
    v_and_b32 v205, 0xffff0000, v208
    v_add_f32 v113, v113, v205
    v_mfma_f32_32x32x16_bf16 v[48:63], a[192:195], a[160:163], 0
    ds_read_b128 a[192:195], v216 offset:8192
    v_fma_f32 v199, v112, s36, v193
    v_exp_f32 v204, v198
    v_add_f32 v196, v196, v203
    ds_read_b64_tr_b16 v[206:207], v225 offset:6144
    v_lshlrev_b32 v205, 16, v209
    s_waitcnt lgkmcnt(5)
    v_mfma_f32_32x32x16_bf16 v[32:47], a[196:199], a[132:135], v[32:47]
    v_add_f32 v114, v114, v205
    v_fma_f32 v200, v113, s36, v193
    v_exp_f32 v201, v199
    v_add_f32 v196, v196, v204
    v_cvt_pk_bf16_f32 v175, v203, v204
    v_and_b32 v205, 0xffff0000, v209
    v_mfma_f32_32x32x16_bf16 v[48:63], a[196:199], a[164:167], v[48:63]
    ds_read_b128 a[196:199], v217 offset:8192
    v_add_f32 v115, v115, v205
    v_fma_f32 v198, v114, s36, v193
    v_exp_f32 v202, v200
    v_add_f32 v197, v197, v201
    s_waitcnt lgkmcnt(4)
    v_lshlrev_b32 v205, 16, v210
    v_mfma_f32_32x32x16_bf16 v[32:47], a[200:203], a[136:139], v[32:47]
    s_add_u32 m0, s48, 16384
    s_nop 0
    buffer_load_dwordx4 v232, s[20:23], 0 offen lds
    v_add_f32 v116, v116, v205
    v_fma_f32 v199, v115, s36, v193
    v_exp_f32 v203, v198
    v_add_f32 v197, v197, v202
    v_cvt_pk_bf16_f32 v184, v201, v202
    v_mfma_f32_32x32x16_bf16 v[48:63], a[200:203], a[168:171], v[48:63]
    ds_read_b128 a[200:203], v218 offset:8192
    v_and_b32 v205, 0xffff0000, v210
    v_add_f32 v117, v117, v205
    v_fma_f32 v200, v116, s36, v193
    v_exp_f32 v204, v199
    v_add_f32 v197, v197, v203
    s_waitcnt lgkmcnt(4)
    v_mfma_f32_32x32x16_bf16 v[32:47], a[204:207], a[140:143], v[32:47]
    ds_read_b64_tr_b16 v[208:209], v225 offset:7168
    v_lshlrev_b32 v205, 16, v211
    v_add_f32 v118, v118, v205
    v_fma_f32 v198, v117, s36, v193
    v_exp_f32 v201, v200
    v_add_f32 v197, v197, v204
    v_mfma_f32_32x32x16_bf16 v[48:63], a[204:207], a[172:175], v[48:63]
    ds_read_b128 a[204:207], v219 offset:8192
    v_cvt_pk_bf16_f32 v185, v203, v204
    v_and_b32 v205, 0xffff0000, v211
    v_add_f32 v119, v119, v205
    v_fma_f32 v199, v118, s36, v193
    v_exp_f32 v202, v198
    s_waitcnt lgkmcnt(5)
    v_mfma_f32_32x32x16_bf16 v[32:47], a[192:195], a[144:147], v[32:47]
    v_add_f32 v197, v197, v201
    s_waitcnt lgkmcnt(4)
    v_lshlrev_b32 v205, 16, v206
    v_add_f32 v120, v120, v205
    v_fma_f32 v200, v119, s36, v193
    v_exp_f32 v203, v199
    v_add_f32 v197, v197, v202
    v_mfma_f32_32x32x16_bf16 v[48:63], a[192:195], a[176:179], v[48:63]
    v_cvt_pk_bf16_f32 v186, v201, v202
    v_and_b32 v205, 0xffff0000, v206
    v_add_f32 v121, v121, v205
    v_fma_f32 v198, v120, s36, v193
    v_exp_f32 v204, v200
    v_add_f32 v197, v197, v203
    s_waitcnt lgkmcnt(3)
    v_mfma_f32_32x32x16_bf16 v[32:47], a[196:199], a[148:151], v[32:47]
    v_lshlrev_b32 v205, 16, v207
    v_add_f32 v122, v122, v205
    v_fma_f32 v199, v121, s36, v193
    v_exp_f32 v201, v198
    v_add_f32 v197, v197, v204
    v_cvt_pk_bf16_f32 v187, v203, v204
    v_mfma_f32_32x32x16_bf16 v[48:63], a[196:199], a[180:183], v[48:63]
    ds_read_b64_tr_b16 a[208:209], v220 offset:0
    v_and_b32 v205, 0xffff0000, v207
    v_add_f32 v123, v123, v205
    v_fma_f32 v200, v122, s36, v193
    v_exp_f32 v202, v199
    v_add_f32 v197, v197, v201
    s_waitcnt lgkmcnt(3)
    v_mfma_f32_32x32x16_bf16 v[32:47], a[200:203], a[152:155], v[32:47]
    ds_read_b64_tr_b16 a[210:211], v220 offset:2048
    ds_read_b64_tr_b16 a[212:213], v221 offset:0
    s_waitcnt lgkmcnt(4)
    v_lshlrev_b32 v205, 16, v208
    v_add_f32 v124, v124, v205
    v_fma_f32 v198, v123, s36, v193
    v_mfma_f32_32x32x16_bf16 v[48:63], a[200:203], a[184:187], v[48:63]
    ds_read_b64_tr_b16 a[214:215], v221 offset:2048
    ds_read_b64_tr_b16 a[216:217], v222 offset:0
    v_exp_f32 v203, v200
    v_add_f32 v197, v197, v202
    v_cvt_pk_bf16_f32 v188, v201, v202
    s_waitcnt lgkmcnt(5)
    v_mfma_f32_32x32x16_bf16 v[32:47], a[204:207], a[156:159], v[32:47]
    ds_read_b64_tr_b16 a[218:219], v222 offset:2048
    v_and_b32 v205, 0xffff0000, v208
    v_add_f32 v125, v125, v205
    v_fma_f32 v199, v124, s36, v193
    v_exp_f32 v204, v198
    v_add_f32 v197, v197, v203
    v_lshlrev_b32 v205, 16, v209
    v_add_f32 v126, v126, v205
    v_fma_f32 v200, v125, s36, v193
    v_exp_f32 v201, v199
    v_add_f32 v197, v197, v204
    v_cvt_pk_bf16_f32 v189, v203, v204
    v_and_b32 v205, 0xffff0000, v209
    v_add_f32 v127, v127, v205
    v_fma_f32 v198, v126, s36, v193
    v_exp_f32 v202, v200
    v_add_f32 v197, v197, v201
    v_fma_f32 v199, v127, s36, v193
    v_exp_f32 v203, v198
    v_add_f32 v197, v197, v202
    v_cvt_pk_bf16_f32 v190, v201, v202
    v_exp_f32 v204, v199
    v_add_f32 v197, v197, v203
    v_add_f32 v197, v197, v204
    v_cvt_pk_bf16_f32 v191, v203, v204
    v_mfma_f32_32x32x16_bf16 v[48:63], a[204:207], a[188:191], v[48:63]
    v_cmp_lt_f32 vcc, 0x45800000, v196
    v_cmp_lt_f32 s[44:45], s47, v197
    s_or_b64 vcc, vcc, s[44:45]
    s_cbranch_vccnz RARE_E1
    v_add_f32 v194, v194, v196
    v_mov_b32 v196, 0
    v_add_f32 v195, v195, v197
    v_mov_b32 v197, 0
BACK_E1:
    ds_read_b64_tr_b16 a[220:221], v223 offset:0
    ds_read_b64_tr_b16 v[206:207], v226 offset:0
    ds_read_b64_tr_b16 v[208:209], v226 offset:1024
    ds_read_b64_tr_b16 v[210:211], v226 offset:2048
    s_waitcnt lgkmcnt(2)
    v_lshlrev_b32 v205, 16, v206
    v_add_f32 v0, v0, v205
    v_and_b32 v205, 0xffff0000, v206
    v_add_f32 v1, v1, v205
    v_mfma_f32_32x32x16_bf16 a[0:15], a[208:211], v[160:163], a[0:15]
    ds_read_b64_tr_b16 a[222:223], v223 offset:2048
    s_add_u32 m0, s48, 17408
    s_nop 0
    buffer_load_dwordx4 v233, s[20:23], 0 offen lds
    v_fma_f32 v198, v0, s36, v192
    v_lshlrev_b32 v205, 16, v207
    v_add_f32 v2, v2, v205
    v_fma_f32 v199, v1, s36, v192
    v_exp_f32 v201, v198
    v_mfma_f32_32x32x16_bf16 a[64:79], a[208:211], v[176:179], a[64:79]
    ds_read_b64_tr_b16 a[208:209], v220 offset:4096
    v_and_b32 v205, 0xffff0000, v207
    v_add_f32 v3, v3, v205
    v_fma_f32 v200, v2, s36, v192
    v_exp_f32 v202, v199
    v_add_f32 v196, v196, v201
    s_waitcnt lgkmcnt(3)
    v_lshlrev_b32 v205, 16, v208
    v_add_f32 v4, v4, v205
    v_mfma_f32_32x32x16_bf16 a[16:31], a[212:215], v[160:163], a[16:31]
    ds_read_b64_tr_b16 a[210:211], v220 offset:6144
    v_fma_f32 v198, v3, s36, v192
    v_exp_f32 v203, v200
    v_add_f32 v196, v196, v202
    v_cvt_pk_bf16_f32 v128, v201, v202
    v_and_b32 v205, 0xffff0000, v208
    v_add_f32 v5, v5, v205
    v_fma_f32 v199, v4, s36, v192
    v_mfma_f32_32x32x16_bf16 a[80:95], a[212:215], v[176:179], a[80:95]
    ds_read_b64_tr_b16 a[212:213], v221 offset:4096
    v_exp_f32 v204, v198
    v_add_f32 v196, v196, v203
    ds_read_b64_tr_b16 v[206:207], v226 offset:3072
    v_lshlrev_b32 v205, 16, v209
    v_add_f32 v6, v6, v205
    v_fma_f32 v200, v5, s36, v192
    v_mfma_f32_32x32x16_bf16 a[32:47], a[216:219], v[160:163], a[32:47]
    ds_read_b64_tr_b16 a[214:215], v221 offset:6144
    v_exp_f32 v201, v199
    v_add_f32 v196, v196, v204
    v_cvt_pk_bf16_f32 v129, v203, v204
    v_and_b32 v205, 0xffff0000, v209
    v_add_f32 v7, v7, v205
    v_fma_f32 v198, v6, s36, v192
    v_mfma_f32_32x32x16_bf16 a[96:111], a[216:219], v[176:179], a[96:111]
    ds_read_b64_tr_b16 a[216:217], v222 offset:4096
    s_add_u32 m0, s48, 18432
    s_nop 0
    buffer_load_dwordx4 v234, s[20:23], 0 offen lds
    v_exp_f32 v202, v200
    v_add_f32 v196, v196, v201
    s_waitcnt lgkmcnt(7)
    v_lshlrev_b32 v205, 16, v210
    v_add_f32 v8, v8, v205
    v_fma_f32 v199, v7, s36, v192
    s_waitcnt lgkmcnt(6)
    v_mfma_f32_32x32x16_bf16 a[48:63], a[220:223], v[160:163], a[48:63]
    ds_read_b64_tr_b16 a[218:219], v222 offset:6144
    v_exp_f32 v203, v198
    v_add_f32 v196, v196, v202
    v_cvt_pk_bf16_f32 v130, v201, v202
    v_and_b32 v205, 0xffff0000, v210
    v_add_f32 v9, v9, v205
    v_fma_f32 v200, v8, s36, v192
    v_mfma_f32_32x32x16_bf16 a[112:127], a[220:223], v[176:179], a[112:127]
    ds_read_b64_tr_b16 a[220:221], v223 offset:4096
    v_exp_f32 v204, v199
    v_add_f32 v196, v196, v203
    ds_read_b64_tr_b16 v[208:209], v227 offset:0
    v_lshlrev_b32 v205, 16, v211
    v_add_f32 v10, v10, v205
    v_fma_f32 v198, v9, s36, v192
    s_waitcnt lgkmcnt(7)
    v_mfma_f32_32x32x16_bf16 a[0:15], a[208:211], v[164:167], a[0:15]
    ds_read_b64_tr_b16 a[222:223], v223 offset:6144
    v_exp_f32 v201, v200
    v_add_f32 v196, v196, v204
    v_cvt_pk_bf16_f32 v131, v203, v204
    v_and_b32 v205, 0xffff0000, v211
    v_add_f32 v11, v11, v205
    v_fma_f32 v199, v10, s36, v192
    v_mfma_f32_32x32x16_bf16 a[64:79], a[208:211], v[180:183], a[64:79]
    ds_read_b64_tr_b16 a[208:209], v220 offset:8192
    v_exp_f32 v202, v198
    v_add_f32 v196, v196, v201
    s_waitcnt lgkmcnt(7)
    v_lshlrev_b32 v205, 16, v206
    v_add_f32 v12, v12, v205
    v_fma_f32 v200, v11, s36, v192
    v_exp_f32 v203, v199
    s_waitcnt lgkmcnt(6)
    v_mfma_f32_32x32x16_bf16 a[16:31], a[212:215], v[164:167], a[16:31]
    ds_read_b64_tr_b16 a[210:211], v220 offset:10240
    s_add_u32 m0, s48, 19456
    s_nop 0
    buffer_load_dwordx4 v235, s[20:23], 0 offen lds
    v_add_f32 v196, v196, v202
    v_cvt_pk_bf16_f32 v132, v201, v202
    v_and_b32 v205, 0xffff0000, v206
    v_add_f32 v13, v13, v205
    v_fma_f32 v198, v12, s36, v192
    v_mfma_f32_32x32x16_bf16 a[80:95], a[212:215], v[180:183], a[80:95]
    ds_read_b64_tr_b16 a[212:213], v221 offset:8192
    v_exp_f32 v204, v200
    v_add_f32 v196, v196, v203
    ds_read_b64_tr_b16 v[210:211], v227 offset:1024
    v_lshlrev_b32 v205, 16, v207
    v_add_f32 v14, v14, v205
    v_fma_f32 v199, v13, s36, v192
    s_waitcnt lgkmcnt(7)
    v_mfma_f32_32x32x16_bf16 a[32:47], a[216:219], v[164:167], a[32:47]
    ds_read_b64_tr_b16 a[214:215], v221 offset:10240
    v_exp_f32 v201, v198
    v_add_f32 v196, v196, v204
    v_cvt_pk_bf16_f32 v133, v203, v204
    v_and_b32 v205, 0xffff0000, v207
    v_add_f32 v15, v15, v205
    v_fma_f32 v200, v14, s36, v192
    v_mfma_f32_32x32x16_bf16 a[96:111], a[216:219], v[180:183], a[96:111]
    ds_read_b64_tr_b16 a[216:217], v222 offset:8192
    v_exp_f32 v202, v199
    v_add_f32 v196, v196, v201
    s_waitcnt lgkmcnt(7)
    v_lshlrev_b32 v205, 16, v208
    v_add_f32 v16, v16, v205
    v_fma_f32 v198, v15, s36, v192
    v_exp_f32 v203, v200
    s_waitcnt lgkmcnt(6)
    v_mfma_f32_32x32x16_bf16 a[48:63], a[220:223], v[164:167], a[48:63]
    ds_read_b64_tr_b16 a[218:219], v222 offset:10240
    v_add_f32 v196, v196, v202
    v_cvt_pk_bf16_f32 v134, v201, v202
    v_and_b32 v205, 0xffff0000, v208
    v_add_f32 v17, v17, v205
    v_fma_f32 v199, v16, s36, v193
    v_exp_f32 v204, v198
    v_add_f32 v196, v196, v203
    v_mfma_f32_32x32x16_bf16 a[112:127], a[220:223], v[180:183], a[112:127]
    ds_read_b64_tr_b16 a[220:221], v223 offset:8192
    s_add_u32 m0, s49, 0
    s_nop 0
    buffer_load_dwordx4 v241, s[24:27], 0 offen lds
    ds_read_b64_tr_b16 v[206:207], v227 offset:2048
    v_lshlrev_b32 v205, 16, v209
    v_add_f32 v18, v18, v205
    v_fma_f32 v200, v17, s36, v193
    v_exp_f32 v201, v199
    s_waitcnt lgkmcnt(7)
    v_mfma_f32_32x32x16_bf16 a[0:15], a[208:211], v[168:171], a[0:15]
    ds_read_b64_tr_b16 a[222:223], v223 offset:10240
    v_add_f32 v196, v196, v204
    v_cvt_pk_bf16_f32 v135, v203, v204
    v_and_b32 v205, 0xffff0000, v209
    v_add_f32 v19, v19, v205
    v_fma_f32 v198, v18, s36, v193
    v_exp_f32 v202, v200
    v_add_f32 v197, v197, v201
    v_mfma_f32_32x32x16_bf16 a[64:79], a[208:211], v[184:187], a[64:79]
    ds_read_b64_tr_b16 a[208:209], v220 offset:12288
    s_waitcnt lgkmcnt(7)
    v_lshlrev_b32 v205, 16, v210
    v_add_f32 v20, v20, v205
    v_fma_f32 v199, v19, s36, v193
    v_exp_f32 v203, v198
    v_add_f32 v197, v197, v202
    v_cvt_pk_bf16_f32 v144, v201, v202
    v_and_b32 v205, 0xffff0000, v210
    s_waitcnt lgkmcnt(6)
    v_mfma_f32_32x32x16_bf16 a[16:31], a[212:215], v[168:171], a[16:31]
    ds_read_b64_tr_b16 a[210:211], v220 offset:14336
    v_add_f32 v21, v21, v205
    v_fma_f32 v200, v20, s36, v193
    v_exp_f32 v204, v199
    v_add_f32 v197, v197, v203
    ds_read_b64_tr_b16 v[208:209], v227 offset:3072
    v_lshlrev_b32 v205, 16, v211
    v_add_f32 v22, v22, v205
    v_mfma_f32_32x32x16_bf16 a[80:95], a[212:215], v[184:187], a[80:95]
    ds_read_b64_tr_b16 a[212:213], v221 offset:12288
    v_fma_f32 v198, v21, s36, v193
    v_exp_f32 v201, v200
    v_add_f32 v197, v197, v204
    v_cvt_pk_bf16_f32 v145, v203, v204
    v_and_b32 v205, 0xffff0000, v211
    v_add_f32 v23, v23, v205
    v_fma_f32 v199, v22, s36, v193
    s_waitcnt lgkmcnt(7)
    v_mfma_f32_32x32x16_bf16 a[32:47], a[216:219], v[168:171], a[32:47]
    ds_read_b64_tr_b16 a[214:215], v221 offset:14336
    s_add_u32 m0, s49, 1024
    s_nop 0
    buffer_load_dwordx4 v242, s[24:27], 0 offen lds
    v_exp_f32 v202, v198
    v_add_f32 v197, v197, v201
    s_waitcnt lgkmcnt(6)
    v_lshlrev_b32 v205, 16, v206
    v_add_f32 v24, v24, v205
    v_fma_f32 v200, v23, s36, v193
    v_mfma_f32_32x32x16_bf16 a[96:111], a[216:219], v[184:187], a[96:111]
    ds_read_b64_tr_b16 a[216:217], v222 offset:12288
    v_exp_f32 v203, v199
    v_add_f32 v197, v197, v202
    v_cvt_pk_bf16_f32 v146, v201, v202
    v_and_b32 v205, 0xffff0000, v206
    v_add_f32 v25, v25, v205
    v_fma_f32 v198, v24, s36, v193
    s_waitcnt lgkmcnt(6)
    v_mfma_f32_32x32x16_bf16 a[48:63], a[220:223], v[168:171], a[48:63]
    ds_read_b64_tr_b16 a[218:219], v222 offset:14336
    v_exp_f32 v204, v200
    v_add_f32 v197, v197, v203
    v_lshlrev_b32 v205, 16, v207
    v_add_f32 v26, v26, v205
    v_fma_f32 v199, v25, s36, v193
    v_exp_f32 v201, v198
    v_mfma_f32_32x32x16_bf16 a[112:127], a[220:223], v[184:187], a[112:127]
    ds_read_b64_tr_b16 a[220:221], v223 offset:12288
    s_waitcnt vmcnt(11)
    v_and_b32 v252, 0x7ff, v244
    v_lshl_add_u32 v228, v252, 8, v236
    v_lshl_add_u32 v232, v252, 8, v240
    v_and_b32 v252, 0x7ff, v245
    v_lshl_add_u32 v229, v252, 8, v237
    v_lshl_add_u32 v233, v252, 8, v240
    v_and_b32 v252, 0x7ff, v246
    v_lshl_add_u32 v230, v252, 8, v238
    v_lshl_add_u32 v234, v252, 8, v240
    v_and_b32 v252, 0x7ff, v247
    v_lshl_add_u32 v231, v252, 8, v239
    v_lshl_add_u32 v235, v252, 8, v240
    s_waitcnt lgkmcnt(6)
    v_mfma_f32_32x32x16_bf16 a[0:15], a[208:211], v[172:175], a[0:15]
    ds_read_b64_tr_b16 a[222:223], v223 offset:14336
    v_add_f32 v197, v197, v204
    v_cvt_pk_bf16_f32 v147, v203, v204
    v_and_b32 v205, 0xffff0000, v207
    v_add_f32 v27, v27, v205
    v_fma_f32 v200, v26, s36, v193
    v_exp_f32 v202, v199
    v_add_f32 v197, v197, v201
    v_mfma_f32_32x32x16_bf16 a[64:79], a[208:211], v[188:191], a[64:79]
    s_waitcnt vmcnt(10)
    v_lshl_add_u32 v241, v248, 12, v243
    s_waitcnt vmcnt(9)
    v_lshl_add_u32 v242, v249, 12, v243
    v_add_u32 v250, 0x100, v250
    v_add_u32 v251, 0x100, v251
    s_waitcnt lgkmcnt(6)
    v_lshlrev_b32 v205, 16, v208
    v_add_f32 v28, v28, v205
    v_fma_f32 v198, v27, s36, v193
    v_exp_f32 v203, v200
    v_add_f32 v197, v197, v202
    s_waitcnt lgkmcnt(4)
    v_mfma_f32_32x32x16_bf16 a[16:31], a[212:215], v[172:175], a[16:31]
    v_cvt_pk_bf16_f32 v148, v201, v202
    v_and_b32 v205, 0xffff0000, v208
    v_add_f32 v29, v29, v205
    v_fma_f32 v199, v28, s36, v193
    v_exp_f32 v204, v198
    v_add_f32 v197, v197, v203
    v_lshlrev_b32 v205, 16, v209
    v_add_f32 v30, v30, v205
    v_fma_f32 v200, v29, s36, v193
    v_mfma_f32_32x32x16_bf16 a[80:95], a[212:215], v[188:191], a[80:95]
    s_waitcnt lgkmcnt(0)
    s_barrier
    s_mov_b32 s42, s41
    s_add_u32 s46, s40, 0x8000
    s_and_b32 s46, s46, 0x1ffff
    s_sub_u32 s41, s46, s40
    s_mov_b32 s40, s46
    s_add_u32 s43, s43, 0x8000
    s_and_b32 s43, s43, 0x1ffff
    s_add_u32 s48, s43, s53
    s_lshr_b32 s46, s43, 2
    s_add_u32 s46, s46, s54
    s_add_u32 s49, s46, 0x20000
    s_ashr_i32 s44, s41, 2
    s_ashr_i32 s45, s42, 2
    v_add_u32 v212, s41, v212
    v_add_u32 v213, s41, v213
    v_add_u32 v214, s41, v214
    v_mfma_f32_32x32x16_bf16 a[32:47], a[216:219], v[172:175], a[32:47]
    ds_read_b128 a[192:195], v212 offset:0
    ds_read_b128 a[196:199], v213 offset:0
    v_add_u32 v215, s41, v215
    v_add_u32 v216, s41, v216
    v_add_u32 v217, s41, v217
    v_mfma_f32_32x32x16_bf16 a[96:111], a[216:219], v[188:191], a[96:111]
    ds_read_b128 a[200:203], v214 offset:0
    v_add_u32 v218, s41, v218
    v_add_u32 v219, s41, v219
    v_add_u32 v220, s42, v220
    v_add_u32 v221, s42, v221
    v_mfma_f32_32x32x16_bf16 a[48:63], a[220:223], v[172:175], a[48:63]
    v_add_u32 v222, s42, v222
    v_add_u32 v223, s42, v223
    v_add_u32 v224, s45, v224
    v_add_u32 v225, s45, v225
    v_add_u32 v226, s44, v226
    v_add_u32 v227, s44, v227
    v_exp_f32 v201, v199
    v_add_f32 v197, v197, v204
    v_cvt_pk_bf16_f32 v149, v203, v204
    v_and_b32 v205, 0xffff0000, v209
    v_add_f32 v31, v31, v205
    v_fma_f32 v198, v30, s36, v193
    v_exp_f32 v202, v200
    v_add_f32 v197, v197, v201
    v_fma_f32 v199, v31, s36, v193
    v_exp_f32 v203, v198
    v_add_f32 v197, v197, v202
    v_cvt_pk_bf16_f32 v150, v201, v202
    v_exp_f32 v204, v199
    v_add_f32 v197, v197, v203
    v_add_f32 v197, v197, v204
    v_cvt_pk_bf16_f32 v151, v203, v204
    v_mfma_f32_32x32x16_bf16 a[112:127], a[220:223], v[188:191], a[112:127]
    s_sub_u32 s39, s39, 1
    s_cmp_lg_u32 s39, 0
    s_cbranch_scc1 LOOP_E
EPI:
    s_nop 15
    v_mbcnt_lo_u32_b32 v0, -1, 0
    v_mbcnt_hi_u32_b32 v0, -1, v0
    v_and_b32 v2, 31, v0
    v_lshrrev_b32 v3, 5, v0
    v_lshlrev_b32 v12, 8, v2
    v_lshl_add_u32 v12, v3, 3, v12
    v_add_u32 v13, 0x2000, v12
    v_mov_b32 v4, v194
    v_mov_b32 v5, v194
    s_nop 1
    v_permlane32_swap_b32 v4, v5
    v_add_f32 v4, v4, v5
    v_rcp_f32 v6, v4
    v_accvgpr_read_b32 v16, a0
    v_accvgpr_read_b32 v17, a1
    v_accvgpr_read_b32 v18, a2
    v_accvgpr_read_b32 v19, a3
    v_mul_f32 v16, v16, v6
    v_mul_f32 v17, v17, v6
    v_mul_f32 v18, v18, v6
    v_mul_f32 v19, v19, v6
    v_cvt_pk_bf16_f32 v20, v16, v17
    v_cvt_pk_bf16_f32 v21, v18, v19
    buffer_store_dwordx2 v[20:21], v12, s[28:31], 0 offen offset:0
    v_accvgpr_read_b32 v24, a4
    v_accvgpr_read_b32 v25, a5
    v_accvgpr_read_b32 v26, a6
    v_accvgpr_read_b32 v27, a7
    v_mul_f32 v24, v24, v6
    v_mul_f32 v25, v25, v6
    v_mul_f32 v26, v26, v6
    v_mul_f32 v27, v27, v6
    v_cvt_pk_bf16_f32 v28, v24, v25
    v_cvt_pk_bf16_f32 v29, v26, v27
    buffer_store_dwordx2 v[28:29], v12, s[28:31], 0 offen offset:16
    v_accvgpr_read_b32 v16, a8
    v_accvgpr_read_b32 v17, a9
    v_accvgpr_read_b32 v18, a10
    v_accvgpr_read_b32 v19, a11
    v_mul_f32 v16, v16, v6
    v_mul_f32 v17, v17, v6
    v_mul_f32 v18, v18, v6
    v_mul_f32 v19, v19, v6
    v_cvt_pk_bf16_f32 v20, v16, v17
    v_cvt_pk_bf16_f32 v21, v18, v19
    buffer_store_dwordx2 v[20:21], v12, s[28:31], 0 offen offset:32
    v_accvgpr_read_b32 v24, a12
    v_accvgpr_read_b32 v25, a13
    v_accvgpr_read_b32 v26, a14
    v_accvgpr_read_b32 v27, a15
    v_mul_f32 v24, v24, v6
    v_mul_f32 v25, v25, v6
    v_mul_f32 v26, v26, v6
    v_mul_f32 v27, v27, v6
    v_cvt_pk_bf16_f32 v28, v24, v25
    v_cvt_pk_bf16_f32 v29, v26, v27
    buffer_store_dwordx2 v[28:29], v12, s[28:31], 0 offen offset:48
    v_accvgpr_read_b32 v16, a16
    v_accvgpr_read_b32 v17, a17
    v_accvgpr_read_b32 v18, a18
    v_accvgpr_read_b32 v19, a19
    v_mul_f32 v16, v16, v6
    v_mul_f32 v17, v17, v6
    v_mul_f32 v18, v18, v6
    v_mul_f32 v19, v19, v6
    v_cvt_pk_bf16_f32 v20, v16, v17
    v_cvt_pk_bf16_f32 v21, v18, v19
    buffer_store_dwordx2 v[20:21], v12, s[28:31], 0 offen offset:64
    v_accvgpr_read_b32 v24, a20
    v_accvgpr_read_b32 v25, a21
    v_accvgpr_read_b32 v26, a22
    v_accvgpr_read_b32 v27, a23
    v_mul_f32 v24, v24, v6
    v_mul_f32 v25, v25, v6
    v_mul_f32 v26, v26, v6
    v_mul_f32 v27, v27, v6
    v_cvt_pk_bf16_f32 v28, v24, v25
    v_cvt_pk_bf16_f32 v29, v26, v27
    buffer_store_dwordx2 v[28:29], v12, s[28:31], 0 offen offset:80
    v_accvgpr_read_b32 v16, a24
    v_accvgpr_read_b32 v17, a25
    v_accvgpr_read_b32 v18, a26
    v_accvgpr_read_b32 v19, a27
    v_mul_f32 v16, v16, v6
    v_mul_f32 v17, v17, v6
    v_mul_f32 v18, v18, v6
    v_mul_f32 v19, v19, v6
    v_cvt_pk_bf16_f32 v20, v16, v17
    v_cvt_pk_bf16_f32 v21, v18, v19
    buffer_store_dwordx2 v[20:21], v12, s[28:31], 0 offen offset:96
    v_accvgpr_read_b32 v24, a28
    v_accvgpr_read_b32 v25, a29
    v_accvgpr_read_b32 v26, a30
    v_accvgpr_read_b32 v27, a31
    v_mul_f32 v24, v24, v6
    v_mul_f32 v25, v25, v6
    v_mul_f32 v26, v26, v6
    v_mul_f32 v27, v27, v6
    v_cvt_pk_bf16_f32 v28, v24, v25
    v_cvt_pk_bf16_f32 v29, v26, v27
    buffer_store_dwordx2 v[28:29], v12, s[28:31], 0 offen offset:112
    v_accvgpr_read_b32 v16, a32
    v_accvgpr_read_b32 v17, a33
    v_accvgpr_read_b32 v18, a34
    v_accvgpr_read_b32 v19, a35
    v_mul_f32 v16, v16, v6
    v_mul_f32 v17, v17, v6
    v_mul_f32 v18, v18, v6
    v_mul_f32 v19, v19, v6
    v_cvt_pk_bf16_f32 v20, v16, v17
    v_cvt_pk_bf16_f32 v21, v18, v19
    buffer_store_dwordx2 v[20:21], v12, s[28:31], 0 offen offset:128
    v_accvgpr_read_b32 v24, a36
    v_accvgpr_read_b32 v25, a37
    v_accvgpr_read_b32 v26, a38
    v_accvgpr_read_b32 v27, a39
    v_mul_f32 v24, v24, v6
    v_mul_f32 v25, v25, v6
    v_mul_f32 v26, v26, v6
    v_mul_f32 v27, v27, v6
    v_cvt_pk_bf16_f32 v28, v24, v25
    v_cvt_pk_bf16_f32 v29, v26, v27
    buffer_store_dwordx2 v[28:29], v12, s[28:31], 0 offen offset:144
    v_accvgpr_read_b32 v16, a40
    v_accvgpr_read_b32 v17, a41
    v_accvgpr_read_b32 v18, a42
    v_accvgpr_read_b32 v19, a43
    v_mul_f32 v16, v16, v6
    v_mul_f32 v17, v17, v6
    v_mul_f32 v18, v18, v6
    v_mul_f32 v19, v19, v6
    v_cvt_pk_bf16_f32 v20, v16, v17
    v_cvt_pk_bf16_f32 v21, v18, v19
    buffer_store_dwordx2 v[20:21], v12, s[28:31], 0 offen offset:160
    v_accvgpr_read_b32 v24, a44
    v_accvgpr_read_b32 v25, a45
    v_accvgpr_read_b32 v26, a46
    v_accvgpr_read_b32 v27, a47
    v_mul_f32 v24, v24, v6
    v_mul_f32 v25, v25, v6
    v_mul_f32 v26, v26, v6
    v_mul_f32 v27, v27, v6
    v_cvt_pk_bf16_f32 v28, v24, v25
    v_cvt_pk_bf16_f32 v29, v26, v27
    buffer_store_dwordx2 v[28:29], v12, s[28:31], 0 offen offset:176
    v_accvgpr_read_b32 v16, a48
    v_accvgpr_read_b32 v17, a49
    v_accvgpr_read_b32 v18, a50
    v_accvgpr_read_b32 v19, a51
    v_mul_f32 v16, v16, v6
    v_mul_f32 v17, v17, v6
    v_mul_f32 v18, v18, v6
    v_mul_f32 v19, v19, v6
    v_cvt_pk_bf16_f32 v20, v16, v17
    v_cvt_pk_bf16_f32 v21, v18, v19
    buffer_store_dwordx2 v[20:21], v12, s[28:31], 0 offen offset:192
    v_accvgpr_read_b32 v24, a52
    v_accvgpr_read_b32 v25, a53
    v_accvgpr_read_b32 v26, a54
    v_accvgpr_read_b32 v27, a55
    v_mul_f32 v24, v24, v6
    v_mul_f32 v25, v25, v6
    v_mul_f32 v26, v26, v6
    v_mul_f32 v27, v27, v6
    v_cvt_pk_bf16_f32 v28, v24, v25
    v_cvt_pk_bf16_f32 v29, v26, v27
    buffer_store_dwordx2 v[28:29], v12, s[28:31], 0 offen offset:208
    v_accvgpr_read_b32 v16, a56
    v_accvgpr_read_b32 v17, a57
    v_accvgpr_read_b32 v18, a58
    v_accvgpr_read_b32 v19, a59
    v_mul_f32 v16, v16, v6
    v_mul_f32 v17, v17, v6
    v_mul_f32 v18, v18, v6
    v_mul_f32 v19, v19, v6
    v_cvt_pk_bf16_f32 v20, v16, v17
    v_cvt_pk_bf16_f32 v21, v18, v19
    buffer_store_dwordx2 v[20:21], v12, s[28:31], 0 offen offset:224
    v_accvgpr_read_b32 v24, a60
    v_accvgpr_read_b32 v25, a61
    v_accvgpr_read_b32 v26, a62
    v_accvgpr_read_b32 v27, a63
    v_mul_f32 v24, v24, v6
    v_mul_f32 v25, v25, v6
    v_mul_f32 v26, v26, v6
    v_mul_f32 v27, v27, v6
    v_cvt_pk_bf16_f32 v28, v24, v25
    v_cvt_pk_bf16_f32 v29, v26, v27
    buffer_store_dwordx2 v[28:29], v12, s[28:31], 0 offen offset:240
    v_mov_b32 v4, v195
    v_mov_b32 v5, v195
    s_nop 1
    v_permlane32_swap_b32 v4, v5
    v_add_f32 v4, v4, v5
    v_rcp_f32 v6, v4
    v_accvgpr_read_b32 v16, a64
    v_accvgpr_read_b32 v17, a65
    v_accvgpr_read_b32 v18, a66
    v_accvgpr_read_b32 v19, a67
    v_mul_f32 v16, v16, v6
    v_mul_f32 v17, v17, v6
    v_mul_f32 v18, v18, v6
    v_mul_f32 v19, v19, v6
    v_cvt_pk_bf16_f32 v20, v16, v17
    v_cvt_pk_bf16_f32 v21, v18, v19
    buffer_store_dwordx2 v[20:21], v13, s[28:31], 0 offen offset:0
    v_accvgpr_read_b32 v24, a68
    v_accvgpr_read_b32 v25, a69
    v_accvgpr_read_b32 v26, a70
    v_accvgpr_read_b32 v27, a71
    v_mul_f32 v24, v24, v6
    v_mul_f32 v25, v25, v6
    v_mul_f32 v26, v26, v6
    v_mul_f32 v27, v27, v6
    v_cvt_pk_bf16_f32 v28, v24, v25
    v_cvt_pk_bf16_f32 v29, v26, v27
    buffer_store_dwordx2 v[28:29], v13, s[28:31], 0 offen offset:16
    v_accvgpr_read_b32 v16, a72
    v_accvgpr_read_b32 v17, a73
    v_accvgpr_read_b32 v18, a74
    v_accvgpr_read_b32 v19, a75
    v_mul_f32 v16, v16, v6
    v_mul_f32 v17, v17, v6
    v_mul_f32 v18, v18, v6
    v_mul_f32 v19, v19, v6
    v_cvt_pk_bf16_f32 v20, v16, v17
    v_cvt_pk_bf16_f32 v21, v18, v19
    buffer_store_dwordx2 v[20:21], v13, s[28:31], 0 offen offset:32
    v_accvgpr_read_b32 v24, a76
    v_accvgpr_read_b32 v25, a77
    v_accvgpr_read_b32 v26, a78
    v_accvgpr_read_b32 v27, a79
    v_mul_f32 v24, v24, v6
    v_mul_f32 v25, v25, v6
    v_mul_f32 v26, v26, v6
    v_mul_f32 v27, v27, v6
    v_cvt_pk_bf16_f32 v28, v24, v25
    v_cvt_pk_bf16_f32 v29, v26, v27
    buffer_store_dwordx2 v[28:29], v13, s[28:31], 0 offen offset:48
    v_accvgpr_read_b32 v16, a80
    v_accvgpr_read_b32 v17, a81
    v_accvgpr_read_b32 v18, a82
    v_accvgpr_read_b32 v19, a83
    v_mul_f32 v16, v16, v6
    v_mul_f32 v17, v17, v6
    v_mul_f32 v18, v18, v6
    v_mul_f32 v19, v19, v6
    v_cvt_pk_bf16_f32 v20, v16, v17
    v_cvt_pk_bf16_f32 v21, v18, v19
    buffer_store_dwordx2 v[20:21], v13, s[28:31], 0 offen offset:64
    v_accvgpr_read_b32 v24, a84
    v_accvgpr_read_b32 v25, a85
    v_accvgpr_read_b32 v26, a86
    v_accvgpr_read_b32 v27, a87
    v_mul_f32 v24, v24, v6
    v_mul_f32 v25, v25, v6
    v_mul_f32 v26, v26, v6
    v_mul_f32 v27, v27, v6
    v_cvt_pk_bf16_f32 v28, v24, v25
    v_cvt_pk_bf16_f32 v29, v26, v27
    buffer_store_dwordx2 v[28:29], v13, s[28:31], 0 offen offset:80
    v_accvgpr_read_b32 v16, a88
    v_accvgpr_read_b32 v17, a89
    v_accvgpr_read_b32 v18, a90
    v_accvgpr_read_b32 v19, a91
    v_mul_f32 v16, v16, v6
    v_mul_f32 v17, v17, v6
    v_mul_f32 v18, v18, v6
    v_mul_f32 v19, v19, v6
    v_cvt_pk_bf16_f32 v20, v16, v17
    v_cvt_pk_bf16_f32 v21, v18, v19
    buffer_store_dwordx2 v[20:21], v13, s[28:31], 0 offen offset:96
    v_accvgpr_read_b32 v24, a92
    v_accvgpr_read_b32 v25, a93
    v_accvgpr_read_b32 v26, a94
    v_accvgpr_read_b32 v27, a95
    v_mul_f32 v24, v24, v6
    v_mul_f32 v25, v25, v6
    v_mul_f32 v26, v26, v6
    v_mul_f32 v27, v27, v6
    v_cvt_pk_bf16_f32 v28, v24, v25
    v_cvt_pk_bf16_f32 v29, v26, v27
    buffer_store_dwordx2 v[28:29], v13, s[28:31], 0 offen offset:112
    v_accvgpr_read_b32 v16, a96
    v_accvgpr_read_b32 v17, a97
    v_accvgpr_read_b32 v18, a98
    v_accvgpr_read_b32 v19, a99
    v_mul_f32 v16, v16, v6
    v_mul_f32 v17, v17, v6
    v_mul_f32 v18, v18, v6
    v_mul_f32 v19, v19, v6
    v_cvt_pk_bf16_f32 v20, v16, v17
    v_cvt_pk_bf16_f32 v21, v18, v19
    buffer_store_dwordx2 v[20:21], v13, s[28:31], 0 offen offset:128
    v_accvgpr_read_b32 v24, a100
    v_accvgpr_read_b32 v25, a101
    v_accvgpr_read_b32 v26, a102
    v_accvgpr_read_b32 v27, a103
    v_mul_f32 v24, v24, v6
    v_mul_f32 v25, v25, v6
    v_mul_f32 v26, v26, v6
    v_mul_f32 v27, v27, v6
    v_cvt_pk_bf16_f32 v28, v24, v25
    v_cvt_pk_bf16_f32 v29, v26, v27
    buffer_store_dwordx2 v[28:29], v13, s[28:31], 0 offen offset:144
    v_accvgpr_read_b32 v16, a104
    v_accvgpr_read_b32 v17, a105
    v_accvgpr_read_b32 v18, a106
    v_accvgpr_read_b32 v19, a107
    v_mul_f32 v16, v16, v6
    v_mul_f32 v17, v17, v6
    v_mul_f32 v18, v18, v6
    v_mul_f32 v19, v19, v6
    v_cvt_pk_bf16_f32 v20, v16, v17
    v_cvt_pk_bf16_f32 v21, v18, v19
    buffer_store_dwordx2 v[20:21], v13, s[28:31], 0 offen offset:160
    v_accvgpr_read_b32 v24, a108
    v_accvgpr_read_b32 v25, a109
    v_accvgpr_read_b32 v26, a110
    v_accvgpr_read_b32 v27, a111
    v_mul_f32 v24, v24, v6
    v_mul_f32 v25, v25, v6
    v_mul_f32 v26, v26, v6
    v_mul_f32 v27, v27, v6
    v_cvt_pk_bf16_f32 v28, v24, v25
    v_cvt_pk_bf16_f32 v29, v26, v27
    buffer_store_dwordx2 v[28:29], v13, s[28:31], 0 offen offset:176
    v_accvgpr_read_b32 v16, a112
    v_accvgpr_read_b32 v17, a113
    v_accvgpr_read_b32 v18, a114
    v_accvgpr_read_b32 v19, a115
    v_mul_f32 v16, v16, v6
    v_mul_f32 v17, v17, v6
    v_mul_f32 v18, v18, v6
    v_mul_f32 v19, v19, v6
    v_cvt_pk_bf16_f32 v20, v16, v17
    v_cvt_pk_bf16_f32 v21, v18, v19
    buffer_store_dwordx2 v[20:21], v13, s[28:31], 0 offen offset:192
    v_accvgpr_read_b32 v24, a116
    v_accvgpr_read_b32 v25, a117
    v_accvgpr_read_b32 v26, a118
    v_accvgpr_read_b32 v27, a119
    v_mul_f32 v24, v24, v6
    v_mul_f32 v25, v25, v6
    v_mul_f32 v26, v26, v6
    v_mul_f32 v27, v27, v6
    v_cvt_pk_bf16_f32 v28, v24, v25
    v_cvt_pk_bf16_f32 v29, v26, v27
    buffer_store_dwordx2 v[28:29], v13, s[28:31], 0 offen offset:208
    v_accvgpr_read_b32 v16, a120
    v_accvgpr_read_b32 v17, a121
    v_accvgpr_read_b32 v18, a122
    v_accvgpr_read_b32 v19, a123
    v_mul_f32 v16, v16, v6
    v_mul_f32 v17, v17, v6
    v_mul_f32 v18, v18, v6
    v_mul_f32 v19, v19, v6
    v_cvt_pk_bf16_f32 v20, v16, v17
    v_cvt_pk_bf16_f32 v21, v18, v19
    buffer_store_dwordx2 v[20:21], v13, s[28:31], 0 offen offset:224
    v_accvgpr_read_b32 v24, a124
    v_accvgpr_read_b32 v25, a125
    v_accvgpr_read_b32 v26, a126
    v_accvgpr_read_b32 v27, a127
    v_mul_f32 v24, v24, v6
    v_mul_f32 v25, v25, v6
    v_mul_f32 v26, v26, v6
    v_mul_f32 v27, v27, v6
    v_cvt_pk_bf16_f32 v28, v24, v25
    v_cvt_pk_bf16_f32 v29, v26, v27
    buffer_store_dwordx2 v[28:29], v13, s[28:31], 0 offen offset:240
MAIN_END:
    s_endpgm
RARE_A0:
    s_nop 7
    v_max3_f32 v252, v0, v1, v2
    v_max3_f32 v252, v252, v3, v4
    v_max3_f32 v252, v252, v5, v6
    v_max3_f32 v252, v252, v7, v8
    v_max3_f32 v252, v252, v9, v10
    v_max3_f32 v252, v252, v11, v12
    v_max3_f32 v252, v252, v13, v14
    v_max3_f32 v252, v252, v15, v32
    v_max3_f32 v252, v252, v33, v34
    v_max3_f32 v252, v252, v35, v36
    v_max3_f32 v252, v252, v37, v38
    v_max3_f32 v252, v252, v39, v40
    v_max3_f32 v252, v252, v41, v42
    v_max3_f32 v252, v252, v43, v44
    v_max3_f32 v252, v252, v45, v46
    v_max_f32 v252, v252, v47
    v_mov_b32 v253, v252
    s_nop 1
    v_permlane32_swap_b32 v252, v253
    v_max_f32 v252, v252, v253
    v_mul_f32 v252, s36, v252
    v_max_f32 v253, v252, -v192
    v_add_f32 v254, v192, v253
    v_exp_f32 v254, -v254
    v_sub_f32 v192, 0, v253
    v_mul_f32 v194, v194, v254
    v_accvgpr_read_b32 v253, a0
    v_mul_f32 v253, v253, v254
    v_accvgpr_write_b32 a0, v253
    v_accvgpr_read_b32 v255, a1
    v_mul_f32 v255, v255, v254
    v_accvgpr_write_b32 a1, v255
    v_accvgpr_read_b32 v253, a2
    v_mul_f32 v253, v253, v254
    v_accvgpr_write_b32 a2, v253
    v_accvgpr_read_b32 v255, a3
    v_mul_f32 v255, v255, v254
    v_accvgpr_write_b32 a3, v255
    v_accvgpr_read_b32 v253, a4
    v_mul_f32 v253, v253, v254
    v_accvgpr_write_b32 a4, v253
    v_accvgpr_read_b32 v255, a5
    v_mul_f32 v255, v255, v254
    v_accvgpr_write_b32 a5, v255
    v_accvgpr_read_b32 v253, a6
    v_mul_f32 v253, v253, v254
    v_accvgpr_write_b32 a6, v253
    v_accvgpr_read_b32 v255, a7
    v_mul_f32 v255, v255, v254
    v_accvgpr_write_b32 a7, v255
    v_accvgpr_read_b32 v253, a8
    v_mul_f32 v253, v253, v254
    v_accvgpr_write_b32 a8, v253
    v_accvgpr_read_b32 v255, a9
    v_mul_f32 v255, v255, v254
    v_accvgpr_write_b32 a9, v255
    v_accvgpr_read_b32 v253, a10
    v_mul_f32 v253, v253, v254
    v_accvgpr_write_b32 a10, v253
    v_accvgpr_read_b32 v255, a11
    v_mul_f32 v255, v255, v254
    v_accvgpr_write_b32 a11, v255
    v_accvgpr_read_b32 v253, a12
    v_mul_f32 v253, v253, v254
    v_accvgpr_write_b32 a12, v253
    v_accvgpr_read_b32 v255, a13
    v_mul_f32 v255, v255, v254
    v_accvgpr_write_b32 a13, v255
    v_accvgpr_read_b32 v253, a14
    v_mul_f32 v253, v253, v254
    v_accvgpr_write_b32 a14, v253
    v_accvgpr_read_b32 v255, a15
    v_mul_f32 v255, v255, v254
    v_accvgpr_write_b32 a15, v255
    v_accvgpr_read_b32 v253, a16
    v_mul_f32 v253, v253, v254
    v_accvgpr_write_b32 a16, v253
    v_accvgpr_read_b32 v255, a17
    v_mul_f32 v255, v255, v254
    v_accvgpr_write_b32 a17, v255
    v_accvgpr_read_b32 v253, a18
    v_mul_f32 v253, v253, v254
    v_accvgpr_write_b32 a18, v253
    v_accvgpr_read_b32 v255, a19
    v_mul_f32 v255, v255, v254
    v_accvgpr_write_b32 a19, v255
    v_accvgpr_read_b32 v253, a20
    v_mul_f32 v253, v253, v254
    v_accvgpr_write_b32 a20, v253
    v_accvgpr_read_b32 v255, a21
    v_mul_f32 v255, v255, v254
    v_accvgpr_write_b32 a21, v255
    v_accvgpr_read_b32 v253, a22
    v_mul_f32 v253, v253, v254
    v_accvgpr_write_b32 a22, v253
    v_accvgpr_read_b32 v255, a23
    v_mul_f32 v255, v255, v254
    v_accvgpr_write_b32 a23, v255
    v_accvgpr_read_b32 v253, a24
    v_mul_f32 v253, v253, v254
    v_accvgpr_write_b32 a24, v253
    v_accvgpr_read_b32 v255, a25
    v_mul_f32 v255, v255, v254
    v_accvgpr_write_b32 a25, v255
    v_accvgpr_read_b32 v253, a26
    v_mul_f32 v253, v253, v254
    v_accvgpr_write_b32 a26, v253
    v_accvgpr_read_b32 v255, a27
    v_mul_f32 v255, v255, v254
    v_accvgpr_write_b32 a27, v255
    v_accvgpr_read_b32 v253, a28
    v_mul_f32 v253, v253, v254
    v_accvgpr_write_b32 a28, v253
    v_accvgpr_read_b32 v255, a29
    v_mul_f32 v255, v255, v254
    v_accvgpr_write_b32 a29, v255
    v_accvgpr_read_b32 v253, a30
    v_mul_f32 v253, v253, v254
    v_accvgpr_write_b32 a30, v253
    v_accvgpr_read_b32 v255, a31
    v_mul_f32 v255, v255, v254
    v_accvgpr_write_b32 a31, v255
    v_accvgpr_read_b32 v253, a32
    v_mul_f32 v253, v253, v254
    v_accvgpr_write_b32 a32, v253
    v_accvgpr_read_b32 v255, a33
    v_mul_f32 v255, v255, v254
    v_accvgpr_write_b32 a33, v255
    v_accvgpr_read_b32 v253, a34
    v_mul_f32 v253, v253, v254
    v_accvgpr_write_b32 a34, v253
    v_accvgpr_read_b32 v255, a35
    v_mul_f32 v255, v255, v254
    v_accvgpr_write_b32 a35, v255
    v_accvgpr_read_b32 v253, a36
    v_mul_f32 v253, v253, v254
    v_accvgpr_write_b32 a36, v253
    v_accvgpr_read_b32 v255, a37
    v_mul_f32 v255, v255, v254
    v_accvgpr_write_b32 a37, v255
    v_accvgpr_read_b32 v253, a38
    v_mul_f32 v253, v253, v254
    v_accvgpr_write_b32 a38, v253
    v_accvgpr_read_b32 v255, a39
    v_mul_f32 v255, v255, v254
    v_accvgpr_write_b32 a39, v255
    v_accvgpr_read_b32 v253, a40
    v_mul_f32 v253, v253, v254
    v_accvgpr_write_b32 a40, v253
    v_accvgpr_read_b32 v255, a41
    v_mul_f32 v255, v255, v254
    v_accvgpr_write_b32 a41, v255
    v_accvgpr_read_b32 v253, a42
    v_mul_f32 v253, v253, v254
    v_accvgpr_write_b32 a42, v253
    v_accvgpr_read_b32 v255, a43
    v_mul_f32 v255, v255, v254
    v_accvgpr_write_b32 a43, v255
    v_accvgpr_read_b32 v253, a44
    v_mul_f32 v253, v253, v254
    v_accvgpr_write_b32 a44, v253
    v_accvgpr_read_b32 v255, a45
    v_mul_f32 v255, v255, v254
    v_accvgpr_write_b32 a45, v255
    v_accvgpr_read_b32 v253, a46
    v_mul_f32 v253, v253, v254
    v_accvgpr_write_b32 a46, v253
    v_accvgpr_read_b32 v255, a47
    v_mul_f32 v255, v255, v254
    v_accvgpr_write_b32 a47, v255
    v_accvgpr_read_b32 v253, a48
    v_mul_f32 v253, v253, v254
    v_accvgpr_write_b32 a48, v253
    v_accvgpr_read_b32 v255, a49
    v_mul_f32 v255, v255, v254
    v_accvgpr_write_b32 a49, v255
    v_accvgpr_read_b32 v253, a50
    v_mul_f32 v253, v253, v254
    v_accvgpr_write_b32 a50, v253
    v_accvgpr_read_b32 v255, a51
    v_mul_f32 v255, v255, v254
    v_accvgpr_write_b32 a51, v255
    v_accvgpr_read_b32 v253, a52
    v_mul_f32 v253, v253, v254
    v_accvgpr_write_b32 a52, v253
    v_accvgpr_read_b32 v255, a53
    v_mul_f32 v255, v255, v254
    v_accvgpr_write_b32 a53, v255
    v_accvgpr_read_b32 v253, a54
    v_mul_f32 v253, v253, v254
    v_accvgpr_write_b32 a54, v253
    v_accvgpr_read_b32 v255, a55
    v_mul_f32 v255, v255, v254
    v_accvgpr_write_b32 a55, v255
    v_accvgpr_read_b32 v253, a56
    v_mul_f32 v253, v253, v254
    v_accvgpr_write_b32 a56, v253
    v_accvgpr_read_b32 v255, a57
    v_mul_f32 v255, v255, v254
    v_accvgpr_write_b32 a57, v255
    v_accvgpr_read_b32 v253, a58
    v_mul_f32 v253, v253, v254
    v_accvgpr_write_b32 a58, v253
    v_accvgpr_read_b32 v255, a59
    v_mul_f32 v255, v255, v254
    v_accvgpr_write_b32 a59, v255
    v_accvgpr_read_b32 v253, a60
    v_mul_f32 v253, v253, v254
    v_accvgpr_write_b32 a60, v253
    v_accvgpr_read_b32 v255, a61
    v_mul_f32 v255, v255, v254
    v_accvgpr_write_b32 a61, v255
    v_accvgpr_read_b32 v253, a62
    v_mul_f32 v253, v253, v254
    v_accvgpr_write_b32 a62, v253
    v_accvgpr_read_b32 v255, a63
    v_mul_f32 v255, v255, v254
    v_accvgpr_write_b32 a63, v255
    v_mov_b32 v196, 0
    v_fma_f32 v198, v0, s36, v192
    v_exp_f32 v201, v198
    s_nop 0
    v_add_f32 v196, v196, v201
    v_fma_f32 v198, v1, s36, v192
    v_exp_f32 v202, v198
    s_nop 0
    v_add_f32 v196, v196, v202
    v_cvt_pk_bf16_f32 v128, v201, v202
    v_fma_f32 v198, v2, s36, v192
    v_exp_f32 v201, v198
    s_nop 0
    v_add_f32 v196, v196, v201
    v_fma_f32 v198, v3, s36, v192
    v_exp_f32 v202, v198
    s_nop 0
    v_add_f32 v196, v196, v202
    v_cvt_pk_bf16_f32 v129, v201, v202
    v_fma_f32 v198, v4, s36, v192
    v_exp_f32 v201, v198
    s_nop 0
    v_add_f32 v196, v196, v201
    v_fma_f32 v198, v5, s36, v192
    v_exp_f32 v202, v198
    s_nop 0
    v_add_f32 v196, v196, v202
    v_cvt_pk_bf16_f32 v130, v201, v202
    v_fma_f32 v198, v6, s36, v192
    v_exp_f32 v201, v198
    s_nop 0
    v_add_f32 v196, v196, v201
    v_fma_f32 v198, v7, s36, v192
    v_exp_f32 v202, v198
    s_nop 0
    v_add_f32 v196, v196, v202
    v_cvt_pk_bf16_f32 v131, v201, v202
    v_fma_f32 v198, v8, s36, v192
    v_exp_f32 v201, v198
    s_nop 0
    v_add_f32 v196, v196, v201
    v_fma_f32 v198, v9, s36, v192
    v_exp_f32 v202, v198
    s_nop 0
    v_add_f32 v196, v196, v202
    v_cvt_pk_bf16_f32 v132, v201, v202
    v_fma_f32 v198, v10, s36, v192
    v_exp_f32 v201, v198
    s_nop 0
    v_add_f32 v196, v196, v201
    v_fma_f32 v198, v11, s36, v192
    v_exp_f32 v202, v198
    s_nop 0
    v_add_f32 v196, v196, v202
    v_cvt_pk_bf16_f32 v133, v201, v202
    v_fma_f32 v198, v12, s36, v192
    v_exp_f32 v201, v198
    s_nop 0
    v_add_f32 v196, v196, v201
    v_fma_f32 v198, v13, s36, v192
    v_exp_f32 v202, v198
    s_nop 0
    v_add_f32 v196, v196, v202
    v_cvt_pk_bf16_f32 v134, v201, v202
    v_fma_f32 v198, v14, s36, v192
    v_exp_f32 v201, v198
    s_nop 0
    v_add_f32 v196, v196, v201
    v_fma_f32 v198, v15, s36, v192
    v_exp_f32 v202, v198
    s_nop 0
    v_add_f32 v196, v196, v202
    v_cvt_pk_bf16_f32 v135, v201, v202
    v_fma_f32 v198, v32, s36, v192
    v_exp_f32 v201, v198
    s_nop 0
    v_add_f32 v196, v196, v201
    v_fma_f32 v198, v33, s36, v192
    v_exp_f32 v202, v198
    s_nop 0
    v_add_f32 v196, v196, v202
    v_cvt_pk_bf16_f32 v136, v201, v202
    v_fma_f32 v198, v34, s36, v192
    v_exp_f32 v201, v198
    s_nop 0
    v_add_f32 v196, v196, v201
    v_fma_f32 v198, v35, s36, v192
    v_exp_f32 v202, v198
    s_nop 0
    v_add_f32 v196, v196, v202
    v_cvt_pk_bf16_f32 v137, v201, v202
    v_fma_f32 v198, v36, s36, v192
    v_exp_f32 v201, v198
    s_nop 0
    v_add_f32 v196, v196, v201
    v_fma_f32 v198, v37, s36, v192
    v_exp_f32 v202, v198
    s_nop 0
    v_add_f32 v196, v196, v202
    v_cvt_pk_bf16_f32 v138, v201, v202
    v_fma_f32 v198, v38, s36, v192
    v_exp_f32 v201, v198
    s_nop 0
    v_add_f32 v196, v196, v201
    v_fma_f32 v198, v39, s36, v192
    v_exp_f32 v202, v198
    s_nop 0
    v_add_f32 v196, v196, v202
    v_cvt_pk_bf16_f32 v139, v201, v202
    v_fma_f32 v198, v40, s36, v192
    v_exp_f32 v201, v198
    s_nop 0
    v_add_f32 v196, v196, v201
    v_fma_f32 v198, v41, s36, v192
    v_exp_f32 v202, v198
    s_nop 0
    v_add_f32 v196, v196, v202
    v_cvt_pk_bf16_f32 v140, v201, v202
    v_fma_f32 v198, v42, s36, v192
    v_exp_f32 v201, v198
    s_nop 0
    v_add_f32 v196, v196, v201
    v_fma_f32 v198, v43, s36, v192
    v_exp_f32 v202, v198
    s_nop 0
    v_add_f32 v196, v196, v202
    v_cvt_pk_bf16_f32 v141, v201, v202
    v_fma_f32 v198, v44, s36, v192
    v_exp_f32 v201, v198
    s_nop 0
    v_add_f32 v196, v196, v201
    v_fma_f32 v198, v45, s36, v192
    v_exp_f32 v202, v198
    s_nop 0
    v_add_f32 v196, v196, v202
    v_cvt_pk_bf16_f32 v142, v201, v202
    v_fma_f32 v198, v46, s36, v192
    v_exp_f32 v201, v198
    s_nop 0
    v_add_f32 v196, v196, v201
    v_fma_f32 v198, v47, s36, v192
    v_exp_f32 v202, v198
    s_nop 0
    v_add_f32 v196, v196, v202
    v_cvt_pk_bf16_f32 v143, v201, v202
    v_add_f32 v194, v194, v196
    v_mov_b32 v196, 0
    v_max3_f32 v252, v16, v17, v18
    v_max3_f32 v252, v252, v19, v20
    v_max3_f32 v252, v252, v21, v22
    v_max3_f32 v252, v252, v23, v24
    v_max3_f32 v252, v252, v25, v26
    v_max3_f32 v252, v252, v27, v28
    v_max3_f32 v252, v252, v29, v30
    v_max3_f32 v252, v252, v31, v48
    v_max3_f32 v252, v252, v49, v50
    v_max3_f32 v252, v252, v51, v52
    v_max3_f32 v252, v252, v53, v54
    v_max3_f32 v252, v252, v55, v56
    v_max3_f32 v252, v252, v57, v58
    v_max3_f32 v252, v252, v59, v60
    v_max3_f32 v252, v252, v61, v62
    v_max_f32 v252, v252, v63
    v_mov_b32 v253, v252
    s_nop 1
    v_permlane32_swap_b32 v252, v253
    v_max_f32 v252, v252, v253
    v_mul_f32 v252, s36, v252
    v_max_f32 v253, v252, -v193
    v_add_f32 v254, v193, v253
    v_exp_f32 v254, -v254
    v_sub_f32 v193, 0, v253
    v_mul_f32 v195, v195, v254
    v_accvgpr_read_b32 v253, a64
    v_mul_f32 v253, v253, v254
    v_accvgpr_write_b32 a64, v253
    v_accvgpr_read_b32 v255, a65
    v_mul_f32 v255, v255, v254
    v_accvgpr_write_b32 a65, v255
    v_accvgpr_read_b32 v253, a66
    v_mul_f32 v253, v253, v254
    v_accvgpr_write_b32 a66, v253
    v_accvgpr_read_b32 v255, a67
    v_mul_f32 v255, v255, v254
    v_accvgpr_write_b32 a67, v255
    v_accvgpr_read_b32 v253, a68
    v_mul_f32 v253, v253, v254
    v_accvgpr_write_b32 a68, v253
    v_accvgpr_read_b32 v255, a69
    v_mul_f32 v255, v255, v254
    v_accvgpr_write_b32 a69, v255
    v_accvgpr_read_b32 v253, a70
    v_mul_f32 v253, v253, v254
    v_accvgpr_write_b32 a70, v253
    v_accvgpr_read_b32 v255, a71
    v_mul_f32 v255, v255, v254
    v_accvgpr_write_b32 a71, v255
    v_accvgpr_read_b32 v253, a72
    v_mul_f32 v253, v253, v254
    v_accvgpr_write_b32 a72, v253
    v_accvgpr_read_b32 v255, a73
    v_mul_f32 v255, v255, v254
    v_accvgpr_write_b32 a73, v255
    v_accvgpr_read_b32 v253, a74
    v_mul_f32 v253, v253, v254
    v_accvgpr_write_b32 a74, v253
    v_accvgpr_read_b32 v255, a75
    v_mul_f32 v255, v255, v254
    v_accvgpr_write_b32 a75, v255
    v_accvgpr_read_b32 v253, a76
    v_mul_f32 v253, v253, v254
    v_accvgpr_write_b32 a76, v253
    v_accvgpr_read_b32 v255, a77
    v_mul_f32 v255, v255, v254
    v_accvgpr_write_b32 a77, v255
    v_accvgpr_read_b32 v253, a78
    v_mul_f32 v253, v253, v254
    v_accvgpr_write_b32 a78, v253
    v_accvgpr_read_b32 v255, a79
    v_mul_f32 v255, v255, v254
    v_accvgpr_write_b32 a79, v255
    v_accvgpr_read_b32 v253, a80
    v_mul_f32 v253, v253, v254
    v_accvgpr_write_b32 a80, v253
    v_accvgpr_read_b32 v255, a81
    v_mul_f32 v255, v255, v254
    v_accvgpr_write_b32 a81, v255
    v_accvgpr_read_b32 v253, a82
    v_mul_f32 v253, v253, v254
    v_accvgpr_write_b32 a82, v253
    v_accvgpr_read_b32 v255, a83
    v_mul_f32 v255, v255, v254
    v_accvgpr_write_b32 a83, v255
    v_accvgpr_read_b32 v253, a84
    v_mul_f32 v253, v253, v254
    v_accvgpr_write_b32 a84, v253
    v_accvgpr_read_b32 v255, a85
    v_mul_f32 v255, v255, v254
    v_accvgpr_write_b32 a85, v255
    v_accvgpr_read_b32 v253, a86
    v_mul_f32 v253, v253, v254
    v_accvgpr_write_b32 a86, v253
    v_accvgpr_read_b32 v255, a87
    v_mul_f32 v255, v255, v254
    v_accvgpr_write_b32 a87, v255
    v_accvgpr_read_b32 v253, a88
    v_mul_f32 v253, v253, v254
    v_accvgpr_write_b32 a88, v253
    v_accvgpr_read_b32 v255, a89
    v_mul_f32 v255, v255, v254
    v_accvgpr_write_b32 a89, v255
    v_accvgpr_read_b32 v253, a90
    v_mul_f32 v253, v253, v254
    v_accvgpr_write_b32 a90, v253
    v_accvgpr_read_b32 v255, a91
    v_mul_f32 v255, v255, v254
    v_accvgpr_write_b32 a91, v255
    v_accvgpr_read_b32 v253, a92
    v_mul_f32 v253, v253, v254
    v_accvgpr_write_b32 a92, v253
    v_accvgpr_read_b32 v255, a93
    v_mul_f32 v255, v255, v254
    v_accvgpr_write_b32 a93, v255
    v_accvgpr_read_b32 v253, a94
    v_mul_f32 v253, v253, v254
    v_accvgpr_write_b32 a94, v253
    v_accvgpr_read_b32 v255, a95
    v_mul_f32 v255, v255, v254
    v_accvgpr_write_b32 a95, v255
    v_accvgpr_read_b32 v253, a96
    v_mul_f32 v253, v253, v254
    v_accvgpr_write_b32 a96, v253
    v_accvgpr_read_b32 v255, a97
    v_mul_f32 v255, v255, v254
    v_accvgpr_write_b32 a97, v255
    v_accvgpr_read_b32 v253, a98
    v_mul_f32 v253, v253, v254
    v_accvgpr_write_b32 a98, v253
    v_accvgpr_read_b32 v255, a99
    v_mul_f32 v255, v255, v254
    v_accvgpr_write_b32 a99, v255
    v_accvgpr_read_b32 v253, a100
    v_mul_f32 v253, v253, v254
    v_accvgpr_write_b32 a100, v253
    v_accvgpr_read_b32 v255, a101
    v_mul_f32 v255, v255, v254
    v_accvgpr_write_b32 a101, v255
    v_accvgpr_read_b32 v253, a102
    v_mul_f32 v253, v253, v254
    v_accvgpr_write_b32 a102, v253
    v_accvgpr_read_b32 v255, a103
    v_mul_f32 v255, v255, v254
    v_accvgpr_write_b32 a103, v255
    v_accvgpr_read_b32 v253, a104
    v_mul_f32 v253, v253, v254
    v_accvgpr_write_b32 a104, v253
    v_accvgpr_read_b32 v255, a105
    v_mul_f32 v255, v255, v254
    v_accvgpr_write_b32 a105, v255
    v_accvgpr_read_b32 v253, a106
    v_mul_f32 v253, v253, v254
    v_accvgpr_write_b32 a106, v253
    v_accvgpr_read_b32 v255, a107
    v_mul_f32 v255, v255, v254
    v_accvgpr_write_b32 a107, v255
    v_accvgpr_read_b32 v253, a108
    v_mul_f32 v253, v253, v254
    v_accvgpr_write_b32 a108, v253
    v_accvgpr_read_b32 v255, a109
    v_mul_f32 v255, v255, v254
    v_accvgpr_write_b32 a109, v255
    v_accvgpr_read_b32 v253, a110
    v_mul_f32 v253, v253, v254
    v_accvgpr_write_b32 a110, v253
    v_accvgpr_read_b32 v255, a111
    v_mul_f32 v255, v255, v254
    v_accvgpr_write_b32 a111, v255
    v_accvgpr_read_b32 v253, a112
    v_mul_f32 v253, v253, v254
    v_accvgpr_write_b32 a112, v253
    v_accvgpr_read_b32 v255, a113
    v_mul_f32 v255, v255, v254
    v_accvgpr_write_b32 a113, v255
    v_accvgpr_read_b32 v253, a114
    v_mul_f32 v253, v253, v254
    v_accvgpr_write_b32 a114, v253
    v_accvgpr_read_b32 v255, a115
    v_mul_f32 v255, v255, v254
    v_accvgpr_write_b32 a115, v255
    v_accvgpr_read_b32 v253, a116
    v_mul_f32 v253, v253, v254
    v_accvgpr_write_b32 a116, v253
    v_accvgpr_read_b32 v255, a117
    v_mul_f32 v255, v255, v254
    v_accvgpr_write_b32 a117, v255
    v_accvgpr_read_b32 v253, a118
    v_mul_f32 v253, v253, v254
    v_accvgpr_write_b32 a118, v253
    v_accvgpr_read_b32 v255, a119
    v_mul_f32 v255, v255, v254
    v_accvgpr_write_b32 a119, v255
    v_accvgpr_read_b32 v253, a120
    v_mul_f32 v253, v253, v254
    v_accvgpr_write_b32 a120, v253
    v_accvgpr_read_b32 v255, a121
    v_mul_f32 v255, v255, v254
    v_accvgpr_write_b32 a121, v255
    v_accvgpr_read_b32 v253, a122
    v_mul_f32 v253, v253, v254
    v_accvgpr_write_b32 a122, v253
    v_accvgpr_read_b32 v255, a123
    v_mul_f32 v255, v255, v254
    v_accvgpr_write_b32 a123, v255
    v_accvgpr_read_b32 v253, a124
    v_mul_f32 v253, v253, v254
    v_accvgpr_write_b32 a124, v253
    v_accvgpr_read_b32 v255, a125
    v_mul_f32 v255, v255, v254
    v_accvgpr_write_b32 a125, v255
    v_accvgpr_read_b32 v253, a126
    v_mul_f32 v253, v253, v254
    v_accvgpr_write_b32 a126, v253
    v_accvgpr_read_b32 v255, a127
    v_mul_f32 v255, v255, v254
    v_accvgpr_write_b32 a127, v255
    v_mov_b32 v197, 0
    v_fma_f32 v198, v16, s36, v193
    v_exp_f32 v201, v198
    s_nop 0
    v_add_f32 v197, v197, v201
    v_fma_f32 v198, v17, s36, v193
    v_exp_f32 v202, v198
    s_nop 0
    v_add_f32 v197, v197, v202
    v_cvt_pk_bf16_f32 v144, v201, v202
    v_fma_f32 v198, v18, s36, v193
    v_exp_f32 v201, v198
    s_nop 0
    v_add_f32 v197, v197, v201
    v_fma_f32 v198, v19, s36, v193
    v_exp_f32 v202, v198
    s_nop 0
    v_add_f32 v197, v197, v202
    v_cvt_pk_bf16_f32 v145, v201, v202
    v_fma_f32 v198, v20, s36, v193
    v_exp_f32 v201, v198
    s_nop 0
    v_add_f32 v197, v197, v201
    v_fma_f32 v198, v21, s36, v193
    v_exp_f32 v202, v198
    s_nop 0
    v_add_f32 v197, v197, v202
    v_cvt_pk_bf16_f32 v146, v201, v202
    v_fma_f32 v198, v22, s36, v193
    v_exp_f32 v201, v198
    s_nop 0
    v_add_f32 v197, v197, v201
    v_fma_f32 v198, v23, s36, v193
    v_exp_f32 v202, v198
    s_nop 0
    v_add_f32 v197, v197, v202
    v_cvt_pk_bf16_f32 v147, v201, v202
    v_fma_f32 v198, v24, s36, v193
    v_exp_f32 v201, v198
    s_nop 0
    v_add_f32 v197, v197, v201
    v_fma_f32 v198, v25, s36, v193
    v_exp_f32 v202, v198
    s_nop 0
    v_add_f32 v197, v197, v202
    v_cvt_pk_bf16_f32 v148, v201, v202
    v_fma_f32 v198, v26, s36, v193
    v_exp_f32 v201, v198
    s_nop 0
    v_add_f32 v197, v197, v201
    v_fma_f32 v198, v27, s36, v193
    v_exp_f32 v202, v198
    s_nop 0
    v_add_f32 v197, v197, v202
    v_cvt_pk_bf16_f32 v149, v201, v202
    v_fma_f32 v198, v28, s36, v193
    v_exp_f32 v201, v198
    s_nop 0
    v_add_f32 v197, v197, v201
    v_fma_f32 v198, v29, s36, v193
    v_exp_f32 v202, v198
    s_nop 0
    v_add_f32 v197, v197, v202
    v_cvt_pk_bf16_f32 v150, v201, v202
    v_fma_f32 v198, v30, s36, v193
    v_exp_f32 v201, v198
    s_nop 0
    v_add_f32 v197, v197, v201
    v_fma_f32 v198, v31, s36, v193
    v_exp_f32 v202, v198
    s_nop 0
    v_add_f32 v197, v197, v202
    v_cvt_pk_bf16_f32 v151, v201, v202
    v_fma_f32 v198, v48, s36, v193
    v_exp_f32 v201, v198
    s_nop 0
    v_add_f32 v197, v197, v201
    v_fma_f32 v198, v49, s36, v193
    v_exp_f32 v202, v198
    s_nop 0
    v_add_f32 v197, v197, v202
    v_cvt_pk_bf16_f32 v152, v201, v202
    v_fma_f32 v198, v50, s36, v193
    v_exp_f32 v201, v198
    s_nop 0
    v_add_f32 v197, v197, v201
    v_fma_f32 v198, v51, s36, v193
    v_exp_f32 v202, v198
    s_nop 0
    v_add_f32 v197, v197, v202
    v_cvt_pk_bf16_f32 v153, v201, v202
    v_fma_f32 v198, v52, s36, v193
    v_exp_f32 v201, v198
    s_nop 0
    v_add_f32 v197, v197, v201
    v_fma_f32 v198, v53, s36, v193
    v_exp_f32 v202, v198
    s_nop 0
    v_add_f32 v197, v197, v202
    v_cvt_pk_bf16_f32 v154, v201, v202
    v_fma_f32 v198, v54, s36, v193
    v_exp_f32 v201, v198
    s_nop 0
    v_add_f32 v197, v197, v201
    v_fma_f32 v198, v55, s36, v193
    v_exp_f32 v202, v198
    s_nop 0
    v_add_f32 v197, v197, v202
    v_cvt_pk_bf16_f32 v155, v201, v202
    v_fma_f32 v198, v56, s36, v193
    v_exp_f32 v201, v198
    s_nop 0
    v_add_f32 v197, v197, v201
    v_fma_f32 v198, v57, s36, v193
    v_exp_f32 v202, v198
    s_nop 0
    v_add_f32 v197, v197, v202
    v_cvt_pk_bf16_f32 v156, v201, v202
    v_fma_f32 v198, v58, s36, v193
    v_exp_f32 v201, v198
    s_nop 0
    v_add_f32 v197, v197, v201
    v_fma_f32 v198, v59, s36, v193
    v_exp_f32 v202, v198
    s_nop 0
    v_add_f32 v197, v197, v202
    v_cvt_pk_bf16_f32 v157, v201, v202
    v_fma_f32 v198, v60, s36, v193
    v_exp_f32 v201, v198
    s_nop 0
    v_add_f32 v197, v197, v201
    v_fma_f32 v198, v61, s36, v193
    v_exp_f32 v202, v198
    s_nop 0
    v_add_f32 v197, v197, v202
    v_cvt_pk_bf16_f32 v158, v201, v202
    v_fma_f32 v198, v62, s36, v193
    v_exp_f32 v201, v198
    s_nop 0
    v_add_f32 v197, v197, v201
    v_fma_f32 v198, v63, s36, v193
    v_exp_f32 v202, v198
    s_nop 0
    v_add_f32 v197, v197, v202
    v_cvt_pk_bf16_f32 v159, v201, v202
    v_add_f32 v195, v195, v197
    v_mov_b32 v197, 0
    s_nop 3
    s_branch BACK_A0
RARE_A1:
    s_nop 7
    v_max3_f32 v252, v64, v65, v66
    v_max3_f32 v252, v252, v67, v68
    v_max3_f32 v252, v252, v69, v70
    v_max3_f32 v252, v252, v71, v72
    v_max3_f32 v252, v252, v73, v74
    v_max3_f32 v252, v252, v75, v76
    v_max3_f32 v252, v252, v77, v78
    v_max3_f32 v252, v252, v79, v96
    v_max3_f32 v252, v252, v97, v98
    v_max3_f32 v252, v252, v99, v100
    v_max3_f32 v252, v252, v101, v102
    v_max3_f32 v252, v252, v103, v104
    v_max3_f32 v252, v252, v105, v106
    v_max3_f32 v252, v252, v107, v108
    v_max3_f32 v252, v252, v109, v110
    v_max_f32 v252, v252, v111
    v_mov_b32 v253, v252
    s_nop 1
    v_permlane32_swap_b32 v252, v253
    v_max_f32 v252, v252, v253
    v_mul_f32 v252, s36, v252
    v_max_f32 v253, v252, -v192
    v_add_f32 v254, v192, v253
    v_exp_f32 v254, -v254
    v_sub_f32 v192, 0, v253
    v_mul_f32 v194, v194, v254
    v_accvgpr_read_b32 v253, a0
    v_mul_f32 v253, v253, v254
    v_accvgpr_write_b32 a0, v253
    v_accvgpr_read_b32 v255, a1
    v_mul_f32 v255, v255, v254
    v_accvgpr_write_b32 a1, v255
    v_accvgpr_read_b32 v253, a2
    v_mul_f32 v253, v253, v254
    v_accvgpr_write_b32 a2, v253
    v_accvgpr_read_b32 v255, a3
    v_mul_f32 v255, v255, v254
    v_accvgpr_write_b32 a3, v255
    v_accvgpr_read_b32 v253, a4
    v_mul_f32 v253, v253, v254
    v_accvgpr_write_b32 a4, v253
    v_accvgpr_read_b32 v255, a5
    v_mul_f32 v255, v255, v254
    v_accvgpr_write_b32 a5, v255
    v_accvgpr_read_b32 v253, a6
    v_mul_f32 v253, v253, v254
    v_accvgpr_write_b32 a6, v253
    v_accvgpr_read_b32 v255, a7
    v_mul_f32 v255, v255, v254
    v_accvgpr_write_b32 a7, v255
    v_accvgpr_read_b32 v253, a8
    v_mul_f32 v253, v253, v254
    v_accvgpr_write_b32 a8, v253
    v_accvgpr_read_b32 v255, a9
    v_mul_f32 v255, v255, v254
    v_accvgpr_write_b32 a9, v255
    v_accvgpr_read_b32 v253, a10
    v_mul_f32 v253, v253, v254
    v_accvgpr_write_b32 a10, v253
    v_accvgpr_read_b32 v255, a11
    v_mul_f32 v255, v255, v254
    v_accvgpr_write_b32 a11, v255
    v_accvgpr_read_b32 v253, a12
    v_mul_f32 v253, v253, v254
    v_accvgpr_write_b32 a12, v253
    v_accvgpr_read_b32 v255, a13
    v_mul_f32 v255, v255, v254
    v_accvgpr_write_b32 a13, v255
    v_accvgpr_read_b32 v253, a14
    v_mul_f32 v253, v253, v254
    v_accvgpr_write_b32 a14, v253
    v_accvgpr_read_b32 v255, a15
    v_mul_f32 v255, v255, v254
    v_accvgpr_write_b32 a15, v255
    v_accvgpr_read_b32 v253, a16
    v_mul_f32 v253, v253, v254
    v_accvgpr_write_b32 a16, v253
    v_accvgpr_read_b32 v255, a17
    v_mul_f32 v255, v255, v254
    v_accvgpr_write_b32 a17, v255
    v_accvgpr_read_b32 v253, a18
    v_mul_f32 v253, v253, v254
    v_accvgpr_write_b32 a18, v253
    v_accvgpr_read_b32 v255, a19
    v_mul_f32 v255, v255, v254
    v_accvgpr_write_b32 a19, v255
    v_accvgpr_read_b32 v253, a20
    v_mul_f32 v253, v253, v254
    v_accvgpr_write_b32 a20, v253
    v_accvgpr_read_b32 v255, a21
    v_mul_f32 v255, v255, v254
    v_accvgpr_write_b32 a21, v255
    v_accvgpr_read_b32 v253, a22
    v_mul_f32 v253, v253, v254
    v_accvgpr_write_b32 a22, v253
    v_accvgpr_read_b32 v255, a23
    v_mul_f32 v255, v255, v254
    v_accvgpr_write_b32 a23, v255
    v_accvgpr_read_b32 v253, a24
    v_mul_f32 v253, v253, v254
    v_accvgpr_write_b32 a24, v253
    v_accvgpr_read_b32 v255, a25
    v_mul_f32 v255, v255, v254
    v_accvgpr_write_b32 a25, v255
    v_accvgpr_read_b32 v253, a26
    v_mul_f32 v253, v253, v254
    v_accvgpr_write_b32 a26, v253
    v_accvgpr_read_b32 v255, a27
    v_mul_f32 v255, v255, v254
    v_accvgpr_write_b32 a27, v255
    v_accvgpr_read_b32 v253, a28
    v_mul_f32 v253, v253, v254
    v_accvgpr_write_b32 a28, v253
    v_accvgpr_read_b32 v255, a29
    v_mul_f32 v255, v255, v254
    v_accvgpr_write_b32 a29, v255
    v_accvgpr_read_b32 v253, a30
    v_mul_f32 v253, v253, v254
    v_accvgpr_write_b32 a30, v253
    v_accvgpr_read_b32 v255, a31
    v_mul_f32 v255, v255, v254
    v_accvgpr_write_b32 a31, v255
    v_accvgpr_read_b32 v253, a32
    v_mul_f32 v253, v253, v254
    v_accvgpr_write_b32 a32, v253
    v_accvgpr_read_b32 v255, a33
    v_mul_f32 v255, v255, v254
    v_accvgpr_write_b32 a33, v255
    v_accvgpr_read_b32 v253, a34
    v_mul_f32 v253, v253, v254
    v_accvgpr_write_b32 a34, v253
    v_accvgpr_read_b32 v255, a35
    v_mul_f32 v255, v255, v254
    v_accvgpr_write_b32 a35, v255
    v_accvgpr_read_b32 v253, a36
    v_mul_f32 v253, v253, v254
    v_accvgpr_write_b32 a36, v253
    v_accvgpr_read_b32 v255, a37
    v_mul_f32 v255, v255, v254
    v_accvgpr_write_b32 a37, v255
    v_accvgpr_read_b32 v253, a38
    v_mul_f32 v253, v253, v254
    v_accvgpr_write_b32 a38, v253
    v_accvgpr_read_b32 v255, a39
    v_mul_f32 v255, v255, v254
    v_accvgpr_write_b32 a39, v255
    v_accvgpr_read_b32 v253, a40
    v_mul_f32 v253, v253, v254
    v_accvgpr_write_b32 a40, v253
    v_accvgpr_read_b32 v255, a41
    v_mul_f32 v255, v255, v254
    v_accvgpr_write_b32 a41, v255
    v_accvgpr_read_b32 v253, a42
    v_mul_f32 v253, v253, v254
    v_accvgpr_write_b32 a42, v253
    v_accvgpr_read_b32 v255, a43
    v_mul_f32 v255, v255, v254
    v_accvgpr_write_b32 a43, v255
    v_accvgpr_read_b32 v253, a44
    v_mul_f32 v253, v253, v254
    v_accvgpr_write_b32 a44, v253
    v_accvgpr_read_b32 v255, a45
    v_mul_f32 v255, v255, v254
    v_accvgpr_write_b32 a45, v255
    v_accvgpr_read_b32 v253, a46
    v_mul_f32 v253, v253, v254
    v_accvgpr_write_b32 a46, v253
    v_accvgpr_read_b32 v255, a47
    v_mul_f32 v255, v255, v254
    v_accvgpr_write_b32 a47, v255
    v_accvgpr_read_b32 v253, a48
    v_mul_f32 v253, v253, v254
    v_accvgpr_write_b32 a48, v253
    v_accvgpr_read_b32 v255, a49
    v_mul_f32 v255, v255, v254
    v_accvgpr_write_b32 a49, v255
    v_accvgpr_read_b32 v253, a50
    v_mul_f32 v253, v253, v254
    v_accvgpr_write_b32 a50, v253
    v_accvgpr_read_b32 v255, a51
    v_mul_f32 v255, v255, v254
    v_accvgpr_write_b32 a51, v255
    v_accvgpr_read_b32 v253, a52
    v_mul_f32 v253, v253, v254
    v_accvgpr_write_b32 a52, v253
    v_accvgpr_read_b32 v255, a53
    v_mul_f32 v255, v255, v254
    v_accvgpr_write_b32 a53, v255
    v_accvgpr_read_b32 v253, a54
    v_mul_f32 v253, v253, v254
    v_accvgpr_write_b32 a54, v253
    v_accvgpr_read_b32 v255, a55
    v_mul_f32 v255, v255, v254
    v_accvgpr_write_b32 a55, v255
    v_accvgpr_read_b32 v253, a56
    v_mul_f32 v253, v253, v254
    v_accvgpr_write_b32 a56, v253
    v_accvgpr_read_b32 v255, a57
    v_mul_f32 v255, v255, v254
    v_accvgpr_write_b32 a57, v255
    v_accvgpr_read_b32 v253, a58
    v_mul_f32 v253, v253, v254
    v_accvgpr_write_b32 a58, v253
    v_accvgpr_read_b32 v255, a59
    v_mul_f32 v255, v255, v254
    v_accvgpr_write_b32 a59, v255
    v_accvgpr_read_b32 v253, a60
    v_mul_f32 v253, v253, v254
    v_accvgpr_write_b32 a60, v253
    v_accvgpr_read_b32 v255, a61
    v_mul_f32 v255, v255, v254
    v_accvgpr_write_b32 a61, v255
    v_accvgpr_read_b32 v253, a62
    v_mul_f32 v253, v253, v254
    v_accvgpr_write_b32 a62, v253
    v_accvgpr_read_b32 v255, a63
    v_mul_f32 v255, v255, v254
    v_accvgpr_write_b32 a63, v255
    v_mov_b32 v196, 0
    v_fma_f32 v198, v64, s36, v192
    v_exp_f32 v201, v198
    s_nop 0
    v_add_f32 v196, v196, v201
    v_fma_f32 v198, v65, s36, v192
    v_exp_f32 v202, v198
    s_nop 0
    v_add_f32 v196, v196, v202
    v_cvt_pk_bf16_f32 v160, v201, v202
    v_fma_f32 v198, v66, s36, v192
    v_exp_f32 v201, v198
    s_nop 0
    v_add_f32 v196, v196, v201
    v_fma_f32 v198, v67, s36, v192
    v_exp_f32 v202, v198
    s_nop 0
    v_add_f32 v196, v196, v202
    v_cvt_pk_bf16_f32 v161, v201, v202
    v_fma_f32 v198, v68, s36, v192
    v_exp_f32 v201, v198
    s_nop 0
    v_add_f32 v196, v196, v201
    v_fma_f32 v198, v69, s36, v192
    v_exp_f32 v202, v198
    s_nop 0
    v_add_f32 v196, v196, v202
    v_cvt_pk_bf16_f32 v162, v201, v202
    v_fma_f32 v198, v70, s36, v192
    v_exp_f32 v201, v198
    s_nop 0
    v_add_f32 v196, v196, v201
    v_fma_f32 v198, v71, s36, v192
    v_exp_f32 v202, v198
    s_nop 0
    v_add_f32 v196, v196, v202
    v_cvt_pk_bf16_f32 v163, v201, v202
    v_fma_f32 v198, v72, s36, v192
    v_exp_f32 v201, v198
    s_nop 0
    v_add_f32 v196, v196, v201
    v_fma_f32 v198, v73, s36, v192
    v_exp_f32 v202, v198
    s_nop 0
    v_add_f32 v196, v196, v202
    v_cvt_pk_bf16_f32 v164, v201, v202
    v_fma_f32 v198, v74, s36, v192
    v_exp_f32 v201, v198
    s_nop 0
    v_add_f32 v196, v196, v201
    v_fma_f32 v198, v75, s36, v192
    v_exp_f32 v202, v198
    s_nop 0
    v_add_f32 v196, v196, v202
    v_cvt_pk_bf16_f32 v165, v201, v202
    v_fma_f32 v198, v76, s36, v192
    v_exp_f32 v201, v198
    s_nop 0
    v_add_f32 v196, v196, v201
    v_fma_f32 v198, v77, s36, v192
    v_exp_f32 v202, v198
    s_nop 0
    v_add_f32 v196, v196, v202
    v_cvt_pk_bf16_f32 v166, v201, v202
    v_fma_f32 v198, v78, s36, v192
    v_exp_f32 v201, v198
    s_nop 0
    v_add_f32 v196, v196, v201
    v_fma_f32 v198, v79, s36, v192
    v_exp_f32 v202, v198
    s_nop 0
    v_add_f32 v196, v196, v202
    v_cvt_pk_bf16_f32 v167, v201, v202
    v_fma_f32 v198, v96, s36, v192
    v_exp_f32 v201, v198
    s_nop 0
    v_add_f32 v196, v196, v201
    v_fma_f32 v198, v97, s36, v192
    v_exp_f32 v202, v198
    s_nop 0
    v_add_f32 v196, v196, v202
    v_cvt_pk_bf16_f32 v168, v201, v202
    v_fma_f32 v198, v98, s36, v192
    v_exp_f32 v201, v198
    s_nop 0
    v_add_f32 v196, v196, v201
    v_fma_f32 v198, v99, s36, v192
    v_exp_f32 v202, v198
    s_nop 0
    v_add_f32 v196, v196, v202
    v_cvt_pk_bf16_f32 v169, v201, v202
    v_fma_f32 v198, v100, s36, v192
    v_exp_f32 v201, v198
    s_nop 0
    v_add_f32 v196, v196, v201
    v_fma_f32 v198, v101, s36, v192
    v_exp_f32 v202, v198
    s_nop 0
    v_add_f32 v196, v196, v202
    v_cvt_pk_bf16_f32 v170, v201, v202
    v_fma_f32 v198, v102, s36, v192
    v_exp_f32 v201, v198
    s_nop 0
    v_add_f32 v196, v196, v201
    v_fma_f32 v198, v103, s36, v192
    v_exp_f32 v202, v198
    s_nop 0
    v_add_f32 v196, v196, v202
    v_cvt_pk_bf16_f32 v171, v201, v202
    v_fma_f32 v198, v104, s36, v192
    v_exp_f32 v201, v198
    s_nop 0
    v_add_f32 v196, v196, v201
    v_fma_f32 v198, v105, s36, v192
    v_exp_f32 v202, v198
    s_nop 0
    v_add_f32 v196, v196, v202
    v_cvt_pk_bf16_f32 v172, v201, v202
    v_fma_f32 v198, v106, s36, v192
    v_exp_f32 v201, v198
    s_nop 0
    v_add_f32 v196, v196, v201
    v_fma_f32 v198, v107, s36, v192
    v_exp_f32 v202, v198
    s_nop 0
    v_add_f32 v196, v196, v202
    v_cvt_pk_bf16_f32 v173, v201, v202
    v_fma_f32 v198, v108, s36, v192
    v_exp_f32 v201, v198
    s_nop 0
    v_add_f32 v196, v196, v201
    v_fma_f32 v198, v109, s36, v192
    v_exp_f32 v202, v198
    s_nop 0
    v_add_f32 v196, v196, v202
    v_cvt_pk_bf16_f32 v174, v201, v202
    v_fma_f32 v198, v110, s36, v192
    v_exp_f32 v201, v198
    s_nop 0
    v_add_f32 v196, v196, v201
    v_fma_f32 v198, v111, s36, v192
    v_exp_f32 v202, v198
    s_nop 0
    v_add_f32 v196, v196, v202
    v_cvt_pk_bf16_f32 v175, v201, v202
    v_add_f32 v194, v194, v196
    v_mov_b32 v196, 0
    v_max3_f32 v252, v80, v81, v82
    v_max3_f32 v252, v252, v83, v84
    v_max3_f32 v252, v252, v85, v86
    v_max3_f32 v252, v252, v87, v88
    v_max3_f32 v252, v252, v89, v90
    v_max3_f32 v252, v252, v91, v92
    v_max3_f32 v252, v252, v93, v94
    v_max3_f32 v252, v252, v95, v112
    v_max3_f32 v252, v252, v113, v114
    v_max3_f32 v252, v252, v115, v116
    v_max3_f32 v252, v252, v117, v118
    v_max3_f32 v252, v252, v119, v120
    v_max3_f32 v252, v252, v121, v122
    v_max3_f32 v252, v252, v123, v124
    v_max3_f32 v252, v252, v125, v126
    v_max_f32 v252, v252, v127
    v_mov_b32 v253, v252
    s_nop 1
    v_permlane32_swap_b32 v252, v253
    v_max_f32 v252, v252, v253
    v_mul_f32 v252, s36, v252
    v_max_f32 v253, v252, -v193
    v_add_f32 v254, v193, v253
    v_exp_f32 v254, -v254
    v_sub_f32 v193, 0, v253
    v_mul_f32 v195, v195, v254
    v_accvgpr_read_b32 v253, a64
    v_mul_f32 v253, v253, v254
    v_accvgpr_write_b32 a64, v253
    v_accvgpr_read_b32 v255, a65
    v_mul_f32 v255, v255, v254
    v_accvgpr_write_b32 a65, v255
    v_accvgpr_read_b32 v253, a66
    v_mul_f32 v253, v253, v254
    v_accvgpr_write_b32 a66, v253
    v_accvgpr_read_b32 v255, a67
    v_mul_f32 v255, v255, v254
    v_accvgpr_write_b32 a67, v255
    v_accvgpr_read_b32 v253, a68
    v_mul_f32 v253, v253, v254
    v_accvgpr_write_b32 a68, v253
    v_accvgpr_read_b32 v255, a69
    v_mul_f32 v255, v255, v254
    v_accvgpr_write_b32 a69, v255
    v_accvgpr_read_b32 v253, a70
    v_mul_f32 v253, v253, v254
    v_accvgpr_write_b32 a70, v253
    v_accvgpr_read_b32 v255, a71
    v_mul_f32 v255, v255, v254
    v_accvgpr_write_b32 a71, v255
    v_accvgpr_read_b32 v253, a72
    v_mul_f32 v253, v253, v254
    v_accvgpr_write_b32 a72, v253
    v_accvgpr_read_b32 v255, a73
    v_mul_f32 v255, v255, v254
    v_accvgpr_write_b32 a73, v255
    v_accvgpr_read_b32 v253, a74
    v_mul_f32 v253, v253, v254
    v_accvgpr_write_b32 a74, v253
    v_accvgpr_read_b32 v255, a75
    v_mul_f32 v255, v255, v254
    v_accvgpr_write_b32 a75, v255
    v_accvgpr_read_b32 v253, a76
    v_mul_f32 v253, v253, v254
    v_accvgpr_write_b32 a76, v253
    v_accvgpr_read_b32 v255, a77
    v_mul_f32 v255, v255, v254
    v_accvgpr_write_b32 a77, v255
    v_accvgpr_read_b32 v253, a78
    v_mul_f32 v253, v253, v254
    v_accvgpr_write_b32 a78, v253
    v_accvgpr_read_b32 v255, a79
    v_mul_f32 v255, v255, v254
    v_accvgpr_write_b32 a79, v255
    v_accvgpr_read_b32 v253, a80
    v_mul_f32 v253, v253, v254
    v_accvgpr_write_b32 a80, v253
    v_accvgpr_read_b32 v255, a81
    v_mul_f32 v255, v255, v254
    v_accvgpr_write_b32 a81, v255
    v_accvgpr_read_b32 v253, a82
    v_mul_f32 v253, v253, v254
    v_accvgpr_write_b32 a82, v253
    v_accvgpr_read_b32 v255, a83
    v_mul_f32 v255, v255, v254
    v_accvgpr_write_b32 a83, v255
    v_accvgpr_read_b32 v253, a84
    v_mul_f32 v253, v253, v254
    v_accvgpr_write_b32 a84, v253
    v_accvgpr_read_b32 v255, a85
    v_mul_f32 v255, v255, v254
    v_accvgpr_write_b32 a85, v255
    v_accvgpr_read_b32 v253, a86
    v_mul_f32 v253, v253, v254
    v_accvgpr_write_b32 a86, v253
    v_accvgpr_read_b32 v255, a87
    v_mul_f32 v255, v255, v254
    v_accvgpr_write_b32 a87, v255
    v_accvgpr_read_b32 v253, a88
    v_mul_f32 v253, v253, v254
    v_accvgpr_write_b32 a88, v253
    v_accvgpr_read_b32 v255, a89
    v_mul_f32 v255, v255, v254
    v_accvgpr_write_b32 a89, v255
    v_accvgpr_read_b32 v253, a90
    v_mul_f32 v253, v253, v254
    v_accvgpr_write_b32 a90, v253
    v_accvgpr_read_b32 v255, a91
    v_mul_f32 v255, v255, v254
    v_accvgpr_write_b32 a91, v255
    v_accvgpr_read_b32 v253, a92
    v_mul_f32 v253, v253, v254
    v_accvgpr_write_b32 a92, v253
    v_accvgpr_read_b32 v255, a93
    v_mul_f32 v255, v255, v254
    v_accvgpr_write_b32 a93, v255
    v_accvgpr_read_b32 v253, a94
    v_mul_f32 v253, v253, v254
    v_accvgpr_write_b32 a94, v253
    v_accvgpr_read_b32 v255, a95
    v_mul_f32 v255, v255, v254
    v_accvgpr_write_b32 a95, v255
    v_accvgpr_read_b32 v253, a96
    v_mul_f32 v253, v253, v254
    v_accvgpr_write_b32 a96, v253
    v_accvgpr_read_b32 v255, a97
    v_mul_f32 v255, v255, v254
    v_accvgpr_write_b32 a97, v255
    v_accvgpr_read_b32 v253, a98
    v_mul_f32 v253, v253, v254
    v_accvgpr_write_b32 a98, v253
    v_accvgpr_read_b32 v255, a99
    v_mul_f32 v255, v255, v254
    v_accvgpr_write_b32 a99, v255
    v_accvgpr_read_b32 v253, a100
    v_mul_f32 v253, v253, v254
    v_accvgpr_write_b32 a100, v253
    v_accvgpr_read_b32 v255, a101
    v_mul_f32 v255, v255, v254
    v_accvgpr_write_b32 a101, v255
    v_accvgpr_read_b32 v253, a102
    v_mul_f32 v253, v253, v254
    v_accvgpr_write_b32 a102, v253
    v_accvgpr_read_b32 v255, a103
    v_mul_f32 v255, v255, v254
    v_accvgpr_write_b32 a103, v255
    v_accvgpr_read_b32 v253, a104
    v_mul_f32 v253, v253, v254
    v_accvgpr_write_b32 a104, v253
    v_accvgpr_read_b32 v255, a105
    v_mul_f32 v255, v255, v254
    v_accvgpr_write_b32 a105, v255
    v_accvgpr_read_b32 v253, a106
    v_mul_f32 v253, v253, v254
    v_accvgpr_write_b32 a106, v253
    v_accvgpr_read_b32 v255, a107
    v_mul_f32 v255, v255, v254
    v_accvgpr_write_b32 a107, v255
    v_accvgpr_read_b32 v253, a108
    v_mul_f32 v253, v253, v254
    v_accvgpr_write_b32 a108, v253
    v_accvgpr_read_b32 v255, a109
    v_mul_f32 v255, v255, v254
    v_accvgpr_write_b32 a109, v255
    v_accvgpr_read_b32 v253, a110
    v_mul_f32 v253, v253, v254
    v_accvgpr_write_b32 a110, v253
    v_accvgpr_read_b32 v255, a111
    v_mul_f32 v255, v255, v254
    v_accvgpr_write_b32 a111, v255
    v_accvgpr_read_b32 v253, a112
    v_mul_f32 v253, v253, v254
    v_accvgpr_write_b32 a112, v253
    v_accvgpr_read_b32 v255, a113
    v_mul_f32 v255, v255, v254
    v_accvgpr_write_b32 a113, v255
    v_accvgpr_read_b32 v253, a114
    v_mul_f32 v253, v253, v254
    v_accvgpr_write_b32 a114, v253
    v_accvgpr_read_b32 v255, a115
    v_mul_f32 v255, v255, v254
    v_accvgpr_write_b32 a115, v255
    v_accvgpr_read_b32 v253, a116
    v_mul_f32 v253, v253, v254
    v_accvgpr_write_b32 a116, v253
    v_accvgpr_read_b32 v255, a117
    v_mul_f32 v255, v255, v254
    v_accvgpr_write_b32 a117, v255
    v_accvgpr_read_b32 v253, a118
    v_mul_f32 v253, v253, v254
    v_accvgpr_write_b32 a118, v253
    v_accvgpr_read_b32 v255, a119
    v_mul_f32 v255, v255, v254
    v_accvgpr_write_b32 a119, v255
    v_accvgpr_read_b32 v253, a120
    v_mul_f32 v253, v253, v254
    v_accvgpr_write_b32 a120, v253
    v_accvgpr_read_b32 v255, a121
    v_mul_f32 v255, v255, v254
    v_accvgpr_write_b32 a121, v255
    v_accvgpr_read_b32 v253, a122
    v_mul_f32 v253, v253, v254
    v_accvgpr_write_b32 a122, v253
    v_accvgpr_read_b32 v255, a123
    v_mul_f32 v255, v255, v254
    v_accvgpr_write_b32 a123, v255
    v_accvgpr_read_b32 v253, a124
    v_mul_f32 v253, v253, v254
    v_accvgpr_write_b32 a124, v253
    v_accvgpr_read_b32 v255, a125
    v_mul_f32 v255, v255, v254
    v_accvgpr_write_b32 a125, v255
    v_accvgpr_read_b32 v253, a126
    v_mul_f32 v253, v253, v254
    v_accvgpr_write_b32 a126, v253
    v_accvgpr_read_b32 v255, a127
    v_mul_f32 v255, v255, v254
    v_accvgpr_write_b32 a127, v255
    v_mov_b32 v197, 0
    v_fma_f32 v198, v80, s36, v193
    v_exp_f32 v201, v198
    s_nop 0
    v_add_f32 v197, v197, v201
    v_fma_f32 v198, v81, s36, v193
    v_exp_f32 v202, v198
    s_nop 0
    v_add_f32 v197, v197, v202
    v_cvt_pk_bf16_f32 v176, v201, v202
    v_fma_f32 v198, v82, s36, v193
    v_exp_f32 v201, v198
    s_nop 0
    v_add_f32 v197, v197, v201
    v_fma_f32 v198, v83, s36, v193
    v_exp_f32 v202, v198
    s_nop 0
    v_add_f32 v197, v197, v202
    v_cvt_pk_bf16_f32 v177, v201, v202
    v_fma_f32 v198, v84, s36, v193
    v_exp_f32 v201, v198
    s_nop 0
    v_add_f32 v197, v197, v201
    v_fma_f32 v198, v85, s36, v193
    v_exp_f32 v202, v198
    s_nop 0
    v_add_f32 v197, v197, v202
    v_cvt_pk_bf16_f32 v178, v201, v202
    v_fma_f32 v198, v86, s36, v193
    v_exp_f32 v201, v198
    s_nop 0
    v_add_f32 v197, v197, v201
    v_fma_f32 v198, v87, s36, v193
    v_exp_f32 v202, v198
    s_nop 0
    v_add_f32 v197, v197, v202
    v_cvt_pk_bf16_f32 v179, v201, v202
    v_fma_f32 v198, v88, s36, v193
    v_exp_f32 v201, v198
    s_nop 0
    v_add_f32 v197, v197, v201
    v_fma_f32 v198, v89, s36, v193
    v_exp_f32 v202, v198
    s_nop 0
    v_add_f32 v197, v197, v202
    v_cvt_pk_bf16_f32 v180, v201, v202
    v_fma_f32 v198, v90, s36, v193
    v_exp_f32 v201, v198
    s_nop 0
    v_add_f32 v197, v197, v201
    v_fma_f32 v198, v91, s36, v193
    v_exp_f32 v202, v198
    s_nop 0
    v_add_f32 v197, v197, v202
    v_cvt_pk_bf16_f32 v181, v201, v202
    v_fma_f32 v198, v92, s36, v193
    v_exp_f32 v201, v198
    s_nop 0
    v_add_f32 v197, v197, v201
    v_fma_f32 v198, v93, s36, v193
    v_exp_f32 v202, v198
    s_nop 0
    v_add_f32 v197, v197, v202
    v_cvt_pk_bf16_f32 v182, v201, v202
    v_fma_f32 v198, v94, s36, v193
    v_exp_f32 v201, v198
    s_nop 0
    v_add_f32 v197, v197, v201
    v_fma_f32 v198, v95, s36, v193
    v_exp_f32 v202, v198
    s_nop 0
    v_add_f32 v197, v197, v202
    v_cvt_pk_bf16_f32 v183, v201, v202
    v_fma_f32 v198, v112, s36, v193
    v_exp_f32 v201, v198
    s_nop 0
    v_add_f32 v197, v197, v201
    v_fma_f32 v198, v113, s36, v193
    v_exp_f32 v202, v198
    s_nop 0
    v_add_f32 v197, v197, v202
    v_cvt_pk_bf16_f32 v184, v201, v202
    v_fma_f32 v198, v114, s36, v193
    v_exp_f32 v201, v198
    s_nop 0
    v_add_f32 v197, v197, v201
    v_fma_f32 v198, v115, s36, v193
    v_exp_f32 v202, v198
    s_nop 0
    v_add_f32 v197, v197, v202
    v_cvt_pk_bf16_f32 v185, v201, v202
    v_fma_f32 v198, v116, s36, v193
    v_exp_f32 v201, v198
    s_nop 0
    v_add_f32 v197, v197, v201
    v_fma_f32 v198, v117, s36, v193
    v_exp_f32 v202, v198
    s_nop 0
    v_add_f32 v197, v197, v202
    v_cvt_pk_bf16_f32 v186, v201, v202
    v_fma_f32 v198, v118, s36, v193
    v_exp_f32 v201, v198
    s_nop 0
    v_add_f32 v197, v197, v201
    v_fma_f32 v198, v119, s36, v193
    v_exp_f32 v202, v198
    s_nop 0
    v_add_f32 v197, v197, v202
    v_cvt_pk_bf16_f32 v187, v201, v202
    v_fma_f32 v198, v120, s36, v193
    v_exp_f32 v201, v198
    s_nop 0
    v_add_f32 v197, v197, v201
    v_fma_f32 v198, v121, s36, v193
    v_exp_f32 v202, v198
    s_nop 0
    v_add_f32 v197, v197, v202
    v_cvt_pk_bf16_f32 v188, v201, v202
    v_fma_f32 v198, v122, s36, v193
    v_exp_f32 v201, v198
    s_nop 0
    v_add_f32 v197, v197, v201
    v_fma_f32 v198, v123, s36, v193
    v_exp_f32 v202, v198
    s_nop 0
    v_add_f32 v197, v197, v202
    v_cvt_pk_bf16_f32 v189, v201, v202
    v_fma_f32 v198, v124, s36, v193
    v_exp_f32 v201, v198
    s_nop 0
    v_add_f32 v197, v197, v201
    v_fma_f32 v198, v125, s36, v193
    v_exp_f32 v202, v198
    s_nop 0
    v_add_f32 v197, v197, v202
    v_cvt_pk_bf16_f32 v190, v201, v202
    v_fma_f32 v198, v126, s36, v193
    v_exp_f32 v201, v198
    s_nop 0
    v_add_f32 v197, v197, v201
    v_fma_f32 v198, v127, s36, v193
    v_exp_f32 v202, v198
    s_nop 0
    v_add_f32 v197, v197, v202
    v_cvt_pk_bf16_f32 v191, v201, v202
    v_add_f32 v195, v195, v197
    v_mov_b32 v197, 0
    s_nop 3
    s_branch BACK_A1
RARE_X28:
    s_nop 7
    v_max3_f32 v252, v0, v1, v2
    v_max3_f32 v252, v252, v3, v4
    v_max3_f32 v252, v252, v5, v6
    v_max3_f32 v252, v252, v7, v8
    v_max3_f32 v252, v252, v9, v10
    v_max3_f32 v252, v252, v11, v12
    v_max3_f32 v252, v252, v13, v14
    v_max3_f32 v252, v252, v15, v32
    v_max3_f32 v252, v252, v33, v34
    v_max3_f32 v252, v252, v35, v36
    v_max3_f32 v252, v252, v37, v38
    v_max3_f32 v252, v252, v39, v40
    v_max3_f32 v252, v252, v41, v42
    v_max3_f32 v252, v252, v43, v44
    v_max3_f32 v252, v252, v45, v46
    v_max_f32 v252, v252, v47
    v_mov_b32 v253, v252
    s_nop 1
    v_permlane32_swap_b32 v252, v253
    v_max_f32 v252, v252, v253
    v_mul_f32 v252, s36, v252
    v_max_f32 v253, v252, -v192
    v_add_f32 v254, v192, v253
    v_exp_f32 v254, -v254
    v_sub_f32 v192, 0, v253
    v_mul_f32 v194, v194, v254
    v_accvgpr_read_b32 v253, a0
    v_mul_f32 v253, v253, v254
    v_accvgpr_write_b32 a0, v253
    v_accvgpr_read_b32 v255, a1
    v_mul_f32 v255, v255, v254
    v_accvgpr_write_b32 a1, v255
    v_accvgpr_read_b32 v253, a2
    v_mul_f32 v253, v253, v254
    v_accvgpr_write_b32 a2, v253
    v_accvgpr_read_b32 v255, a3
    v_mul_f32 v255, v255, v254
    v_accvgpr_write_b32 a3, v255
    v_accvgpr_read_b32 v253, a4
    v_mul_f32 v253, v253, v254
    v_accvgpr_write_b32 a4, v253
    v_accvgpr_read_b32 v255, a5
    v_mul_f32 v255, v255, v254
    v_accvgpr_write_b32 a5, v255
    v_accvgpr_read_b32 v253, a6
    v_mul_f32 v253, v253, v254
    v_accvgpr_write_b32 a6, v253
    v_accvgpr_read_b32 v255, a7
    v_mul_f32 v255, v255, v254
    v_accvgpr_write_b32 a7, v255
    v_accvgpr_read_b32 v253, a8
    v_mul_f32 v253, v253, v254
    v_accvgpr_write_b32 a8, v253
    v_accvgpr_read_b32 v255, a9
    v_mul_f32 v255, v255, v254
    v_accvgpr_write_b32 a9, v255
    v_accvgpr_read_b32 v253, a10
    v_mul_f32 v253, v253, v254
    v_accvgpr_write_b32 a10, v253
    v_accvgpr_read_b32 v255, a11
    v_mul_f32 v255, v255, v254
    v_accvgpr_write_b32 a11, v255
    v_accvgpr_read_b32 v253, a12
    v_mul_f32 v253, v253, v254
    v_accvgpr_write_b32 a12, v253
    v_accvgpr_read_b32 v255, a13
    v_mul_f32 v255, v255, v254
    v_accvgpr_write_b32 a13, v255
    v_accvgpr_read_b32 v253, a14
    v_mul_f32 v253, v253, v254
    v_accvgpr_write_b32 a14, v253
    v_accvgpr_read_b32 v255, a15
    v_mul_f32 v255, v255, v254
    v_accvgpr_write_b32 a15, v255
    v_accvgpr_read_b32 v253, a16
    v_mul_f32 v253, v253, v254
    v_accvgpr_write_b32 a16, v253
    v_accvgpr_read_b32 v255, a17
    v_mul_f32 v255, v255, v254
    v_accvgpr_write_b32 a17, v255
    v_accvgpr_read_b32 v253, a18
    v_mul_f32 v253, v253, v254
    v_accvgpr_write_b32 a18, v253
    v_accvgpr_read_b32 v255, a19
    v_mul_f32 v255, v255, v254
    v_accvgpr_write_b32 a19, v255
    v_accvgpr_read_b32 v253, a20
    v_mul_f32 v253, v253, v254
    v_accvgpr_write_b32 a20, v253
    v_accvgpr_read_b32 v255, a21
    v_mul_f32 v255, v255, v254
    v_accvgpr_write_b32 a21, v255
    v_accvgpr_read_b32 v253, a22
    v_mul_f32 v253, v253, v254
    v_accvgpr_write_b32 a22, v253
    v_accvgpr_read_b32 v255, a23
    v_mul_f32 v255, v255, v254
    v_accvgpr_write_b32 a23, v255
    v_accvgpr_read_b32 v253, a24
    v_mul_f32 v253, v253, v254
    v_accvgpr_write_b32 a24, v253
    v_accvgpr_read_b32 v255, a25
    v_mul_f32 v255, v255, v254
    v_accvgpr_write_b32 a25, v255
    v_accvgpr_read_b32 v253, a26
    v_mul_f32 v253, v253, v254
    v_accvgpr_write_b32 a26, v253
    v_accvgpr_read_b32 v255, a27
    v_mul_f32 v255, v255, v254
    v_accvgpr_write_b32 a27, v255
    v_accvgpr_read_b32 v253, a28
    v_mul_f32 v253, v253, v254
    v_accvgpr_write_b32 a28, v253
    v_accvgpr_read_b32 v255, a29
    v_mul_f32 v255, v255, v254
    v_accvgpr_write_b32 a29, v255
    v_accvgpr_read_b32 v253, a30
    v_mul_f32 v253, v253, v254
    v_accvgpr_write_b32 a30, v253
    v_accvgpr_read_b32 v255, a31
    v_mul_f32 v255, v255, v254
    v_accvgpr_write_b32 a31, v255
    v_accvgpr_read_b32 v253, a32
    v_mul_f32 v253, v253, v254
    v_accvgpr_write_b32 a32, v253
    v_accvgpr_read_b32 v255, a33
    v_mul_f32 v255, v255, v254
    v_accvgpr_write_b32 a33, v255
    v_accvgpr_read_b32 v253, a34
    v_mul_f32 v253, v253, v254
    v_accvgpr_write_b32 a34, v253
    v_accvgpr_read_b32 v255, a35
    v_mul_f32 v255, v255, v254
    v_accvgpr_write_b32 a35, v255
    v_accvgpr_read_b32 v253, a36
    v_mul_f32 v253, v253, v254
    v_accvgpr_write_b32 a36, v253
    v_accvgpr_read_b32 v255, a37
    v_mul_f32 v255, v255, v254
    v_accvgpr_write_b32 a37, v255
    v_accvgpr_read_b32 v253, a38
    v_mul_f32 v253, v253, v254
    v_accvgpr_write_b32 a38, v253
    v_accvgpr_read_b32 v255, a39
    v_mul_f32 v255, v255, v254
    v_accvgpr_write_b32 a39, v255
    v_accvgpr_read_b32 v253, a40
    v_mul_f32 v253, v253, v254
    v_accvgpr_write_b32 a40, v253
    v_accvgpr_read_b32 v255, a41
    v_mul_f32 v255, v255, v254
    v_accvgpr_write_b32 a41, v255
    v_accvgpr_read_b32 v253, a42
    v_mul_f32 v253, v253, v254
    v_accvgpr_write_b32 a42, v253
    v_accvgpr_read_b32 v255, a43
    v_mul_f32 v255, v255, v254
    v_accvgpr_write_b32 a43, v255
    v_accvgpr_read_b32 v253, a44
    v_mul_f32 v253, v253, v254
    v_accvgpr_write_b32 a44, v253
    v_accvgpr_read_b32 v255, a45
    v_mul_f32 v255, v255, v254
    v_accvgpr_write_b32 a45, v255
    v_accvgpr_read_b32 v253, a46
    v_mul_f32 v253, v253, v254
    v_accvgpr_write_b32 a46, v253
    v_accvgpr_read_b32 v255, a47
    v_mul_f32 v255, v255, v254
    v_accvgpr_write_b32 a47, v255
    v_accvgpr_read_b32 v253, a48
    v_mul_f32 v253, v253, v254
    v_accvgpr_write_b32 a48, v253
    v_accvgpr_read_b32 v255, a49
    v_mul_f32 v255, v255, v254
    v_accvgpr_write_b32 a49, v255
    v_accvgpr_read_b32 v253, a50
    v_mul_f32 v253, v253, v254
    v_accvgpr_write_b32 a50, v253
    v_accvgpr_read_b32 v255, a51
    v_mul_f32 v255, v255, v254
    v_accvgpr_write_b32 a51, v255
    v_accvgpr_read_b32 v253, a52
    v_mul_f32 v253, v253, v254
    v_accvgpr_write_b32 a52, v253
    v_accvgpr_read_b32 v255, a53
    v_mul_f32 v255, v255, v254
    v_accvgpr_write_b32 a53, v255
    v_accvgpr_read_b32 v253, a54
    v_mul_f32 v253, v253, v254
    v_accvgpr_write_b32 a54, v253
    v_accvgpr_read_b32 v255, a55
    v_mul_f32 v255, v255, v254
    v_accvgpr_write_b32 a55, v255
    v_accvgpr_read_b32 v253, a56
    v_mul_f32 v253, v253, v254
    v_accvgpr_write_b32 a56, v253
    v_accvgpr_read_b32 v255, a57
    v_mul_f32 v255, v255, v254
    v_accvgpr_write_b32 a57, v255
    v_accvgpr_read_b32 v253, a58
    v_mul_f32 v253, v253, v254
    v_accvgpr_write_b32 a58, v253
    v_accvgpr_read_b32 v255, a59
    v_mul_f32 v255, v255, v254
    v_accvgpr_write_b32 a59, v255
    v_accvgpr_read_b32 v253, a60
    v_mul_f32 v253, v253, v254
    v_accvgpr_write_b32 a60, v253
    v_accvgpr_read_b32 v255, a61
    v_mul_f32 v255, v255, v254
    v_accvgpr_write_b32 a61, v255
    v_accvgpr_read_b32 v253, a62
    v_mul_f32 v253, v253, v254
    v_accvgpr_write_b32 a62, v253
    v_accvgpr_read_b32 v255, a63
    v_mul_f32 v255, v255, v254
    v_accvgpr_write_b32 a63, v255
    v_mov_b32 v196, 0
    v_fma_f32 v198, v0, s36, v192
    v_exp_f32 v201, v198
    s_nop 0
    v_add_f32 v196, v196, v201
    v_fma_f32 v198, v1, s36, v192
    v_exp_f32 v202, v198
    s_nop 0
    v_add_f32 v196, v196, v202
    v_cvt_pk_bf16_f32 v128, v201, v202
    v_fma_f32 v198, v2, s36, v192
    v_exp_f32 v201, v198
    s_nop 0
    v_add_f32 v196, v196, v201
    v_fma_f32 v198, v3, s36, v192
    v_exp_f32 v202, v198
    s_nop 0
    v_add_f32 v196, v196, v202
    v_cvt_pk_bf16_f32 v129, v201, v202
    v_fma_f32 v198, v4, s36, v192
    v_exp_f32 v201, v198
    s_nop 0
    v_add_f32 v196, v196, v201
    v_fma_f32 v198, v5, s36, v192
    v_exp_f32 v202, v198
    s_nop 0
    v_add_f32 v196, v196, v202
    v_cvt_pk_bf16_f32 v130, v201, v202
    v_fma_f32 v198, v6, s36, v192
    v_exp_f32 v201, v198
    s_nop 0
    v_add_f32 v196, v196, v201
    v_fma_f32 v198, v7, s36, v192
    v_exp_f32 v202, v198
    s_nop 0
    v_add_f32 v196, v196, v202
    v_cvt_pk_bf16_f32 v131, v201, v202
    v_fma_f32 v198, v8, s36, v192
    v_exp_f32 v201, v198
    s_nop 0
    v_add_f32 v196, v196, v201
    v_fma_f32 v198, v9, s36, v192
    v_exp_f32 v202, v198
    s_nop 0
    v_add_f32 v196, v196, v202
    v_cvt_pk_bf16_f32 v132, v201, v202
    v_fma_f32 v198, v10, s36, v192
    v_exp_f32 v201, v198
    s_nop 0
    v_add_f32 v196, v196, v201
    v_fma_f32 v198, v11, s36, v192
    v_exp_f32 v202, v198
    s_nop 0
    v_add_f32 v196, v196, v202
    v_cvt_pk_bf16_f32 v133, v201, v202
    v_fma_f32 v198, v12, s36, v192
    v_exp_f32 v201, v198
    s_nop 0
    v_add_f32 v196, v196, v201
    v_fma_f32 v198, v13, s36, v192
    v_exp_f32 v202, v198
    s_nop 0
    v_add_f32 v196, v196, v202
    v_cvt_pk_bf16_f32 v134, v201, v202
    v_fma_f32 v198, v14, s36, v192
    v_exp_f32 v201, v198
    s_nop 0
    v_add_f32 v196, v196, v201
    v_fma_f32 v198, v15, s36, v192
    v_exp_f32 v202, v198
    s_nop 0
    v_add_f32 v196, v196, v202
    v_cvt_pk_bf16_f32 v135, v201, v202
    v_fma_f32 v198, v32, s36, v192
    v_exp_f32 v201, v198
    s_nop 0
    v_add_f32 v196, v196, v201
    v_fma_f32 v198, v33, s36, v192
    v_exp_f32 v202, v198
    s_nop 0
    v_add_f32 v196, v196, v202
    v_cvt_pk_bf16_f32 v136, v201, v202
    v_fma_f32 v198, v34, s36, v192
    v_exp_f32 v201, v198
    s_nop 0
    v_add_f32 v196, v196, v201
    v_fma_f32 v198, v35, s36, v192
    v_exp_f32 v202, v198
    s_nop 0
    v_add_f32 v196, v196, v202
    v_cvt_pk_bf16_f32 v137, v201, v202
    v_fma_f32 v198, v36, s36, v192
    v_exp_f32 v201, v198
    s_nop 0
    v_add_f32 v196, v196, v201
    v_fma_f32 v198, v37, s36, v192
    v_exp_f32 v202, v198
    s_nop 0
    v_add_f32 v196, v196, v202
    v_cvt_pk_bf16_f32 v138, v201, v202
    v_fma_f32 v198, v38, s36, v192
    v_exp_f32 v201, v198
    s_nop 0
    v_add_f32 v196, v196, v201
    v_fma_f32 v198, v39, s36, v192
    v_exp_f32 v202, v198
    s_nop 0
    v_add_f32 v196, v196, v202
    v_cvt_pk_bf16_f32 v139, v201, v202
    v_fma_f32 v198, v40, s36, v192
    v_exp_f32 v201, v198
    s_nop 0
    v_add_f32 v196, v196, v201
    v_fma_f32 v198, v41, s36, v192
    v_exp_f32 v202, v198
    s_nop 0
    v_add_f32 v196, v196, v202
    v_cvt_pk_bf16_f32 v140, v201, v202
    v_fma_f32 v198, v42, s36, v192
    v_exp_f32 v201, v198
    s_nop 0
    v_add_f32 v196, v196, v201
    v_fma_f32 v198, v43, s36, v192
    v_exp_f32 v202, v198
    s_nop 0
    v_add_f32 v196, v196, v202
    v_cvt_pk_bf16_f32 v141, v201, v202
    v_fma_f32 v198, v44, s36, v192
    v_exp_f32 v201, v198
    s_nop 0
    v_add_f32 v196, v196, v201
    v_fma_f32 v198, v45, s36, v192
    v_exp_f32 v202, v198
    s_nop 0
    v_add_f32 v196, v196, v202
    v_cvt_pk_bf16_f32 v142, v201, v202
    v_fma_f32 v198, v46, s36, v192
    v_exp_f32 v201, v198
    s_nop 0
    v_add_f32 v196, v196, v201
    v_fma_f32 v198, v47, s36, v192
    v_exp_f32 v202, v198
    s_nop 0
    v_add_f32 v196, v196, v202
    v_cvt_pk_bf16_f32 v143, v201, v202
    v_add_f32 v194, v194, v196
    v_mov_b32 v196, 0
    v_max3_f32 v252, v16, v17, v18
    v_max3_f32 v252, v252, v19, v20
    v_max3_f32 v252, v252, v21, v22
    v_max3_f32 v252, v252, v23, v24
    v_max3_f32 v252, v252, v25, v26
    v_max3_f32 v252, v252, v27, v28
    v_max3_f32 v252, v252, v29, v30
    v_max3_f32 v252, v252, v31, v48
    v_max3_f32 v252, v252, v49, v50
    v_max3_f32 v252, v252, v51, v52
    v_max3_f32 v252, v252, v53, v54
    v_max3_f32 v252, v252, v55, v56
    v_max3_f32 v252, v252, v57, v58
    v_max3_f32 v252, v252, v59, v60
    v_max3_f32 v252, v252, v61, v62
    v_max_f32 v252, v252, v63
    v_mov_b32 v253, v252
    s_nop 1
    v_permlane32_swap_b32 v252, v253
    v_max_f32 v252, v252, v253
    v_mul_f32 v252, s36, v252
    v_max_f32 v253, v252, -v193
    v_add_f32 v254, v193, v253
    v_exp_f32 v254, -v254
    v_sub_f32 v193, 0, v253
    v_mul_f32 v195, v195, v254
    v_accvgpr_read_b32 v253, a64
    v_mul_f32 v253, v253, v254
    v_accvgpr_write_b32 a64, v253
    v_accvgpr_read_b32 v255, a65
    v_mul_f32 v255, v255, v254
    v_accvgpr_write_b32 a65, v255
    v_accvgpr_read_b32 v253, a66
    v_mul_f32 v253, v253, v254
    v_accvgpr_write_b32 a66, v253
    v_accvgpr_read_b32 v255, a67
    v_mul_f32 v255, v255, v254
    v_accvgpr_write_b32 a67, v255
    v_accvgpr_read_b32 v253, a68
    v_mul_f32 v253, v253, v254
    v_accvgpr_write_b32 a68, v253
    v_accvgpr_read_b32 v255, a69
    v_mul_f32 v255, v255, v254
    v_accvgpr_write_b32 a69, v255
    v_accvgpr_read_b32 v253, a70
    v_mul_f32 v253, v253, v254
    v_accvgpr_write_b32 a70, v253
    v_accvgpr_read_b32 v255, a71
    v_mul_f32 v255, v255, v254
    v_accvgpr_write_b32 a71, v255
    v_accvgpr_read_b32 v253, a72
    v_mul_f32 v253, v253, v254
    v_accvgpr_write_b32 a72, v253
    v_accvgpr_read_b32 v255, a73
    v_mul_f32 v255, v255, v254
    v_accvgpr_write_b32 a73, v255
    v_accvgpr_read_b32 v253, a74
    v_mul_f32 v253, v253, v254
    v_accvgpr_write_b32 a74, v253
    v_accvgpr_read_b32 v255, a75
    v_mul_f32 v255, v255, v254
    v_accvgpr_write_b32 a75, v255
    v_accvgpr_read_b32 v253, a76
    v_mul_f32 v253, v253, v254
    v_accvgpr_write_b32 a76, v253
    v_accvgpr_read_b32 v255, a77
    v_mul_f32 v255, v255, v254
    v_accvgpr_write_b32 a77, v255
    v_accvgpr_read_b32 v253, a78
    v_mul_f32 v253, v253, v254
    v_accvgpr_write_b32 a78, v253
    v_accvgpr_read_b32 v255, a79
    v_mul_f32 v255, v255, v254
    v_accvgpr_write_b32 a79, v255
    v_accvgpr_read_b32 v253, a80
    v_mul_f32 v253, v253, v254
    v_accvgpr_write_b32 a80, v253
    v_accvgpr_read_b32 v255, a81
    v_mul_f32 v255, v255, v254
    v_accvgpr_write_b32 a81, v255
    v_accvgpr_read_b32 v253, a82
    v_mul_f32 v253, v253, v254
    v_accvgpr_write_b32 a82, v253
    v_accvgpr_read_b32 v255, a83
    v_mul_f32 v255, v255, v254
    v_accvgpr_write_b32 a83, v255
    v_accvgpr_read_b32 v253, a84
    v_mul_f32 v253, v253, v254
    v_accvgpr_write_b32 a84, v253
    v_accvgpr_read_b32 v255, a85
    v_mul_f32 v255, v255, v254
    v_accvgpr_write_b32 a85, v255
    v_accvgpr_read_b32 v253, a86
    v_mul_f32 v253, v253, v254
    v_accvgpr_write_b32 a86, v253
    v_accvgpr_read_b32 v255, a87
    v_mul_f32 v255, v255, v254
    v_accvgpr_write_b32 a87, v255
    v_accvgpr_read_b32 v253, a88
    v_mul_f32 v253, v253, v254
    v_accvgpr_write_b32 a88, v253
    v_accvgpr_read_b32 v255, a89
    v_mul_f32 v255, v255, v254
    v_accvgpr_write_b32 a89, v255
    v_accvgpr_read_b32 v253, a90
    v_mul_f32 v253, v253, v254
    v_accvgpr_write_b32 a90, v253
    v_accvgpr_read_b32 v255, a91
    v_mul_f32 v255, v255, v254
    v_accvgpr_write_b32 a91, v255
    v_accvgpr_read_b32 v253, a92
    v_mul_f32 v253, v253, v254
    v_accvgpr_write_b32 a92, v253
    v_accvgpr_read_b32 v255, a93
    v_mul_f32 v255, v255, v254
    v_accvgpr_write_b32 a93, v255
    v_accvgpr_read_b32 v253, a94
    v_mul_f32 v253, v253, v254
    v_accvgpr_write_b32 a94, v253
    v_accvgpr_read_b32 v255, a95
    v_mul_f32 v255, v255, v254
    v_accvgpr_write_b32 a95, v255
    v_accvgpr_read_b32 v253, a96
    v_mul_f32 v253, v253, v254
    v_accvgpr_write_b32 a96, v253
    v_accvgpr_read_b32 v255, a97
    v_mul_f32 v255, v255, v254
    v_accvgpr_write_b32 a97, v255
    v_accvgpr_read_b32 v253, a98
    v_mul_f32 v253, v253, v254
    v_accvgpr_write_b32 a98, v253
    v_accvgpr_read_b32 v255, a99
    v_mul_f32 v255, v255, v254
    v_accvgpr_write_b32 a99, v255
    v_accvgpr_read_b32 v253, a100
    v_mul_f32 v253, v253, v254
    v_accvgpr_write_b32 a100, v253
    v_accvgpr_read_b32 v255, a101
    v_mul_f32 v255, v255, v254
    v_accvgpr_write_b32 a101, v255
    v_accvgpr_read_b32 v253, a102
    v_mul_f32 v253, v253, v254
    v_accvgpr_write_b32 a102, v253
    v_accvgpr_read_b32 v255, a103
    v_mul_f32 v255, v255, v254
    v_accvgpr_write_b32 a103, v255
    v_accvgpr_read_b32 v253, a104
    v_mul_f32 v253, v253, v254
    v_accvgpr_write_b32 a104, v253
    v_accvgpr_read_b32 v255, a105
    v_mul_f32 v255, v255, v254
    v_accvgpr_write_b32 a105, v255
    v_accvgpr_read_b32 v253, a106
    v_mul_f32 v253, v253, v254
    v_accvgpr_write_b32 a106, v253
    v_accvgpr_read_b32 v255, a107
    v_mul_f32 v255, v255, v254
    v_accvgpr_write_b32 a107, v255
    v_accvgpr_read_b32 v253, a108
    v_mul_f32 v253, v253, v254
    v_accvgpr_write_b32 a108, v253
    v_accvgpr_read_b32 v255, a109
    v_mul_f32 v255, v255, v254
    v_accvgpr_write_b32 a109, v255
    v_accvgpr_read_b32 v253, a110
    v_mul_f32 v253, v253, v254
    v_accvgpr_write_b32 a110, v253
    v_accvgpr_read_b32 v255, a111
    v_mul_f32 v255, v255, v254
    v_accvgpr_write_b32 a111, v255
    v_accvgpr_read_b32 v253, a112
    v_mul_f32 v253, v253, v254
    v_accvgpr_write_b32 a112, v253
    v_accvgpr_read_b32 v255, a113
    v_mul_f32 v255, v255, v254
    v_accvgpr_write_b32 a113, v255
    v_accvgpr_read_b32 v253, a114
    v_mul_f32 v253, v253, v254
    v_accvgpr_write_b32 a114, v253
    v_accvgpr_read_b32 v255, a115
    v_mul_f32 v255, v255, v254
    v_accvgpr_write_b32 a115, v255
    v_accvgpr_read_b32 v253, a116
    v_mul_f32 v253, v253, v254
    v_accvgpr_write_b32 a116, v253
    v_accvgpr_read_b32 v255, a117
    v_mul_f32 v255, v255, v254
    v_accvgpr_write_b32 a117, v255
    v_accvgpr_read_b32 v253, a118
    v_mul_f32 v253, v253, v254
    v_accvgpr_write_b32 a118, v253
    v_accvgpr_read_b32 v255, a119
    v_mul_f32 v255, v255, v254
    v_accvgpr_write_b32 a119, v255
    v_accvgpr_read_b32 v253, a120
    v_mul_f32 v253, v253, v254
    v_accvgpr_write_b32 a120, v253
    v_accvgpr_read_b32 v255, a121
    v_mul_f32 v255, v255, v254
    v_accvgpr_write_b32 a121, v255
    v_accvgpr_read_b32 v253, a122
    v_mul_f32 v253, v253, v254
    v_accvgpr_write_b32 a122, v253
    v_accvgpr_read_b32 v255, a123
    v_mul_f32 v255, v255, v254
    v_accvgpr_write_b32 a123, v255
    v_accvgpr_read_b32 v253, a124
    v_mul_f32 v253, v253, v254
    v_accvgpr_write_b32 a124, v253
    v_accvgpr_read_b32 v255, a125
    v_mul_f32 v255, v255, v254
    v_accvgpr_write_b32 a125, v255
    v_accvgpr_read_b32 v253, a126
    v_mul_f32 v253, v253, v254
    v_accvgpr_write_b32 a126, v253
    v_accvgpr_read_b32 v255, a127
    v_mul_f32 v255, v255, v254
    v_accvgpr_write_b32 a127, v255
    v_mov_b32 v197, 0
    v_fma_f32 v198, v16, s36, v193
    v_exp_f32 v201, v198
    s_nop 0
    v_add_f32 v197, v197, v201
    v_fma_f32 v198, v17, s36, v193
    v_exp_f32 v202, v198
    s_nop 0
    v_add_f32 v197, v197, v202
    v_cvt_pk_bf16_f32 v144, v201, v202
    v_fma_f32 v198, v18, s36, v193
    v_exp_f32 v201, v198
    s_nop 0
    v_add_f32 v197, v197, v201
    v_fma_f32 v198, v19, s36, v193
    v_exp_f32 v202, v198
    s_nop 0
    v_add_f32 v197, v197, v202
    v_cvt_pk_bf16_f32 v145, v201, v202
    v_fma_f32 v198, v20, s36, v193
    v_exp_f32 v201, v198
    s_nop 0
    v_add_f32 v197, v197, v201
    v_fma_f32 v198, v21, s36, v193
    v_exp_f32 v202, v198
    s_nop 0
    v_add_f32 v197, v197, v202
    v_cvt_pk_bf16_f32 v146, v201, v202
    v_fma_f32 v198, v22, s36, v193
    v_exp_f32 v201, v198
    s_nop 0
    v_add_f32 v197, v197, v201
    v_fma_f32 v198, v23, s36, v193
    v_exp_f32 v202, v198
    s_nop 0
    v_add_f32 v197, v197, v202
    v_cvt_pk_bf16_f32 v147, v201, v202
    v_fma_f32 v198, v24, s36, v193
    v_exp_f32 v201, v198
    s_nop 0
    v_add_f32 v197, v197, v201
    v_fma_f32 v198, v25, s36, v193
    v_exp_f32 v202, v198
    s_nop 0
    v_add_f32 v197, v197, v202
    v_cvt_pk_bf16_f32 v148, v201, v202
    v_fma_f32 v198, v26, s36, v193
    v_exp_f32 v201, v198
    s_nop 0
    v_add_f32 v197, v197, v201
    v_fma_f32 v198, v27, s36, v193
    v_exp_f32 v202, v198
    s_nop 0
    v_add_f32 v197, v197, v202
    v_cvt_pk_bf16_f32 v149, v201, v202
    v_fma_f32 v198, v28, s36, v193
    v_exp_f32 v201, v198
    s_nop 0
    v_add_f32 v197, v197, v201
    v_fma_f32 v198, v29, s36, v193
    v_exp_f32 v202, v198
    s_nop 0
    v_add_f32 v197, v197, v202
    v_cvt_pk_bf16_f32 v150, v201, v202
    v_fma_f32 v198, v30, s36, v193
    v_exp_f32 v201, v198
    s_nop 0
    v_add_f32 v197, v197, v201
    v_fma_f32 v198, v31, s36, v193
    v_exp_f32 v202, v198
    s_nop 0
    v_add_f32 v197, v197, v202
    v_cvt_pk_bf16_f32 v151, v201, v202
    v_fma_f32 v198, v48, s36, v193
    v_exp_f32 v201, v198
    s_nop 0
    v_add_f32 v197, v197, v201
    v_fma_f32 v198, v49, s36, v193
    v_exp_f32 v202, v198
    s_nop 0
    v_add_f32 v197, v197, v202
    v_cvt_pk_bf16_f32 v152, v201, v202
    v_fma_f32 v198, v50, s36, v193
    v_exp_f32 v201, v198
    s_nop 0
    v_add_f32 v197, v197, v201
    v_fma_f32 v198, v51, s36, v193
    v_exp_f32 v202, v198
    s_nop 0
    v_add_f32 v197, v197, v202
    v_cvt_pk_bf16_f32 v153, v201, v202
    v_fma_f32 v198, v52, s36, v193
    v_exp_f32 v201, v198
    s_nop 0
    v_add_f32 v197, v197, v201
    v_fma_f32 v198, v53, s36, v193
    v_exp_f32 v202, v198
    s_nop 0
    v_add_f32 v197, v197, v202
    v_cvt_pk_bf16_f32 v154, v201, v202
    v_fma_f32 v198, v54, s36, v193
    v_exp_f32 v201, v198
    s_nop 0
    v_add_f32 v197, v197, v201
    v_fma_f32 v198, v55, s36, v193
    v_exp_f32 v202, v198
    s_nop 0
    v_add_f32 v197, v197, v202
    v_cvt_pk_bf16_f32 v155, v201, v202
    v_fma_f32 v198, v56, s36, v193
    v_exp_f32 v201, v198
    s_nop 0
    v_add_f32 v197, v197, v201
    v_fma_f32 v198, v57, s36, v193
    v_exp_f32 v202, v198
    s_nop 0
    v_add_f32 v197, v197, v202
    v_cvt_pk_bf16_f32 v156, v201, v202
    v_fma_f32 v198, v58, s36, v193
    v_exp_f32 v201, v198
    s_nop 0
    v_add_f32 v197, v197, v201
    v_fma_f32 v198, v59, s36, v193
    v_exp_f32 v202, v198
    s_nop 0
    v_add_f32 v197, v197, v202
    v_cvt_pk_bf16_f32 v157, v201, v202
    v_fma_f32 v198, v60, s36, v193
    v_exp_f32 v201, v198
    s_nop 0
    v_add_f32 v197, v197, v201
    v_fma_f32 v198, v61, s36, v193
    v_exp_f32 v202, v198
    s_nop 0
    v_add_f32 v197, v197, v202
    v_cvt_pk_bf16_f32 v158, v201, v202
    v_fma_f32 v198, v62, s36, v193
    v_exp_f32 v201, v198
    s_nop 0
    v_add_f32 v197, v197, v201
    v_fma_f32 v198, v63, s36, v193
    v_exp_f32 v202, v198
    s_nop 0
    v_add_f32 v197, v197, v202
    v_cvt_pk_bf16_f32 v159, v201, v202
    v_add_f32 v195, v195, v197
    v_mov_b32 v197, 0
    s_nop 3
    s_branch BACK_X28
RARE_X29:
    s_nop 7
    v_max3_f32 v252, v64, v65, v66
    v_max3_f32 v252, v252, v67, v68
    v_max3_f32 v252, v252, v69, v70
    v_max3_f32 v252, v252, v71, v72
    v_max3_f32 v252, v252, v73, v74
    v_max3_f32 v252, v252, v75, v76
    v_max3_f32 v252, v252, v77, v78
    v_max3_f32 v252, v252, v79, v96
    v_max3_f32 v252, v252, v97, v98
    v_max3_f32 v252, v252, v99, v100
    v_max3_f32 v252, v252, v101, v102
    v_max3_f32 v252, v252, v103, v104
    v_max3_f32 v252, v252, v105, v106
    v_max3_f32 v252, v252, v107, v108
    v_max3_f32 v252, v252, v109, v110
    v_max_f32 v252, v252, v111
    v_mov_b32 v253, v252
    s_nop 1
    v_permlane32_swap_b32 v252, v253
    v_max_f32 v252, v252, v253
    v_mul_f32 v252, s36, v252
    v_max_f32 v253, v252, -v192
    v_add_f32 v254, v192, v253
    v_exp_f32 v254, -v254
    v_sub_f32 v192, 0, v253
    v_mul_f32 v194, v194, v254
    v_accvgpr_read_b32 v253, a0
    v_mul_f32 v253, v253, v254
    v_accvgpr_write_b32 a0, v253
    v_accvgpr_read_b32 v255, a1
    v_mul_f32 v255, v255, v254
    v_accvgpr_write_b32 a1, v255
    v_accvgpr_read_b32 v253, a2
    v_mul_f32 v253, v253, v254
    v_accvgpr_write_b32 a2, v253
    v_accvgpr_read_b32 v255, a3
    v_mul_f32 v255, v255, v254
    v_accvgpr_write_b32 a3, v255
    v_accvgpr_read_b32 v253, a4
    v_mul_f32 v253, v253, v254
    v_accvgpr_write_b32 a4, v253
    v_accvgpr_read_b32 v255, a5
    v_mul_f32 v255, v255, v254
    v_accvgpr_write_b32 a5, v255
    v_accvgpr_read_b32 v253, a6
    v_mul_f32 v253, v253, v254
    v_accvgpr_write_b32 a6, v253
    v_accvgpr_read_b32 v255, a7
    v_mul_f32 v255, v255, v254
    v_accvgpr_write_b32 a7, v255
    v_accvgpr_read_b32 v253, a8
    v_mul_f32 v253, v253, v254
    v_accvgpr_write_b32 a8, v253
    v_accvgpr_read_b32 v255, a9
    v_mul_f32 v255, v255, v254
    v_accvgpr_write_b32 a9, v255
    v_accvgpr_read_b32 v253, a10
    v_mul_f32 v253, v253, v254
    v_accvgpr_write_b32 a10, v253
    v_accvgpr_read_b32 v255, a11
    v_mul_f32 v255, v255, v254
    v_accvgpr_write_b32 a11, v255
    v_accvgpr_read_b32 v253, a12
    v_mul_f32 v253, v253, v254
    v_accvgpr_write_b32 a12, v253
    v_accvgpr_read_b32 v255, a13
    v_mul_f32 v255, v255, v254
    v_accvgpr_write_b32 a13, v255
    v_accvgpr_read_b32 v253, a14
    v_mul_f32 v253, v253, v254
    v_accvgpr_write_b32 a14, v253
    v_accvgpr_read_b32 v255, a15
    v_mul_f32 v255, v255, v254
    v_accvgpr_write_b32 a15, v255
    v_accvgpr_read_b32 v253, a16
    v_mul_f32 v253, v253, v254
    v_accvgpr_write_b32 a16, v253
    v_accvgpr_read_b32 v255, a17
    v_mul_f32 v255, v255, v254
    v_accvgpr_write_b32 a17, v255
    v_accvgpr_read_b32 v253, a18
    v_mul_f32 v253, v253, v254
    v_accvgpr_write_b32 a18, v253
    v_accvgpr_read_b32 v255, a19
    v_mul_f32 v255, v255, v254
    v_accvgpr_write_b32 a19, v255
    v_accvgpr_read_b32 v253, a20
    v_mul_f32 v253, v253, v254
    v_accvgpr_write_b32 a20, v253
    v_accvgpr_read_b32 v255, a21
    v_mul_f32 v255, v255, v254
    v_accvgpr_write_b32 a21, v255
    v_accvgpr_read_b32 v253, a22
    v_mul_f32 v253, v253, v254
    v_accvgpr_write_b32 a22, v253
    v_accvgpr_read_b32 v255, a23
    v_mul_f32 v255, v255, v254
    v_accvgpr_write_b32 a23, v255
    v_accvgpr_read_b32 v253, a24
    v_mul_f32 v253, v253, v254
    v_accvgpr_write_b32 a24, v253
    v_accvgpr_read_b32 v255, a25
    v_mul_f32 v255, v255, v254
    v_accvgpr_write_b32 a25, v255
    v_accvgpr_read_b32 v253, a26
    v_mul_f32 v253, v253, v254
    v_accvgpr_write_b32 a26, v253
    v_accvgpr_read_b32 v255, a27
    v_mul_f32 v255, v255, v254
    v_accvgpr_write_b32 a27, v255
    v_accvgpr_read_b32 v253, a28
    v_mul_f32 v253, v253, v254
    v_accvgpr_write_b32 a28, v253
    v_accvgpr_read_b32 v255, a29
    v_mul_f32 v255, v255, v254
    v_accvgpr_write_b32 a29, v255
    v_accvgpr_read_b32 v253, a30
    v_mul_f32 v253, v253, v254
    v_accvgpr_write_b32 a30, v253
    v_accvgpr_read_b32 v255, a31
    v_mul_f32 v255, v255, v254
    v_accvgpr_write_b32 a31, v255
    v_accvgpr_read_b32 v253, a32
    v_mul_f32 v253, v253, v254
    v_accvgpr_write_b32 a32, v253
    v_accvgpr_read_b32 v255, a33
    v_mul_f32 v255, v255, v254
    v_accvgpr_write_b32 a33, v255
    v_accvgpr_read_b32 v253, a34
    v_mul_f32 v253, v253, v254
    v_accvgpr_write_b32 a34, v253
    v_accvgpr_read_b32 v255, a35
    v_mul_f32 v255, v255, v254
    v_accvgpr_write_b32 a35, v255
    v_accvgpr_read_b32 v253, a36
    v_mul_f32 v253, v253, v254
    v_accvgpr_write_b32 a36, v253
    v_accvgpr_read_b32 v255, a37
    v_mul_f32 v255, v255, v254
    v_accvgpr_write_b32 a37, v255
    v_accvgpr_read_b32 v253, a38
    v_mul_f32 v253, v253, v254
    v_accvgpr_write_b32 a38, v253
    v_accvgpr_read_b32 v255, a39
    v_mul_f32 v255, v255, v254
    v_accvgpr_write_b32 a39, v255
    v_accvgpr_read_b32 v253, a40
    v_mul_f32 v253, v253, v254
    v_accvgpr_write_b32 a40, v253
    v_accvgpr_read_b32 v255, a41
    v_mul_f32 v255, v255, v254
    v_accvgpr_write_b32 a41, v255
    v_accvgpr_read_b32 v253, a42
    v_mul_f32 v253, v253, v254
    v_accvgpr_write_b32 a42, v253
    v_accvgpr_read_b32 v255, a43
    v_mul_f32 v255, v255, v254
    v_accvgpr_write_b32 a43, v255
    v_accvgpr_read_b32 v253, a44
    v_mul_f32 v253, v253, v254
    v_accvgpr_write_b32 a44, v253
    v_accvgpr_read_b32 v255, a45
    v_mul_f32 v255, v255, v254
    v_accvgpr_write_b32 a45, v255
    v_accvgpr_read_b32 v253, a46
    v_mul_f32 v253, v253, v254
    v_accvgpr_write_b32 a46, v253
    v_accvgpr_read_b32 v255, a47
    v_mul_f32 v255, v255, v254
    v_accvgpr_write_b32 a47, v255
    v_accvgpr_read_b32 v253, a48
    v_mul_f32 v253, v253, v254
    v_accvgpr_write_b32 a48, v253
    v_accvgpr_read_b32 v255, a49
    v_mul_f32 v255, v255, v254
    v_accvgpr_write_b32 a49, v255
    v_accvgpr_read_b32 v253, a50
    v_mul_f32 v253, v253, v254
    v_accvgpr_write_b32 a50, v253
    v_accvgpr_read_b32 v255, a51
    v_mul_f32 v255, v255, v254
    v_accvgpr_write_b32 a51, v255
    v_accvgpr_read_b32 v253, a52
    v_mul_f32 v253, v253, v254
    v_accvgpr_write_b32 a52, v253
    v_accvgpr_read_b32 v255, a53
    v_mul_f32 v255, v255, v254
    v_accvgpr_write_b32 a53, v255
    v_accvgpr_read_b32 v253, a54
    v_mul_f32 v253, v253, v254
    v_accvgpr_write_b32 a54, v253
    v_accvgpr_read_b32 v255, a55
    v_mul_f32 v255, v255, v254
    v_accvgpr_write_b32 a55, v255
    v_accvgpr_read_b32 v253, a56
    v_mul_f32 v253, v253, v254
    v_accvgpr_write_b32 a56, v253
    v_accvgpr_read_b32 v255, a57
    v_mul_f32 v255, v255, v254
    v_accvgpr_write_b32 a57, v255
    v_accvgpr_read_b32 v253, a58
    v_mul_f32 v253, v253, v254
    v_accvgpr_write_b32 a58, v253
    v_accvgpr_read_b32 v255, a59
    v_mul_f32 v255, v255, v254
    v_accvgpr_write_b32 a59, v255
    v_accvgpr_read_b32 v253, a60
    v_mul_f32 v253, v253, v254
    v_accvgpr_write_b32 a60, v253
    v_accvgpr_read_b32 v255, a61
    v_mul_f32 v255, v255, v254
    v_accvgpr_write_b32 a61, v255
    v_accvgpr_read_b32 v253, a62
    v_mul_f32 v253, v253, v254
    v_accvgpr_write_b32 a62, v253
    v_accvgpr_read_b32 v255, a63
    v_mul_f32 v255, v255, v254
    v_accvgpr_write_b32 a63, v255
    v_mov_b32 v196, 0
    v_fma_f32 v198, v64, s36, v192
    v_exp_f32 v201, v198
    s_nop 0
    v_add_f32 v196, v196, v201
    v_fma_f32 v198, v65, s36, v192
    v_exp_f32 v202, v198
    s_nop 0
    v_add_f32 v196, v196, v202
    v_cvt_pk_bf16_f32 v160, v201, v202
    v_fma_f32 v198, v66, s36, v192
    v_exp_f32 v201, v198
    s_nop 0
    v_add_f32 v196, v196, v201
    v_fma_f32 v198, v67, s36, v192
    v_exp_f32 v202, v198
    s_nop 0
    v_add_f32 v196, v196, v202
    v_cvt_pk_bf16_f32 v161, v201, v202
    v_fma_f32 v198, v68, s36, v192
    v_exp_f32 v201, v198
    s_nop 0
    v_add_f32 v196, v196, v201
    v_fma_f32 v198, v69, s36, v192
    v_exp_f32 v202, v198
    s_nop 0
    v_add_f32 v196, v196, v202
    v_cvt_pk_bf16_f32 v162, v201, v202
    v_fma_f32 v198, v70, s36, v192
    v_exp_f32 v201, v198
    s_nop 0
    v_add_f32 v196, v196, v201
    v_fma_f32 v198, v71, s36, v192
    v_exp_f32 v202, v198
    s_nop 0
    v_add_f32 v196, v196, v202
    v_cvt_pk_bf16_f32 v163, v201, v202
    v_fma_f32 v198, v72, s36, v192
    v_exp_f32 v201, v198
    s_nop 0
    v_add_f32 v196, v196, v201
    v_fma_f32 v198, v73, s36, v192
    v_exp_f32 v202, v198
    s_nop 0
    v_add_f32 v196, v196, v202
    v_cvt_pk_bf16_f32 v164, v201, v202
    v_fma_f32 v198, v74, s36, v192
    v_exp_f32 v201, v198
    s_nop 0
    v_add_f32 v196, v196, v201
    v_fma_f32 v198, v75, s36, v192
    v_exp_f32 v202, v198
    s_nop 0
    v_add_f32 v196, v196, v202
    v_cvt_pk_bf16_f32 v165, v201, v202
    v_fma_f32 v198, v76, s36, v192
    v_exp_f32 v201, v198
    s_nop 0
    v_add_f32 v196, v196, v201
    v_fma_f32 v198, v77, s36, v192
    v_exp_f32 v202, v198
    s_nop 0
    v_add_f32 v196, v196, v202
    v_cvt_pk_bf16_f32 v166, v201, v202
    v_fma_f32 v198, v78, s36, v192
    v_exp_f32 v201, v198
    s_nop 0
    v_add_f32 v196, v196, v201
    v_fma_f32 v198, v79, s36, v192
    v_exp_f32 v202, v198
    s_nop 0
    v_add_f32 v196, v196, v202
    v_cvt_pk_bf16_f32 v167, v201, v202
    v_fma_f32 v198, v96, s36, v192
    v_exp_f32 v201, v198
    s_nop 0
    v_add_f32 v196, v196, v201
    v_fma_f32 v198, v97, s36, v192
    v_exp_f32 v202, v198
    s_nop 0
    v_add_f32 v196, v196, v202
    v_cvt_pk_bf16_f32 v168, v201, v202
    v_fma_f32 v198, v98, s36, v192
    v_exp_f32 v201, v198
    s_nop 0
    v_add_f32 v196, v196, v201
    v_fma_f32 v198, v99, s36, v192
    v_exp_f32 v202, v198
    s_nop 0
    v_add_f32 v196, v196, v202
    v_cvt_pk_bf16_f32 v169, v201, v202
    v_fma_f32 v198, v100, s36, v192
    v_exp_f32 v201, v198
    s_nop 0
    v_add_f32 v196, v196, v201
    v_fma_f32 v198, v101, s36, v192
    v_exp_f32 v202, v198
    s_nop 0
    v_add_f32 v196, v196, v202
    v_cvt_pk_bf16_f32 v170, v201, v202
    v_fma_f32 v198, v102, s36, v192
    v_exp_f32 v201, v198
    s_nop 0
    v_add_f32 v196, v196, v201
    v_fma_f32 v198, v103, s36, v192
    v_exp_f32 v202, v198
    s_nop 0
    v_add_f32 v196, v196, v202
    v_cvt_pk_bf16_f32 v171, v201, v202
    v_fma_f32 v198, v104, s36, v192
    v_exp_f32 v201, v198
    s_nop 0
    v_add_f32 v196, v196, v201
    v_fma_f32 v198, v105, s36, v192
    v_exp_f32 v202, v198
    s_nop 0
    v_add_f32 v196, v196, v202
    v_cvt_pk_bf16_f32 v172, v201, v202
    v_fma_f32 v198, v106, s36, v192
    v_exp_f32 v201, v198
    s_nop 0
    v_add_f32 v196, v196, v201
    v_fma_f32 v198, v107, s36, v192
    v_exp_f32 v202, v198
    s_nop 0
    v_add_f32 v196, v196, v202
    v_cvt_pk_bf16_f32 v173, v201, v202
    v_fma_f32 v198, v108, s36, v192
    v_exp_f32 v201, v198
    s_nop 0
    v_add_f32 v196, v196, v201
    v_fma_f32 v198, v109, s36, v192
    v_exp_f32 v202, v198
    s_nop 0
    v_add_f32 v196, v196, v202
    v_cvt_pk_bf16_f32 v174, v201, v202
    v_fma_f32 v198, v110, s36, v192
    v_exp_f32 v201, v198
    s_nop 0
    v_add_f32 v196, v196, v201
    v_fma_f32 v198, v111, s36, v192
    v_exp_f32 v202, v198
    s_nop 0
    v_add_f32 v196, v196, v202
    v_cvt_pk_bf16_f32 v175, v201, v202
    v_add_f32 v194, v194, v196
    v_mov_b32 v196, 0
    v_max3_f32 v252, v80, v81, v82
    v_max3_f32 v252, v252, v83, v84
    v_max3_f32 v252, v252, v85, v86
    v_max3_f32 v252, v252, v87, v88
    v_max3_f32 v252, v252, v89, v90
    v_max3_f32 v252, v252, v91, v92
    v_max3_f32 v252, v252, v93, v94
    v_max3_f32 v252, v252, v95, v112
    v_max3_f32 v252, v252, v113, v114
    v_max3_f32 v252, v252, v115, v116
    v_max3_f32 v252, v252, v117, v118
    v_max3_f32 v252, v252, v119, v120
    v_max3_f32 v252, v252, v121, v122
    v_max3_f32 v252, v252, v123, v124
    v_max3_f32 v252, v252, v125, v126
    v_max_f32 v252, v252, v127
    v_mov_b32 v253, v252
    s_nop 1
    v_permlane32_swap_b32 v252, v253
    v_max_f32 v252, v252, v253
    v_mul_f32 v252, s36, v252
    v_max_f32 v253, v252, -v193
    v_add_f32 v254, v193, v253
    v_exp_f32 v254, -v254
    v_sub_f32 v193, 0, v253
    v_mul_f32 v195, v195, v254
    v_accvgpr_read_b32 v253, a64
    v_mul_f32 v253, v253, v254
    v_accvgpr_write_b32 a64, v253
    v_accvgpr_read_b32 v255, a65
    v_mul_f32 v255, v255, v254
    v_accvgpr_write_b32 a65, v255
    v_accvgpr_read_b32 v253, a66
    v_mul_f32 v253, v253, v254
    v_accvgpr_write_b32 a66, v253
    v_accvgpr_read_b32 v255, a67
    v_mul_f32 v255, v255, v254
    v_accvgpr_write_b32 a67, v255
    v_accvgpr_read_b32 v253, a68
    v_mul_f32 v253, v253, v254
    v_accvgpr_write_b32 a68, v253
    v_accvgpr_read_b32 v255, a69
    v_mul_f32 v255, v255, v254
    v_accvgpr_write_b32 a69, v255
    v_accvgpr_read_b32 v253, a70
    v_mul_f32 v253, v253, v254
    v_accvgpr_write_b32 a70, v253
    v_accvgpr_read_b32 v255, a71
    v_mul_f32 v255, v255, v254
    v_accvgpr_write_b32 a71, v255
    v_accvgpr_read_b32 v253, a72
    v_mul_f32 v253, v253, v254
    v_accvgpr_write_b32 a72, v253
    v_accvgpr_read_b32 v255, a73
    v_mul_f32 v255, v255, v254
    v_accvgpr_write_b32 a73, v255
    v_accvgpr_read_b32 v253, a74
    v_mul_f32 v253, v253, v254
    v_accvgpr_write_b32 a74, v253
    v_accvgpr_read_b32 v255, a75
    v_mul_f32 v255, v255, v254
    v_accvgpr_write_b32 a75, v255
    v_accvgpr_read_b32 v253, a76
    v_mul_f32 v253, v253, v254
    v_accvgpr_write_b32 a76, v253
    v_accvgpr_read_b32 v255, a77
    v_mul_f32 v255, v255, v254
    v_accvgpr_write_b32 a77, v255
    v_accvgpr_read_b32 v253, a78
    v_mul_f32 v253, v253, v254
    v_accvgpr_write_b32 a78, v253
    v_accvgpr_read_b32 v255, a79
    v_mul_f32 v255, v255, v254
    v_accvgpr_write_b32 a79, v255
    v_accvgpr_read_b32 v253, a80
    v_mul_f32 v253, v253, v254
    v_accvgpr_write_b32 a80, v253
    v_accvgpr_read_b32 v255, a81
    v_mul_f32 v255, v255, v254
    v_accvgpr_write_b32 a81, v255
    v_accvgpr_read_b32 v253, a82
    v_mul_f32 v253, v253, v254
    v_accvgpr_write_b32 a82, v253
    v_accvgpr_read_b32 v255, a83
    v_mul_f32 v255, v255, v254
    v_accvgpr_write_b32 a83, v255
    v_accvgpr_read_b32 v253, a84
    v_mul_f32 v253, v253, v254
    v_accvgpr_write_b32 a84, v253
    v_accvgpr_read_b32 v255, a85
    v_mul_f32 v255, v255, v254
    v_accvgpr_write_b32 a85, v255
    v_accvgpr_read_b32 v253, a86
    v_mul_f32 v253, v253, v254
    v_accvgpr_write_b32 a86, v253
    v_accvgpr_read_b32 v255, a87
    v_mul_f32 v255, v255, v254
    v_accvgpr_write_b32 a87, v255
    v_accvgpr_read_b32 v253, a88
    v_mul_f32 v253, v253, v254
    v_accvgpr_write_b32 a88, v253
    v_accvgpr_read_b32 v255, a89
    v_mul_f32 v255, v255, v254
    v_accvgpr_write_b32 a89, v255
    v_accvgpr_read_b32 v253, a90
    v_mul_f32 v253, v253, v254
    v_accvgpr_write_b32 a90, v253
    v_accvgpr_read_b32 v255, a91
    v_mul_f32 v255, v255, v254
    v_accvgpr_write_b32 a91, v255
    v_accvgpr_read_b32 v253, a92
    v_mul_f32 v253, v253, v254
    v_accvgpr_write_b32 a92, v253
    v_accvgpr_read_b32 v255, a93
    v_mul_f32 v255, v255, v254
    v_accvgpr_write_b32 a93, v255
    v_accvgpr_read_b32 v253, a94
    v_mul_f32 v253, v253, v254
    v_accvgpr_write_b32 a94, v253
    v_accvgpr_read_b32 v255, a95
    v_mul_f32 v255, v255, v254
    v_accvgpr_write_b32 a95, v255
    v_accvgpr_read_b32 v253, a96
    v_mul_f32 v253, v253, v254
    v_accvgpr_write_b32 a96, v253
    v_accvgpr_read_b32 v255, a97
    v_mul_f32 v255, v255, v254
    v_accvgpr_write_b32 a97, v255
    v_accvgpr_read_b32 v253, a98
    v_mul_f32 v253, v253, v254
    v_accvgpr_write_b32 a98, v253
    v_accvgpr_read_b32 v255, a99
    v_mul_f32 v255, v255, v254
    v_accvgpr_write_b32 a99, v255
    v_accvgpr_read_b32 v253, a100
    v_mul_f32 v253, v253, v254
    v_accvgpr_write_b32 a100, v253
    v_accvgpr_read_b32 v255, a101
    v_mul_f32 v255, v255, v254
    v_accvgpr_write_b32 a101, v255
    v_accvgpr_read_b32 v253, a102
    v_mul_f32 v253, v253, v254
    v_accvgpr_write_b32 a102, v253
    v_accvgpr_read_b32 v255, a103
    v_mul_f32 v255, v255, v254
    v_accvgpr_write_b32 a103, v255
    v_accvgpr_read_b32 v253, a104
    v_mul_f32 v253, v253, v254
    v_accvgpr_write_b32 a104, v253
    v_accvgpr_read_b32 v255, a105
    v_mul_f32 v255, v255, v254
    v_accvgpr_write_b32 a105, v255
    v_accvgpr_read_b32 v253, a106
    v_mul_f32 v253, v253, v254
    v_accvgpr_write_b32 a106, v253
    v_accvgpr_read_b32 v255, a107
    v_mul_f32 v255, v255, v254
    v_accvgpr_write_b32 a107, v255
    v_accvgpr_read_b32 v253, a108
    v_mul_f32 v253, v253, v254
    v_accvgpr_write_b32 a108, v253
    v_accvgpr_read_b32 v255, a109
    v_mul_f32 v255, v255, v254
    v_accvgpr_write_b32 a109, v255
    v_accvgpr_read_b32 v253, a110
    v_mul_f32 v253, v253, v254
    v_accvgpr_write_b32 a110, v253
    v_accvgpr_read_b32 v255, a111
    v_mul_f32 v255, v255, v254
    v_accvgpr_write_b32 a111, v255
    v_accvgpr_read_b32 v253, a112
    v_mul_f32 v253, v253, v254
    v_accvgpr_write_b32 a112, v253
    v_accvgpr_read_b32 v255, a113
    v_mul_f32 v255, v255, v254
    v_accvgpr_write_b32 a113, v255
    v_accvgpr_read_b32 v253, a114
    v_mul_f32 v253, v253, v254
    v_accvgpr_write_b32 a114, v253
    v_accvgpr_read_b32 v255, a115
    v_mul_f32 v255, v255, v254
    v_accvgpr_write_b32 a115, v255
    v_accvgpr_read_b32 v253, a116
    v_mul_f32 v253, v253, v254
    v_accvgpr_write_b32 a116, v253
    v_accvgpr_read_b32 v255, a117
    v_mul_f32 v255, v255, v254
    v_accvgpr_write_b32 a117, v255
    v_accvgpr_read_b32 v253, a118
    v_mul_f32 v253, v253, v254
    v_accvgpr_write_b32 a118, v253
    v_accvgpr_read_b32 v255, a119
    v_mul_f32 v255, v255, v254
    v_accvgpr_write_b32 a119, v255
    v_accvgpr_read_b32 v253, a120
    v_mul_f32 v253, v253, v254
    v_accvgpr_write_b32 a120, v253
    v_accvgpr_read_b32 v255, a121
    v_mul_f32 v255, v255, v254
    v_accvgpr_write_b32 a121, v255
    v_accvgpr_read_b32 v253, a122
    v_mul_f32 v253, v253, v254
    v_accvgpr_write_b32 a122, v253
    v_accvgpr_read_b32 v255, a123
    v_mul_f32 v255, v255, v254
    v_accvgpr_write_b32 a123, v255
    v_accvgpr_read_b32 v253, a124
    v_mul_f32 v253, v253, v254
    v_accvgpr_write_b32 a124, v253
    v_accvgpr_read_b32 v255, a125
    v_mul_f32 v255, v255, v254
    v_accvgpr_write_b32 a125, v255
    v_accvgpr_read_b32 v253, a126
    v_mul_f32 v253, v253, v254
    v_accvgpr_write_b32 a126, v253
    v_accvgpr_read_b32 v255, a127
    v_mul_f32 v255, v255, v254
    v_accvgpr_write_b32 a127, v255
    v_mov_b32 v197, 0
    v_fma_f32 v198, v80, s36, v193
    v_exp_f32 v201, v198
    s_nop 0
    v_add_f32 v197, v197, v201
    v_fma_f32 v198, v81, s36, v193
    v_exp_f32 v202, v198
    s_nop 0
    v_add_f32 v197, v197, v202
    v_cvt_pk_bf16_f32 v176, v201, v202
    v_fma_f32 v198, v82, s36, v193
    v_exp_f32 v201, v198
    s_nop 0
    v_add_f32 v197, v197, v201
    v_fma_f32 v198, v83, s36, v193
    v_exp_f32 v202, v198
    s_nop 0
    v_add_f32 v197, v197, v202
    v_cvt_pk_bf16_f32 v177, v201, v202
    v_fma_f32 v198, v84, s36, v193
    v_exp_f32 v201, v198
    s_nop 0
    v_add_f32 v197, v197, v201
    v_fma_f32 v198, v85, s36, v193
    v_exp_f32 v202, v198
    s_nop 0
    v_add_f32 v197, v197, v202
    v_cvt_pk_bf16_f32 v178, v201, v202
    v_fma_f32 v198, v86, s36, v193
    v_exp_f32 v201, v198
    s_nop 0
    v_add_f32 v197, v197, v201
    v_fma_f32 v198, v87, s36, v193
    v_exp_f32 v202, v198
    s_nop 0
    v_add_f32 v197, v197, v202
    v_cvt_pk_bf16_f32 v179, v201, v202
    v_fma_f32 v198, v88, s36, v193
    v_exp_f32 v201, v198
    s_nop 0
    v_add_f32 v197, v197, v201
    v_fma_f32 v198, v89, s36, v193
    v_exp_f32 v202, v198
    s_nop 0
    v_add_f32 v197, v197, v202
    v_cvt_pk_bf16_f32 v180, v201, v202
    v_fma_f32 v198, v90, s36, v193
    v_exp_f32 v201, v198
    s_nop 0
    v_add_f32 v197, v197, v201
    v_fma_f32 v198, v91, s36, v193
    v_exp_f32 v202, v198
    s_nop 0
    v_add_f32 v197, v197, v202
    v_cvt_pk_bf16_f32 v181, v201, v202
    v_fma_f32 v198, v92, s36, v193
    v_exp_f32 v201, v198
    s_nop 0
    v_add_f32 v197, v197, v201
    v_fma_f32 v198, v93, s36, v193
    v_exp_f32 v202, v198
    s_nop 0
    v_add_f32 v197, v197, v202
    v_cvt_pk_bf16_f32 v182, v201, v202
    v_fma_f32 v198, v94, s36, v193
    v_exp_f32 v201, v198
    s_nop 0
    v_add_f32 v197, v197, v201
    v_fma_f32 v198, v95, s36, v193
    v_exp_f32 v202, v198
    s_nop 0
    v_add_f32 v197, v197, v202
    v_cvt_pk_bf16_f32 v183, v201, v202
    v_fma_f32 v198, v112, s36, v193
    v_exp_f32 v201, v198
    s_nop 0
    v_add_f32 v197, v197, v201
    v_fma_f32 v198, v113, s36, v193
    v_exp_f32 v202, v198
    s_nop 0
    v_add_f32 v197, v197, v202
    v_cvt_pk_bf16_f32 v184, v201, v202
    v_fma_f32 v198, v114, s36, v193
    v_exp_f32 v201, v198
    s_nop 0
    v_add_f32 v197, v197, v201
    v_fma_f32 v198, v115, s36, v193
    v_exp_f32 v202, v198
    s_nop 0
    v_add_f32 v197, v197, v202
    v_cvt_pk_bf16_f32 v185, v201, v202
    v_fma_f32 v198, v116, s36, v193
    v_exp_f32 v201, v198
    s_nop 0
    v_add_f32 v197, v197, v201
    v_fma_f32 v198, v117, s36, v193
    v_exp_f32 v202, v198
    s_nop 0
    v_add_f32 v197, v197, v202
    v_cvt_pk_bf16_f32 v186, v201, v202
    v_fma_f32 v198, v118, s36, v193
    v_exp_f32 v201, v198
    s_nop 0
    v_add_f32 v197, v197, v201
    v_fma_f32 v198, v119, s36, v193
    v_exp_f32 v202, v198
    s_nop 0
    v_add_f32 v197, v197, v202
    v_cvt_pk_bf16_f32 v187, v201, v202
    v_fma_f32 v198, v120, s36, v193
    v_exp_f32 v201, v198
    s_nop 0
    v_add_f32 v197, v197, v201
    v_fma_f32 v198, v121, s36, v193
    v_exp_f32 v202, v198
    s_nop 0
    v_add_f32 v197, v197, v202
    v_cvt_pk_bf16_f32 v188, v201, v202
    v_fma_f32 v198, v122, s36, v193
    v_exp_f32 v201, v198
    s_nop 0
    v_add_f32 v197, v197, v201
    v_fma_f32 v198, v123, s36, v193
    v_exp_f32 v202, v198
    s_nop 0
    v_add_f32 v197, v197, v202
    v_cvt_pk_bf16_f32 v189, v201, v202
    v_fma_f32 v198, v124, s36, v193
    v_exp_f32 v201, v198
    s_nop 0
    v_add_f32 v197, v197, v201
    v_fma_f32 v198, v125, s36, v193
    v_exp_f32 v202, v198
    s_nop 0
    v_add_f32 v197, v197, v202
    v_cvt_pk_bf16_f32 v190, v201, v202
    v_fma_f32 v198, v126, s36, v193
    v_exp_f32 v201, v198
    s_nop 0
    v_add_f32 v197, v197, v201
    v_fma_f32 v198, v127, s36, v193
    v_exp_f32 v202, v198
    s_nop 0
    v_add_f32 v197, v197, v202
    v_cvt_pk_bf16_f32 v191, v201, v202
    v_add_f32 v195, v195, v197
    v_mov_b32 v197, 0
    s_nop 3
    s_branch BACK_X29
RARE_X30:
    s_nop 7
    v_max3_f32 v252, v0, v1, v2
    v_max3_f32 v252, v252, v3, v4
    v_max3_f32 v252, v252, v5, v6
    v_max3_f32 v252, v252, v7, v8
    v_max3_f32 v252, v252, v9, v10
    v_max3_f32 v252, v252, v11, v12
    v_max3_f32 v252, v252, v13, v14
    v_max3_f32 v252, v252, v15, v32
    v_max3_f32 v252, v252, v33, v34
    v_max3_f32 v252, v252, v35, v36
    v_max3_f32 v252, v252, v37, v38
    v_max3_f32 v252, v252, v39, v40
    v_max3_f32 v252, v252, v41, v42
    v_max3_f32 v252, v252, v43, v44
    v_max3_f32 v252, v252, v45, v46
    v_max_f32 v252, v252, v47
    v_mov_b32 v253, v252
    s_nop 1
    v_permlane32_swap_b32 v252, v253
    v_max_f32 v252, v252, v253
    v_mul_f32 v252, s36, v252
    v_max_f32 v253, v252, -v192
    v_add_f32 v254, v192, v253
    v_exp_f32 v254, -v254
    v_sub_f32 v192, 0, v253
    v_mul_f32 v194, v194, v254
    v_accvgpr_read_b32 v253, a0
    v_mul_f32 v253, v253, v254
    v_accvgpr_write_b32 a0, v253
    v_accvgpr_read_b32 v255, a1
    v_mul_f32 v255, v255, v254
    v_accvgpr_write_b32 a1, v255
    v_accvgpr_read_b32 v253, a2
    v_mul_f32 v253, v253, v254
    v_accvgpr_write_b32 a2, v253
    v_accvgpr_read_b32 v255, a3
    v_mul_f32 v255, v255, v254
    v_accvgpr_write_b32 a3, v255
    v_accvgpr_read_b32 v253, a4
    v_mul_f32 v253, v253, v254
    v_accvgpr_write_b32 a4, v253
    v_accvgpr_read_b32 v255, a5
    v_mul_f32 v255, v255, v254
    v_accvgpr_write_b32 a5, v255
    v_accvgpr_read_b32 v253, a6
    v_mul_f32 v253, v253, v254
    v_accvgpr_write_b32 a6, v253
    v_accvgpr_read_b32 v255, a7
    v_mul_f32 v255, v255, v254
    v_accvgpr_write_b32 a7, v255
    v_accvgpr_read_b32 v253, a8
    v_mul_f32 v253, v253, v254
    v_accvgpr_write_b32 a8, v253
    v_accvgpr_read_b32 v255, a9
    v_mul_f32 v255, v255, v254
    v_accvgpr_write_b32 a9, v255
    v_accvgpr_read_b32 v253, a10
    v_mul_f32 v253, v253, v254
    v_accvgpr_write_b32 a10, v253
    v_accvgpr_read_b32 v255, a11
    v_mul_f32 v255, v255, v254
    v_accvgpr_write_b32 a11, v255
    v_accvgpr_read_b32 v253, a12
    v_mul_f32 v253, v253, v254
    v_accvgpr_write_b32 a12, v253
    v_accvgpr_read_b32 v255, a13
    v_mul_f32 v255, v255, v254
    v_accvgpr_write_b32 a13, v255
    v_accvgpr_read_b32 v253, a14
    v_mul_f32 v253, v253, v254
    v_accvgpr_write_b32 a14, v253
    v_accvgpr_read_b32 v255, a15
    v_mul_f32 v255, v255, v254
    v_accvgpr_write_b32 a15, v255
    v_accvgpr_read_b32 v253, a16
    v_mul_f32 v253, v253, v254
    v_accvgpr_write_b32 a16, v253
    v_accvgpr_read_b32 v255, a17
    v_mul_f32 v255, v255, v254
    v_accvgpr_write_b32 a17, v255
    v_accvgpr_read_b32 v253, a18
    v_mul_f32 v253, v253, v254
    v_accvgpr_write_b32 a18, v253
    v_accvgpr_read_b32 v255, a19
    v_mul_f32 v255, v255, v254
    v_accvgpr_write_b32 a19, v255
    v_accvgpr_read_b32 v253, a20
    v_mul_f32 v253, v253, v254
    v_accvgpr_write_b32 a20, v253
    v_accvgpr_read_b32 v255, a21
    v_mul_f32 v255, v255, v254
    v_accvgpr_write_b32 a21, v255
    v_accvgpr_read_b32 v253, a22
    v_mul_f32 v253, v253, v254
    v_accvgpr_write_b32 a22, v253
    v_accvgpr_read_b32 v255, a23
    v_mul_f32 v255, v255, v254
    v_accvgpr_write_b32 a23, v255
    v_accvgpr_read_b32 v253, a24
    v_mul_f32 v253, v253, v254
    v_accvgpr_write_b32 a24, v253
    v_accvgpr_read_b32 v255, a25
    v_mul_f32 v255, v255, v254
    v_accvgpr_write_b32 a25, v255
    v_accvgpr_read_b32 v253, a26
    v_mul_f32 v253, v253, v254
    v_accvgpr_write_b32 a26, v253
    v_accvgpr_read_b32 v255, a27
    v_mul_f32 v255, v255, v254
    v_accvgpr_write_b32 a27, v255
    v_accvgpr_read_b32 v253, a28
    v_mul_f32 v253, v253, v254
    v_accvgpr_write_b32 a28, v253
    v_accvgpr_read_b32 v255, a29
    v_mul_f32 v255, v255, v254
    v_accvgpr_write_b32 a29, v255
    v_accvgpr_read_b32 v253, a30
    v_mul_f32 v253, v253, v254
    v_accvgpr_write_b32 a30, v253
    v_accvgpr_read_b32 v255, a31
    v_mul_f32 v255, v255, v254
    v_accvgpr_write_b32 a31, v255
    v_accvgpr_read_b32 v253, a32
    v_mul_f32 v253, v253, v254
    v_accvgpr_write_b32 a32, v253
    v_accvgpr_read_b32 v255, a33
    v_mul_f32 v255, v255, v254
    v_accvgpr_write_b32 a33, v255
    v_accvgpr_read_b32 v253, a34
    v_mul_f32 v253, v253, v254
    v_accvgpr_write_b32 a34, v253
    v_accvgpr_read_b32 v255, a35
    v_mul_f32 v255, v255, v254
    v_accvgpr_write_b32 a35, v255
    v_accvgpr_read_b32 v253, a36
    v_mul_f32 v253, v253, v254
    v_accvgpr_write_b32 a36, v253
    v_accvgpr_read_b32 v255, a37
    v_mul_f32 v255, v255, v254
    v_accvgpr_write_b32 a37, v255
    v_accvgpr_read_b32 v253, a38
    v_mul_f32 v253, v253, v254
    v_accvgpr_write_b32 a38, v253
    v_accvgpr_read_b32 v255, a39
    v_mul_f32 v255, v255, v254
    v_accvgpr_write_b32 a39, v255
    v_accvgpr_read_b32 v253, a40
    v_mul_f32 v253, v253, v254
    v_accvgpr_write_b32 a40, v253
    v_accvgpr_read_b32 v255, a41
    v_mul_f32 v255, v255, v254
    v_accvgpr_write_b32 a41, v255
    v_accvgpr_read_b32 v253, a42
    v_mul_f32 v253, v253, v254
    v_accvgpr_write_b32 a42, v253
    v_accvgpr_read_b32 v255, a43
    v_mul_f32 v255, v255, v254
    v_accvgpr_write_b32 a43, v255
    v_accvgpr_read_b32 v253, a44
    v_mul_f32 v253, v253, v254
    v_accvgpr_write_b32 a44, v253
    v_accvgpr_read_b32 v255, a45
    v_mul_f32 v255, v255, v254
    v_accvgpr_write_b32 a45, v255
    v_accvgpr_read_b32 v253, a46
    v_mul_f32 v253, v253, v254
    v_accvgpr_write_b32 a46, v253
    v_accvgpr_read_b32 v255, a47
    v_mul_f32 v255, v255, v254
    v_accvgpr_write_b32 a47, v255
    v_accvgpr_read_b32 v253, a48
    v_mul_f32 v253, v253, v254
    v_accvgpr_write_b32 a48, v253
    v_accvgpr_read_b32 v255, a49
    v_mul_f32 v255, v255, v254
    v_accvgpr_write_b32 a49, v255
    v_accvgpr_read_b32 v253, a50
    v_mul_f32 v253, v253, v254
    v_accvgpr_write_b32 a50, v253
    v_accvgpr_read_b32 v255, a51
    v_mul_f32 v255, v255, v254
    v_accvgpr_write_b32 a51, v255
    v_accvgpr_read_b32 v253, a52
    v_mul_f32 v253, v253, v254
    v_accvgpr_write_b32 a52, v253
    v_accvgpr_read_b32 v255, a53
    v_mul_f32 v255, v255, v254
    v_accvgpr_write_b32 a53, v255
    v_accvgpr_read_b32 v253, a54
    v_mul_f32 v253, v253, v254
    v_accvgpr_write_b32 a54, v253
    v_accvgpr_read_b32 v255, a55
    v_mul_f32 v255, v255, v254
    v_accvgpr_write_b32 a55, v255
    v_accvgpr_read_b32 v253, a56
    v_mul_f32 v253, v253, v254
    v_accvgpr_write_b32 a56, v253
    v_accvgpr_read_b32 v255, a57
    v_mul_f32 v255, v255, v254
    v_accvgpr_write_b32 a57, v255
    v_accvgpr_read_b32 v253, a58
    v_mul_f32 v253, v253, v254
    v_accvgpr_write_b32 a58, v253
    v_accvgpr_read_b32 v255, a59
    v_mul_f32 v255, v255, v254
    v_accvgpr_write_b32 a59, v255
    v_accvgpr_read_b32 v253, a60
    v_mul_f32 v253, v253, v254
    v_accvgpr_write_b32 a60, v253
    v_accvgpr_read_b32 v255, a61
    v_mul_f32 v255, v255, v254
    v_accvgpr_write_b32 a61, v255
    v_accvgpr_read_b32 v253, a62
    v_mul_f32 v253, v253, v254
    v_accvgpr_write_b32 a62, v253
    v_accvgpr_read_b32 v255, a63
    v_mul_f32 v255, v255, v254
    v_accvgpr_write_b32 a63, v255
    v_mov_b32 v196, 0
    v_fma_f32 v198, v0, s36, v192
    v_exp_f32 v201, v198
    s_nop 0
    v_add_f32 v196, v196, v201
    v_fma_f32 v198, v1, s36, v192
    v_exp_f32 v202, v198
    s_nop 0
    v_add_f32 v196, v196, v202
    v_cvt_pk_bf16_f32 v128, v201, v202
    v_fma_f32 v198, v2, s36, v192
    v_exp_f32 v201, v198
    s_nop 0
    v_add_f32 v196, v196, v201
    v_fma_f32 v198, v3, s36, v192
    v_exp_f32 v202, v198
    s_nop 0
    v_add_f32 v196, v196, v202
    v_cvt_pk_bf16_f32 v129, v201, v202
    v_fma_f32 v198, v4, s36, v192
    v_exp_f32 v201, v198
    s_nop 0
    v_add_f32 v196, v196, v201
    v_fma_f32 v198, v5, s36, v192
    v_exp_f32 v202, v198
    s_nop 0
    v_add_f32 v196, v196, v202
    v_cvt_pk_bf16_f32 v130, v201, v202
    v_fma_f32 v198, v6, s36, v192
    v_exp_f32 v201, v198
    s_nop 0
    v_add_f32 v196, v196, v201
    v_fma_f32 v198, v7, s36, v192
    v_exp_f32 v202, v198
    s_nop 0
    v_add_f32 v196, v196, v202
    v_cvt_pk_bf16_f32 v131, v201, v202
    v_fma_f32 v198, v8, s36, v192
    v_exp_f32 v201, v198
    s_nop 0
    v_add_f32 v196, v196, v201
    v_fma_f32 v198, v9, s36, v192
    v_exp_f32 v202, v198
    s_nop 0
    v_add_f32 v196, v196, v202
    v_cvt_pk_bf16_f32 v132, v201, v202
    v_fma_f32 v198, v10, s36, v192
    v_exp_f32 v201, v198
    s_nop 0
    v_add_f32 v196, v196, v201
    v_fma_f32 v198, v11, s36, v192
    v_exp_f32 v202, v198
    s_nop 0
    v_add_f32 v196, v196, v202
    v_cvt_pk_bf16_f32 v133, v201, v202
    v_fma_f32 v198, v12, s36, v192
    v_exp_f32 v201, v198
    s_nop 0
    v_add_f32 v196, v196, v201
    v_fma_f32 v198, v13, s36, v192
    v_exp_f32 v202, v198
    s_nop 0
    v_add_f32 v196, v196, v202
    v_cvt_pk_bf16_f32 v134, v201, v202
    v_fma_f32 v198, v14, s36, v192
    v_exp_f32 v201, v198
    s_nop 0
    v_add_f32 v196, v196, v201
    v_fma_f32 v198, v15, s36, v192
    v_exp_f32 v202, v198
    s_nop 0
    v_add_f32 v196, v196, v202
    v_cvt_pk_bf16_f32 v135, v201, v202
    v_fma_f32 v198, v32, s36, v192
    v_exp_f32 v201, v198
    s_nop 0
    v_add_f32 v196, v196, v201
    v_fma_f32 v198, v33, s36, v192
    v_exp_f32 v202, v198
    s_nop 0
    v_add_f32 v196, v196, v202
    v_cvt_pk_bf16_f32 v136, v201, v202
    v_fma_f32 v198, v34, s36, v192
    v_exp_f32 v201, v198
    s_nop 0
    v_add_f32 v196, v196, v201
    v_fma_f32 v198, v35, s36, v192
    v_exp_f32 v202, v198
    s_nop 0
    v_add_f32 v196, v196, v202
    v_cvt_pk_bf16_f32 v137, v201, v202
    v_fma_f32 v198, v36, s36, v192
    v_exp_f32 v201, v198
    s_nop 0
    v_add_f32 v196, v196, v201
    v_fma_f32 v198, v37, s36, v192
    v_exp_f32 v202, v198
    s_nop 0
    v_add_f32 v196, v196, v202
    v_cvt_pk_bf16_f32 v138, v201, v202
    v_fma_f32 v198, v38, s36, v192
    v_exp_f32 v201, v198
    s_nop 0
    v_add_f32 v196, v196, v201
    v_fma_f32 v198, v39, s36, v192
    v_exp_f32 v202, v198
    s_nop 0
    v_add_f32 v196, v196, v202
    v_cvt_pk_bf16_f32 v139, v201, v202
    v_fma_f32 v198, v40, s36, v192
    v_exp_f32 v201, v198
    s_nop 0
    v_add_f32 v196, v196, v201
    v_fma_f32 v198, v41, s36, v192
    v_exp_f32 v202, v198
    s_nop 0
    v_add_f32 v196, v196, v202
    v_cvt_pk_bf16_f32 v140, v201, v202
    v_fma_f32 v198, v42, s36, v192
    v_exp_f32 v201, v198
    s_nop 0
    v_add_f32 v196, v196, v201
    v_fma_f32 v198, v43, s36, v192
    v_exp_f32 v202, v198
    s_nop 0
    v_add_f32 v196, v196, v202
    v_cvt_pk_bf16_f32 v141, v201, v202
    v_fma_f32 v198, v44, s36, v192
    v_exp_f32 v201, v198
    s_nop 0
    v_add_f32 v196, v196, v201
    v_fma_f32 v198, v45, s36, v192
    v_exp_f32 v202, v198
    s_nop 0
    v_add_f32 v196, v196, v202
    v_cvt_pk_bf16_f32 v142, v201, v202
    v_fma_f32 v198, v46, s36, v192
    v_exp_f32 v201, v198
    s_nop 0
    v_add_f32 v196, v196, v201
    v_fma_f32 v198, v47, s36, v192
    v_exp_f32 v202, v198
    s_nop 0
    v_add_f32 v196, v196, v202
    v_cvt_pk_bf16_f32 v143, v201, v202
    v_add_f32 v194, v194, v196
    v_mov_b32 v196, 0
    v_max3_f32 v252, v16, v17, v18
    v_max3_f32 v252, v252, v19, v20
    v_max3_f32 v252, v252, v21, v22
    v_max3_f32 v252, v252, v23, v24
    v_max3_f32 v252, v252, v25, v26
    v_max3_f32 v252, v252, v27, v28
    v_max3_f32 v252, v252, v29, v30
    v_max3_f32 v252, v252, v31, v48
    v_max3_f32 v252, v252, v49, v50
    v_max3_f32 v252, v252, v51, v52
    v_max3_f32 v252, v252, v53, v54
    v_max3_f32 v252, v252, v55, v56
    v_max3_f32 v252, v252, v57, v58
    v_max3_f32 v252, v252, v59, v60
    v_max3_f32 v252, v252, v61, v62
    v_max_f32 v252, v252, v63
    v_mov_b32 v253, v252
    s_nop 1
    v_permlane32_swap_b32 v252, v253
    v_max_f32 v252, v252, v253
    v_mul_f32 v252, s36, v252
    v_max_f32 v253, v252, -v193
    v_add_f32 v254, v193, v253
    v_exp_f32 v254, -v254
    v_sub_f32 v193, 0, v253
    v_mul_f32 v195, v195, v254
    v_accvgpr_read_b32 v253, a64
    v_mul_f32 v253, v253, v254
    v_accvgpr_write_b32 a64, v253
    v_accvgpr_read_b32 v255, a65
    v_mul_f32 v255, v255, v254
    v_accvgpr_write_b32 a65, v255
    v_accvgpr_read_b32 v253, a66
    v_mul_f32 v253, v253, v254
    v_accvgpr_write_b32 a66, v253
    v_accvgpr_read_b32 v255, a67
    v_mul_f32 v255, v255, v254
    v_accvgpr_write_b32 a67, v255
    v_accvgpr_read_b32 v253, a68
    v_mul_f32 v253, v253, v254
    v_accvgpr_write_b32 a68, v253
    v_accvgpr_read_b32 v255, a69
    v_mul_f32 v255, v255, v254
    v_accvgpr_write_b32 a69, v255
    v_accvgpr_read_b32 v253, a70
    v_mul_f32 v253, v253, v254
    v_accvgpr_write_b32 a70, v253
    v_accvgpr_read_b32 v255, a71
    v_mul_f32 v255, v255, v254
    v_accvgpr_write_b32 a71, v255
    v_accvgpr_read_b32 v253, a72
    v_mul_f32 v253, v253, v254
    v_accvgpr_write_b32 a72, v253
    v_accvgpr_read_b32 v255, a73
    v_mul_f32 v255, v255, v254
    v_accvgpr_write_b32 a73, v255
    v_accvgpr_read_b32 v253, a74
    v_mul_f32 v253, v253, v254
    v_accvgpr_write_b32 a74, v253
    v_accvgpr_read_b32 v255, a75
    v_mul_f32 v255, v255, v254
    v_accvgpr_write_b32 a75, v255
    v_accvgpr_read_b32 v253, a76
    v_mul_f32 v253, v253, v254
    v_accvgpr_write_b32 a76, v253
    v_accvgpr_read_b32 v255, a77
    v_mul_f32 v255, v255, v254
    v_accvgpr_write_b32 a77, v255
    v_accvgpr_read_b32 v253, a78
    v_mul_f32 v253, v253, v254
    v_accvgpr_write_b32 a78, v253
    v_accvgpr_read_b32 v255, a79
    v_mul_f32 v255, v255, v254
    v_accvgpr_write_b32 a79, v255
    v_accvgpr_read_b32 v253, a80
    v_mul_f32 v253, v253, v254
    v_accvgpr_write_b32 a80, v253
    v_accvgpr_read_b32 v255, a81
    v_mul_f32 v255, v255, v254
    v_accvgpr_write_b32 a81, v255
    v_accvgpr_read_b32 v253, a82
    v_mul_f32 v253, v253, v254
    v_accvgpr_write_b32 a82, v253
    v_accvgpr_read_b32 v255, a83
    v_mul_f32 v255, v255, v254
    v_accvgpr_write_b32 a83, v255
    v_accvgpr_read_b32 v253, a84
    v_mul_f32 v253, v253, v254
    v_accvgpr_write_b32 a84, v253
    v_accvgpr_read_b32 v255, a85
    v_mul_f32 v255, v255, v254
    v_accvgpr_write_b32 a85, v255
    v_accvgpr_read_b32 v253, a86
    v_mul_f32 v253, v253, v254
    v_accvgpr_write_b32 a86, v253
    v_accvgpr_read_b32 v255, a87
    v_mul_f32 v255, v255, v254
    v_accvgpr_write_b32 a87, v255
    v_accvgpr_read_b32 v253, a88
    v_mul_f32 v253, v253, v254
    v_accvgpr_write_b32 a88, v253
    v_accvgpr_read_b32 v255, a89
    v_mul_f32 v255, v255, v254
    v_accvgpr_write_b32 a89, v255
    v_accvgpr_read_b32 v253, a90
    v_mul_f32 v253, v253, v254
    v_accvgpr_write_b32 a90, v253
    v_accvgpr_read_b32 v255, a91
    v_mul_f32 v255, v255, v254
    v_accvgpr_write_b32 a91, v255
    v_accvgpr_read_b32 v253, a92
    v_mul_f32 v253, v253, v254
    v_accvgpr_write_b32 a92, v253
    v_accvgpr_read_b32 v255, a93
    v_mul_f32 v255, v255, v254
    v_accvgpr_write_b32 a93, v255
    v_accvgpr_read_b32 v253, a94
    v_mul_f32 v253, v253, v254
    v_accvgpr_write_b32 a94, v253
    v_accvgpr_read_b32 v255, a95
    v_mul_f32 v255, v255, v254
    v_accvgpr_write_b32 a95, v255
    v_accvgpr_read_b32 v253, a96
    v_mul_f32 v253, v253, v254
    v_accvgpr_write_b32 a96, v253
    v_accvgpr_read_b32 v255, a97
    v_mul_f32 v255, v255, v254
    v_accvgpr_write_b32 a97, v255
    v_accvgpr_read_b32 v253, a98
    v_mul_f32 v253, v253, v254
    v_accvgpr_write_b32 a98, v253
    v_accvgpr_read_b32 v255, a99
    v_mul_f32 v255, v255, v254
    v_accvgpr_write_b32 a99, v255
    v_accvgpr_read_b32 v253, a100
    v_mul_f32 v253, v253, v254
    v_accvgpr_write_b32 a100, v253
    v_accvgpr_read_b32 v255, a101
    v_mul_f32 v255, v255, v254
    v_accvgpr_write_b32 a101, v255
    v_accvgpr_read_b32 v253, a102
    v_mul_f32 v253, v253, v254
    v_accvgpr_write_b32 a102, v253
    v_accvgpr_read_b32 v255, a103
    v_mul_f32 v255, v255, v254
    v_accvgpr_write_b32 a103, v255
    v_accvgpr_read_b32 v253, a104
    v_mul_f32 v253, v253, v254
    v_accvgpr_write_b32 a104, v253
    v_accvgpr_read_b32 v255, a105
    v_mul_f32 v255, v255, v254
    v_accvgpr_write_b32 a105, v255
    v_accvgpr_read_b32 v253, a106
    v_mul_f32 v253, v253, v254
    v_accvgpr_write_b32 a106, v253
    v_accvgpr_read_b32 v255, a107
    v_mul_f32 v255, v255, v254
    v_accvgpr_write_b32 a107, v255
    v_accvgpr_read_b32 v253, a108
    v_mul_f32 v253, v253, v254
    v_accvgpr_write_b32 a108, v253
    v_accvgpr_read_b32 v255, a109
    v_mul_f32 v255, v255, v254
    v_accvgpr_write_b32 a109, v255
    v_accvgpr_read_b32 v253, a110
    v_mul_f32 v253, v253, v254
    v_accvgpr_write_b32 a110, v253
    v_accvgpr_read_b32 v255, a111
    v_mul_f32 v255, v255, v254
    v_accvgpr_write_b32 a111, v255
    v_accvgpr_read_b32 v253, a112
    v_mul_f32 v253, v253, v254
    v_accvgpr_write_b32 a112, v253
    v_accvgpr_read_b32 v255, a113
    v_mul_f32 v255, v255, v254
    v_accvgpr_write_b32 a113, v255
    v_accvgpr_read_b32 v253, a114
    v_mul_f32 v253, v253, v254
    v_accvgpr_write_b32 a114, v253
    v_accvgpr_read_b32 v255, a115
    v_mul_f32 v255, v255, v254
    v_accvgpr_write_b32 a115, v255
    v_accvgpr_read_b32 v253, a116
    v_mul_f32 v253, v253, v254
    v_accvgpr_write_b32 a116, v253
    v_accvgpr_read_b32 v255, a117
    v_mul_f32 v255, v255, v254
    v_accvgpr_write_b32 a117, v255
    v_accvgpr_read_b32 v253, a118
    v_mul_f32 v253, v253, v254
    v_accvgpr_write_b32 a118, v253
    v_accvgpr_read_b32 v255, a119
    v_mul_f32 v255, v255, v254
    v_accvgpr_write_b32 a119, v255
    v_accvgpr_read_b32 v253, a120
    v_mul_f32 v253, v253, v254
    v_accvgpr_write_b32 a120, v253
    v_accvgpr_read_b32 v255, a121
    v_mul_f32 v255, v255, v254
    v_accvgpr_write_b32 a121, v255
    v_accvgpr_read_b32 v253, a122
    v_mul_f32 v253, v253, v254
    v_accvgpr_write_b32 a122, v253
    v_accvgpr_read_b32 v255, a123
    v_mul_f32 v255, v255, v254
    v_accvgpr_write_b32 a123, v255
    v_accvgpr_read_b32 v253, a124
    v_mul_f32 v253, v253, v254
    v_accvgpr_write_b32 a124, v253
    v_accvgpr_read_b32 v255, a125
    v_mul_f32 v255, v255, v254
    v_accvgpr_write_b32 a125, v255
    v_accvgpr_read_b32 v253, a126
    v_mul_f32 v253, v253, v254
    v_accvgpr_write_b32 a126, v253
    v_accvgpr_read_b32 v255, a127
    v_mul_f32 v255, v255, v254
    v_accvgpr_write_b32 a127, v255
    v_mov_b32 v197, 0
    v_fma_f32 v198, v16, s36, v193
    v_exp_f32 v201, v198
    s_nop 0
    v_add_f32 v197, v197, v201
    v_fma_f32 v198, v17, s36, v193
    v_exp_f32 v202, v198
    s_nop 0
    v_add_f32 v197, v197, v202
    v_cvt_pk_bf16_f32 v144, v201, v202
    v_fma_f32 v198, v18, s36, v193
    v_exp_f32 v201, v198
    s_nop 0
    v_add_f32 v197, v197, v201
    v_fma_f32 v198, v19, s36, v193
    v_exp_f32 v202, v198
    s_nop 0
    v_add_f32 v197, v197, v202
    v_cvt_pk_bf16_f32 v145, v201, v202
    v_fma_f32 v198, v20, s36, v193
    v_exp_f32 v201, v198
    s_nop 0
    v_add_f32 v197, v197, v201
    v_fma_f32 v198, v21, s36, v193
    v_exp_f32 v202, v198
    s_nop 0
    v_add_f32 v197, v197, v202
    v_cvt_pk_bf16_f32 v146, v201, v202
    v_fma_f32 v198, v22, s36, v193
    v_exp_f32 v201, v198
    s_nop 0
    v_add_f32 v197, v197, v201
    v_fma_f32 v198, v23, s36, v193
    v_exp_f32 v202, v198
    s_nop 0
    v_add_f32 v197, v197, v202
    v_cvt_pk_bf16_f32 v147, v201, v202
    v_fma_f32 v198, v24, s36, v193
    v_exp_f32 v201, v198
    s_nop 0
    v_add_f32 v197, v197, v201
    v_fma_f32 v198, v25, s36, v193
    v_exp_f32 v202, v198
    s_nop 0
    v_add_f32 v197, v197, v202
    v_cvt_pk_bf16_f32 v148, v201, v202
    v_fma_f32 v198, v26, s36, v193
    v_exp_f32 v201, v198
    s_nop 0
    v_add_f32 v197, v197, v201
    v_fma_f32 v198, v27, s36, v193
    v_exp_f32 v202, v198
    s_nop 0
    v_add_f32 v197, v197, v202
    v_cvt_pk_bf16_f32 v149, v201, v202
    v_fma_f32 v198, v28, s36, v193
    v_exp_f32 v201, v198
    s_nop 0
    v_add_f32 v197, v197, v201
    v_fma_f32 v198, v29, s36, v193
    v_exp_f32 v202, v198
    s_nop 0
    v_add_f32 v197, v197, v202
    v_cvt_pk_bf16_f32 v150, v201, v202
    v_fma_f32 v198, v30, s36, v193
    v_exp_f32 v201, v198
    s_nop 0
    v_add_f32 v197, v197, v201
    v_fma_f32 v198, v31, s36, v193
    v_exp_f32 v202, v198
    s_nop 0
    v_add_f32 v197, v197, v202
    v_cvt_pk_bf16_f32 v151, v201, v202
    v_fma_f32 v198, v48, s36, v193
    v_exp_f32 v201, v198
    s_nop 0
    v_add_f32 v197, v197, v201
    v_fma_f32 v198, v49, s36, v193
    v_exp_f32 v202, v198
    s_nop 0
    v_add_f32 v197, v197, v202
    v_cvt_pk_bf16_f32 v152, v201, v202
    v_fma_f32 v198, v50, s36, v193
    v_exp_f32 v201, v198
    s_nop 0
    v_add_f32 v197, v197, v201
    v_fma_f32 v198, v51, s36, v193
    v_exp_f32 v202, v198
    s_nop 0
    v_add_f32 v197, v197, v202
    v_cvt_pk_bf16_f32 v153, v201, v202
    v_fma_f32 v198, v52, s36, v193
    v_exp_f32 v201, v198
    s_nop 0
    v_add_f32 v197, v197, v201
    v_fma_f32 v198, v53, s36, v193
    v_exp_f32 v202, v198
    s_nop 0
    v_add_f32 v197, v197, v202
    v_cvt_pk_bf16_f32 v154, v201, v202
    v_fma_f32 v198, v54, s36, v193
    v_exp_f32 v201, v198
    s_nop 0
    v_add_f32 v197, v197, v201
    v_fma_f32 v198, v55, s36, v193
    v_exp_f32 v202, v198
    s_nop 0
    v_add_f32 v197, v197, v202
    v_cvt_pk_bf16_f32 v155, v201, v202
    v_fma_f32 v198, v56, s36, v193
    v_exp_f32 v201, v198
    s_nop 0
    v_add_f32 v197, v197, v201
    v_fma_f32 v198, v57, s36, v193
    v_exp_f32 v202, v198
    s_nop 0
    v_add_f32 v197, v197, v202
    v_cvt_pk_bf16_f32 v156, v201, v202
    v_fma_f32 v198, v58, s36, v193
    v_exp_f32 v201, v198
    s_nop 0
    v_add_f32 v197, v197, v201
    v_fma_f32 v198, v59, s36, v193
    v_exp_f32 v202, v198
    s_nop 0
    v_add_f32 v197, v197, v202
    v_cvt_pk_bf16_f32 v157, v201, v202
    v_fma_f32 v198, v60, s36, v193
    v_exp_f32 v201, v198
    s_nop 0
    v_add_f32 v197, v197, v201
    v_fma_f32 v198, v61, s36, v193
    v_exp_f32 v202, v198
    s_nop 0
    v_add_f32 v197, v197, v202
    v_cvt_pk_bf16_f32 v158, v201, v202
    v_fma_f32 v198, v62, s36, v193
    v_exp_f32 v201, v198
    s_nop 0
    v_add_f32 v197, v197, v201
    v_fma_f32 v198, v63, s36, v193
    v_exp_f32 v202, v198
    s_nop 0
    v_add_f32 v197, v197, v202
    v_cvt_pk_bf16_f32 v159, v201, v202
    v_add_f32 v195, v195, v197
    v_mov_b32 v197, 0
    s_nop 3
    s_branch BACK_X30
RARE_X31:
    s_nop 7
    v_max3_f32 v252, v64, v65, v66
    v_max3_f32 v252, v252, v67, v68
    v_max3_f32 v252, v252, v69, v70
    v_max3_f32 v252, v252, v71, v72
    v_max3_f32 v252, v252, v73, v74
    v_max3_f32 v252, v252, v75, v76
    v_max3_f32 v252, v252, v77, v78
    v_max3_f32 v252, v252, v79, v96
    v_max3_f32 v252, v252, v97, v98
    v_max3_f32 v252, v252, v99, v100
    v_max3_f32 v252, v252, v101, v102
    v_max3_f32 v252, v252, v103, v104
    v_max3_f32 v252, v252, v105, v106
    v_max3_f32 v252, v252, v107, v108
    v_max3_f32 v252, v252, v109, v110
    v_max_f32 v252, v252, v111
    v_mov_b32 v253, v252
    s_nop 1
    v_permlane32_swap_b32 v252, v253
    v_max_f32 v252, v252, v253
    v_mul_f32 v252, s36, v252
    v_max_f32 v253, v252, -v192
    v_add_f32 v254, v192, v253
    v_exp_f32 v254, -v254
    v_sub_f32 v192, 0, v253
    v_mul_f32 v194, v194, v254
    v_accvgpr_read_b32 v253, a0
    v_mul_f32 v253, v253, v254
    v_accvgpr_write_b32 a0, v253
    v_accvgpr_read_b32 v255, a1
    v_mul_f32 v255, v255, v254
    v_accvgpr_write_b32 a1, v255
    v_accvgpr_read_b32 v253, a2
    v_mul_f32 v253, v253, v254
    v_accvgpr_write_b32 a2, v253
    v_accvgpr_read_b32 v255, a3
    v_mul_f32 v255, v255, v254
    v_accvgpr_write_b32 a3, v255
    v_accvgpr_read_b32 v253, a4
    v_mul_f32 v253, v253, v254
    v_accvgpr_write_b32 a4, v253
    v_accvgpr_read_b32 v255, a5
    v_mul_f32 v255, v255, v254
    v_accvgpr_write_b32 a5, v255
    v_accvgpr_read_b32 v253, a6
    v_mul_f32 v253, v253, v254
    v_accvgpr_write_b32 a6, v253
    v_accvgpr_read_b32 v255, a7
    v_mul_f32 v255, v255, v254
    v_accvgpr_write_b32 a7, v255
    v_accvgpr_read_b32 v253, a8
    v_mul_f32 v253, v253, v254
    v_accvgpr_write_b32 a8, v253
    v_accvgpr_read_b32 v255, a9
    v_mul_f32 v255, v255, v254
    v_accvgpr_write_b32 a9, v255
    v_accvgpr_read_b32 v253, a10
    v_mul_f32 v253, v253, v254
    v_accvgpr_write_b32 a10, v253
    v_accvgpr_read_b32 v255, a11
    v_mul_f32 v255, v255, v254
    v_accvgpr_write_b32 a11, v255
    v_accvgpr_read_b32 v253, a12
    v_mul_f32 v253, v253, v254
    v_accvgpr_write_b32 a12, v253
    v_accvgpr_read_b32 v255, a13
    v_mul_f32 v255, v255, v254
    v_accvgpr_write_b32 a13, v255
    v_accvgpr_read_b32 v253, a14
    v_mul_f32 v253, v253, v254
    v_accvgpr_write_b32 a14, v253
    v_accvgpr_read_b32 v255, a15
    v_mul_f32 v255, v255, v254
    v_accvgpr_write_b32 a15, v255
    v_accvgpr_read_b32 v253, a16
    v_mul_f32 v253, v253, v254
    v_accvgpr_write_b32 a16, v253
    v_accvgpr_read_b32 v255, a17
    v_mul_f32 v255, v255, v254
    v_accvgpr_write_b32 a17, v255
    v_accvgpr_read_b32 v253, a18
    v_mul_f32 v253, v253, v254
    v_accvgpr_write_b32 a18, v253
    v_accvgpr_read_b32 v255, a19
    v_mul_f32 v255, v255, v254
    v_accvgpr_write_b32 a19, v255
    v_accvgpr_read_b32 v253, a20
    v_mul_f32 v253, v253, v254
    v_accvgpr_write_b32 a20, v253
    v_accvgpr_read_b32 v255, a21
    v_mul_f32 v255, v255, v254
    v_accvgpr_write_b32 a21, v255
    v_accvgpr_read_b32 v253, a22
    v_mul_f32 v253, v253, v254
    v_accvgpr_write_b32 a22, v253
    v_accvgpr_read_b32 v255, a23
    v_mul_f32 v255, v255, v254
    v_accvgpr_write_b32 a23, v255
    v_accvgpr_read_b32 v253, a24
    v_mul_f32 v253, v253, v254
    v_accvgpr_write_b32 a24, v253
    v_accvgpr_read_b32 v255, a25
    v_mul_f32 v255, v255, v254
    v_accvgpr_write_b32 a25, v255
    v_accvgpr_read_b32 v253, a26
    v_mul_f32 v253, v253, v254
    v_accvgpr_write_b32 a26, v253
    v_accvgpr_read_b32 v255, a27
    v_mul_f32 v255, v255, v254
    v_accvgpr_write_b32 a27, v255
    v_accvgpr_read_b32 v253, a28
    v_mul_f32 v253, v253, v254
    v_accvgpr_write_b32 a28, v253
    v_accvgpr_read_b32 v255, a29
    v_mul_f32 v255, v255, v254
    v_accvgpr_write_b32 a29, v255
    v_accvgpr_read_b32 v253, a30
    v_mul_f32 v253, v253, v254
    v_accvgpr_write_b32 a30, v253
    v_accvgpr_read_b32 v255, a31
    v_mul_f32 v255, v255, v254
    v_accvgpr_write_b32 a31, v255
    v_accvgpr_read_b32 v253, a32
    v_mul_f32 v253, v253, v254
    v_accvgpr_write_b32 a32, v253
    v_accvgpr_read_b32 v255, a33
    v_mul_f32 v255, v255, v254
    v_accvgpr_write_b32 a33, v255
    v_accvgpr_read_b32 v253, a34
    v_mul_f32 v253, v253, v254
    v_accvgpr_write_b32 a34, v253
    v_accvgpr_read_b32 v255, a35
    v_mul_f32 v255, v255, v254
    v_accvgpr_write_b32 a35, v255
    v_accvgpr_read_b32 v253, a36
    v_mul_f32 v253, v253, v254
    v_accvgpr_write_b32 a36, v253
    v_accvgpr_read_b32 v255, a37
    v_mul_f32 v255, v255, v254
    v_accvgpr_write_b32 a37, v255
    v_accvgpr_read_b32 v253, a38
    v_mul_f32 v253, v253, v254
    v_accvgpr_write_b32 a38, v253
    v_accvgpr_read_b32 v255, a39
    v_mul_f32 v255, v255, v254
    v_accvgpr_write_b32 a39, v255
    v_accvgpr_read_b32 v253, a40
    v_mul_f32 v253, v253, v254
    v_accvgpr_write_b32 a40, v253
    v_accvgpr_read_b32 v255, a41
    v_mul_f32 v255, v255, v254
    v_accvgpr_write_b32 a41, v255
    v_accvgpr_read_b32 v253, a42
    v_mul_f32 v253, v253, v254
    v_accvgpr_write_b32 a42, v253
    v_accvgpr_read_b32 v255, a43
    v_mul_f32 v255, v255, v254
    v_accvgpr_write_b32 a43, v255
    v_accvgpr_read_b32 v253, a44
    v_mul_f32 v253, v253, v254
    v_accvgpr_write_b32 a44, v253
    v_accvgpr_read_b32 v255, a45
    v_mul_f32 v255, v255, v254
    v_accvgpr_write_b32 a45, v255
    v_accvgpr_read_b32 v253, a46
    v_mul_f32 v253, v253, v254
    v_accvgpr_write_b32 a46, v253
    v_accvgpr_read_b32 v255, a47
    v_mul_f32 v255, v255, v254
    v_accvgpr_write_b32 a47, v255
    v_accvgpr_read_b32 v253, a48
    v_mul_f32 v253, v253, v254
    v_accvgpr_write_b32 a48, v253
    v_accvgpr_read_b32 v255, a49
    v_mul_f32 v255, v255, v254
    v_accvgpr_write_b32 a49, v255
    v_accvgpr_read_b32 v253, a50
    v_mul_f32 v253, v253, v254
    v_accvgpr_write_b32 a50, v253
    v_accvgpr_read_b32 v255, a51
    v_mul_f32 v255, v255, v254
    v_accvgpr_write_b32 a51, v255
    v_accvgpr_read_b32 v253, a52
    v_mul_f32 v253, v253, v254
    v_accvgpr_write_b32 a52, v253
    v_accvgpr_read_b32 v255, a53
    v_mul_f32 v255, v255, v254
    v_accvgpr_write_b32 a53, v255
    v_accvgpr_read_b32 v253, a54
    v_mul_f32 v253, v253, v254
    v_accvgpr_write_b32 a54, v253
    v_accvgpr_read_b32 v255, a55
    v_mul_f32 v255, v255, v254
    v_accvgpr_write_b32 a55, v255
    v_accvgpr_read_b32 v253, a56
    v_mul_f32 v253, v253, v254
    v_accvgpr_write_b32 a56, v253
    v_accvgpr_read_b32 v255, a57
    v_mul_f32 v255, v255, v254
    v_accvgpr_write_b32 a57, v255
    v_accvgpr_read_b32 v253, a58
    v_mul_f32 v253, v253, v254
    v_accvgpr_write_b32 a58, v253
    v_accvgpr_read_b32 v255, a59
    v_mul_f32 v255, v255, v254
    v_accvgpr_write_b32 a59, v255
    v_accvgpr_read_b32 v253, a60
    v_mul_f32 v253, v253, v254
    v_accvgpr_write_b32 a60, v253
    v_accvgpr_read_b32 v255, a61
    v_mul_f32 v255, v255, v254
    v_accvgpr_write_b32 a61, v255
    v_accvgpr_read_b32 v253, a62
    v_mul_f32 v253, v253, v254
    v_accvgpr_write_b32 a62, v253
    v_accvgpr_read_b32 v255, a63
    v_mul_f32 v255, v255, v254
    v_accvgpr_write_b32 a63, v255
    v_mov_b32 v196, 0
    v_fma_f32 v198, v64, s36, v192
    v_exp_f32 v201, v198
    s_nop 0
    v_add_f32 v196, v196, v201
    v_fma_f32 v198, v65, s36, v192
    v_exp_f32 v202, v198
    s_nop 0
    v_add_f32 v196, v196, v202
    v_cvt_pk_bf16_f32 v160, v201, v202
    v_fma_f32 v198, v66, s36, v192
    v_exp_f32 v201, v198
    s_nop 0
    v_add_f32 v196, v196, v201
    v_fma_f32 v198, v67, s36, v192
    v_exp_f32 v202, v198
    s_nop 0
    v_add_f32 v196, v196, v202
    v_cvt_pk_bf16_f32 v161, v201, v202
    v_fma_f32 v198, v68, s36, v192
    v_exp_f32 v201, v198
    s_nop 0
    v_add_f32 v196, v196, v201
    v_fma_f32 v198, v69, s36, v192
    v_exp_f32 v202, v198
    s_nop 0
    v_add_f32 v196, v196, v202
    v_cvt_pk_bf16_f32 v162, v201, v202
    v_fma_f32 v198, v70, s36, v192
    v_exp_f32 v201, v198
    s_nop 0
    v_add_f32 v196, v196, v201
    v_fma_f32 v198, v71, s36, v192
    v_exp_f32 v202, v198
    s_nop 0
    v_add_f32 v196, v196, v202
    v_cvt_pk_bf16_f32 v163, v201, v202
    v_fma_f32 v198, v72, s36, v192
    v_exp_f32 v201, v198
    s_nop 0
    v_add_f32 v196, v196, v201
    v_fma_f32 v198, v73, s36, v192
    v_exp_f32 v202, v198
    s_nop 0
    v_add_f32 v196, v196, v202
    v_cvt_pk_bf16_f32 v164, v201, v202
    v_fma_f32 v198, v74, s36, v192
    v_exp_f32 v201, v198
    s_nop 0
    v_add_f32 v196, v196, v201
    v_fma_f32 v198, v75, s36, v192
    v_exp_f32 v202, v198
    s_nop 0
    v_add_f32 v196, v196, v202
    v_cvt_pk_bf16_f32 v165, v201, v202
    v_fma_f32 v198, v76, s36, v192
    v_exp_f32 v201, v198
    s_nop 0
    v_add_f32 v196, v196, v201
    v_fma_f32 v198, v77, s36, v192
    v_exp_f32 v202, v198
    s_nop 0
    v_add_f32 v196, v196, v202
    v_cvt_pk_bf16_f32 v166, v201, v202
    v_fma_f32 v198, v78, s36, v192
    v_exp_f32 v201, v198
    s_nop 0
    v_add_f32 v196, v196, v201
    v_fma_f32 v198, v79, s36, v192
    v_exp_f32 v202, v198
    s_nop 0
    v_add_f32 v196, v196, v202
    v_cvt_pk_bf16_f32 v167, v201, v202
    v_fma_f32 v198, v96, s36, v192
    v_exp_f32 v201, v198
    s_nop 0
    v_add_f32 v196, v196, v201
    v_fma_f32 v198, v97, s36, v192
    v_exp_f32 v202, v198
    s_nop 0
    v_add_f32 v196, v196, v202
    v_cvt_pk_bf16_f32 v168, v201, v202
    v_fma_f32 v198, v98, s36, v192
    v_exp_f32 v201, v198
    s_nop 0
    v_add_f32 v196, v196, v201
    v_fma_f32 v198, v99, s36, v192
    v_exp_f32 v202, v198
    s_nop 0
    v_add_f32 v196, v196, v202
    v_cvt_pk_bf16_f32 v169, v201, v202
    v_fma_f32 v198, v100, s36, v192
    v_exp_f32 v201, v198
    s_nop 0
    v_add_f32 v196, v196, v201
    v_fma_f32 v198, v101, s36, v192
    v_exp_f32 v202, v198
    s_nop 0
    v_add_f32 v196, v196, v202
    v_cvt_pk_bf16_f32 v170, v201, v202
    v_fma_f32 v198, v102, s36, v192
    v_exp_f32 v201, v198
    s_nop 0
    v_add_f32 v196, v196, v201
    v_fma_f32 v198, v103, s36, v192
    v_exp_f32 v202, v198
    s_nop 0
    v_add_f32 v196, v196, v202
    v_cvt_pk_bf16_f32 v171, v201, v202
    v_fma_f32 v198, v104, s36, v192
    v_exp_f32 v201, v198
    s_nop 0
    v_add_f32 v196, v196, v201
    v_fma_f32 v198, v105, s36, v192
    v_exp_f32 v202, v198
    s_nop 0
    v_add_f32 v196, v196, v202
    v_cvt_pk_bf16_f32 v172, v201, v202
    v_fma_f32 v198, v106, s36, v192
    v_exp_f32 v201, v198
    s_nop 0
    v_add_f32 v196, v196, v201
    v_fma_f32 v198, v107, s36, v192
    v_exp_f32 v202, v198
    s_nop 0
    v_add_f32 v196, v196, v202
    v_cvt_pk_bf16_f32 v173, v201, v202
    v_fma_f32 v198, v108, s36, v192
    v_exp_f32 v201, v198
    s_nop 0
    v_add_f32 v196, v196, v201
    v_fma_f32 v198, v109, s36, v192
    v_exp_f32 v202, v198
    s_nop 0
    v_add_f32 v196, v196, v202
    v_cvt_pk_bf16_f32 v174, v201, v202
    v_fma_f32 v198, v110, s36, v192
    v_exp_f32 v201, v198
    s_nop 0
    v_add_f32 v196, v196, v201
    v_fma_f32 v198, v111, s36, v192
    v_exp_f32 v202, v198
    s_nop 0
    v_add_f32 v196, v196, v202
    v_cvt_pk_bf16_f32 v175, v201, v202
    v_add_f32 v194, v194, v196
    v_mov_b32 v196, 0
    v_max3_f32 v252, v80, v81, v82
    v_max3_f32 v252, v252, v83, v84
    v_max3_f32 v252, v252, v85, v86
    v_max3_f32 v252, v252, v87, v88
    v_max3_f32 v252, v252, v89, v90
    v_max3_f32 v252, v252, v91, v92
    v_max3_f32 v252, v252, v93, v94
    v_max3_f32 v252, v252, v95, v112
    v_max3_f32 v252, v252, v113, v114
    v_max3_f32 v252, v252, v115, v116
    v_max3_f32 v252, v252, v117, v118
    v_max3_f32 v252, v252, v119, v120
    v_max3_f32 v252, v252, v121, v122
    v_max3_f32 v252, v252, v123, v124
    v_max3_f32 v252, v252, v125, v126
    v_max_f32 v252, v252, v127
    v_mov_b32 v253, v252
    s_nop 1
    v_permlane32_swap_b32 v252, v253
    v_max_f32 v252, v252, v253
    v_mul_f32 v252, s36, v252
    v_max_f32 v253, v252, -v193
    v_add_f32 v254, v193, v253
    v_exp_f32 v254, -v254
    v_sub_f32 v193, 0, v253
    v_mul_f32 v195, v195, v254
    v_accvgpr_read_b32 v253, a64
    v_mul_f32 v253, v253, v254
    v_accvgpr_write_b32 a64, v253
    v_accvgpr_read_b32 v255, a65
    v_mul_f32 v255, v255, v254
    v_accvgpr_write_b32 a65, v255
    v_accvgpr_read_b32 v253, a66
    v_mul_f32 v253, v253, v254
    v_accvgpr_write_b32 a66, v253
    v_accvgpr_read_b32 v255, a67
    v_mul_f32 v255, v255, v254
    v_accvgpr_write_b32 a67, v255
    v_accvgpr_read_b32 v253, a68
    v_mul_f32 v253, v253, v254
    v_accvgpr_write_b32 a68, v253
    v_accvgpr_read_b32 v255, a69
    v_mul_f32 v255, v255, v254
    v_accvgpr_write_b32 a69, v255
    v_accvgpr_read_b32 v253, a70
    v_mul_f32 v253, v253, v254
    v_accvgpr_write_b32 a70, v253
    v_accvgpr_read_b32 v255, a71
    v_mul_f32 v255, v255, v254
    v_accvgpr_write_b32 a71, v255
    v_accvgpr_read_b32 v253, a72
    v_mul_f32 v253, v253, v254
    v_accvgpr_write_b32 a72, v253
    v_accvgpr_read_b32 v255, a73
    v_mul_f32 v255, v255, v254
    v_accvgpr_write_b32 a73, v255
    v_accvgpr_read_b32 v253, a74
    v_mul_f32 v253, v253, v254
    v_accvgpr_write_b32 a74, v253
    v_accvgpr_read_b32 v255, a75
    v_mul_f32 v255, v255, v254
    v_accvgpr_write_b32 a75, v255
    v_accvgpr_read_b32 v253, a76
    v_mul_f32 v253, v253, v254
    v_accvgpr_write_b32 a76, v253
    v_accvgpr_read_b32 v255, a77
    v_mul_f32 v255, v255, v254
    v_accvgpr_write_b32 a77, v255
    v_accvgpr_read_b32 v253, a78
    v_mul_f32 v253, v253, v254
    v_accvgpr_write_b32 a78, v253
    v_accvgpr_read_b32 v255, a79
    v_mul_f32 v255, v255, v254
    v_accvgpr_write_b32 a79, v255
    v_accvgpr_read_b32 v253, a80
    v_mul_f32 v253, v253, v254
    v_accvgpr_write_b32 a80, v253
    v_accvgpr_read_b32 v255, a81
    v_mul_f32 v255, v255, v254
    v_accvgpr_write_b32 a81, v255
    v_accvgpr_read_b32 v253, a82
    v_mul_f32 v253, v253, v254
    v_accvgpr_write_b32 a82, v253
    v_accvgpr_read_b32 v255, a83
    v_mul_f32 v255, v255, v254
    v_accvgpr_write_b32 a83, v255
    v_accvgpr_read_b32 v253, a84
    v_mul_f32 v253, v253, v254
    v_accvgpr_write_b32 a84, v253
    v_accvgpr_read_b32 v255, a85
    v_mul_f32 v255, v255, v254
    v_accvgpr_write_b32 a85, v255
    v_accvgpr_read_b32 v253, a86
    v_mul_f32 v253, v253, v254
    v_accvgpr_write_b32 a86, v253
    v_accvgpr_read_b32 v255, a87
    v_mul_f32 v255, v255, v254
    v_accvgpr_write_b32 a87, v255
    v_accvgpr_read_b32 v253, a88
    v_mul_f32 v253, v253, v254
    v_accvgpr_write_b32 a88, v253
    v_accvgpr_read_b32 v255, a89
    v_mul_f32 v255, v255, v254
    v_accvgpr_write_b32 a89, v255
    v_accvgpr_read_b32 v253, a90
    v_mul_f32 v253, v253, v254
    v_accvgpr_write_b32 a90, v253
    v_accvgpr_read_b32 v255, a91
    v_mul_f32 v255, v255, v254
    v_accvgpr_write_b32 a91, v255
    v_accvgpr_read_b32 v253, a92
    v_mul_f32 v253, v253, v254
    v_accvgpr_write_b32 a92, v253
    v_accvgpr_read_b32 v255, a93
    v_mul_f32 v255, v255, v254
    v_accvgpr_write_b32 a93, v255
    v_accvgpr_read_b32 v253, a94
    v_mul_f32 v253, v253, v254
    v_accvgpr_write_b32 a94, v253
    v_accvgpr_read_b32 v255, a95
    v_mul_f32 v255, v255, v254
    v_accvgpr_write_b32 a95, v255
    v_accvgpr_read_b32 v253, a96
    v_mul_f32 v253, v253, v254
    v_accvgpr_write_b32 a96, v253
    v_accvgpr_read_b32 v255, a97
    v_mul_f32 v255, v255, v254
    v_accvgpr_write_b32 a97, v255
    v_accvgpr_read_b32 v253, a98
    v_mul_f32 v253, v253, v254
    v_accvgpr_write_b32 a98, v253
    v_accvgpr_read_b32 v255, a99
    v_mul_f32 v255, v255, v254
    v_accvgpr_write_b32 a99, v255
    v_accvgpr_read_b32 v253, a100
    v_mul_f32 v253, v253, v254
    v_accvgpr_write_b32 a100, v253
    v_accvgpr_read_b32 v255, a101
    v_mul_f32 v255, v255, v254
    v_accvgpr_write_b32 a101, v255
    v_accvgpr_read_b32 v253, a102
    v_mul_f32 v253, v253, v254
    v_accvgpr_write_b32 a102, v253
    v_accvgpr_read_b32 v255, a103
    v_mul_f32 v255, v255, v254
    v_accvgpr_write_b32 a103, v255
    v_accvgpr_read_b32 v253, a104
    v_mul_f32 v253, v253, v254
    v_accvgpr_write_b32 a104, v253
    v_accvgpr_read_b32 v255, a105
    v_mul_f32 v255, v255, v254
    v_accvgpr_write_b32 a105, v255
    v_accvgpr_read_b32 v253, a106
    v_mul_f32 v253, v253, v254
    v_accvgpr_write_b32 a106, v253
    v_accvgpr_read_b32 v255, a107
    v_mul_f32 v255, v255, v254
    v_accvgpr_write_b32 a107, v255
    v_accvgpr_read_b32 v253, a108
    v_mul_f32 v253, v253, v254
    v_accvgpr_write_b32 a108, v253
    v_accvgpr_read_b32 v255, a109
    v_mul_f32 v255, v255, v254
    v_accvgpr_write_b32 a109, v255
    v_accvgpr_read_b32 v253, a110
    v_mul_f32 v253, v253, v254
    v_accvgpr_write_b32 a110, v253
    v_accvgpr_read_b32 v255, a111
    v_mul_f32 v255, v255, v254
    v_accvgpr_write_b32 a111, v255
    v_accvgpr_read_b32 v253, a112
    v_mul_f32 v253, v253, v254
    v_accvgpr_write_b32 a112, v253
    v_accvgpr_read_b32 v255, a113
    v_mul_f32 v255, v255, v254
    v_accvgpr_write_b32 a113, v255
    v_accvgpr_read_b32 v253, a114
    v_mul_f32 v253, v253, v254
    v_accvgpr_write_b32 a114, v253
    v_accvgpr_read_b32 v255, a115
    v_mul_f32 v255, v255, v254
    v_accvgpr_write_b32 a115, v255
    v_accvgpr_read_b32 v253, a116
    v_mul_f32 v253, v253, v254
    v_accvgpr_write_b32 a116, v253
    v_accvgpr_read_b32 v255, a117
    v_mul_f32 v255, v255, v254
    v_accvgpr_write_b32 a117, v255
    v_accvgpr_read_b32 v253, a118
    v_mul_f32 v253, v253, v254
    v_accvgpr_write_b32 a118, v253
    v_accvgpr_read_b32 v255, a119
    v_mul_f32 v255, v255, v254
    v_accvgpr_write_b32 a119, v255
    v_accvgpr_read_b32 v253, a120
    v_mul_f32 v253, v253, v254
    v_accvgpr_write_b32 a120, v253
    v_accvgpr_read_b32 v255, a121
    v_mul_f32 v255, v255, v254
    v_accvgpr_write_b32 a121, v255
    v_accvgpr_read_b32 v253, a122
    v_mul_f32 v253, v253, v254
    v_accvgpr_write_b32 a122, v253
    v_accvgpr_read_b32 v255, a123
    v_mul_f32 v255, v255, v254
    v_accvgpr_write_b32 a123, v255
    v_accvgpr_read_b32 v253, a124
    v_mul_f32 v253, v253, v254
    v_accvgpr_write_b32 a124, v253
    v_accvgpr_read_b32 v255, a125
    v_mul_f32 v255, v255, v254
    v_accvgpr_write_b32 a125, v255
    v_accvgpr_read_b32 v253, a126
    v_mul_f32 v253, v253, v254
    v_accvgpr_write_b32 a126, v253
    v_accvgpr_read_b32 v255, a127
    v_mul_f32 v255, v255, v254
    v_accvgpr_write_b32 a127, v255
    v_mov_b32 v197, 0
    v_fma_f32 v198, v80, s36, v193
    v_exp_f32 v201, v198
    s_nop 0
    v_add_f32 v197, v197, v201
    v_fma_f32 v198, v81, s36, v193
    v_exp_f32 v202, v198
    s_nop 0
    v_add_f32 v197, v197, v202
    v_cvt_pk_bf16_f32 v176, v201, v202
    v_fma_f32 v198, v82, s36, v193
    v_exp_f32 v201, v198
    s_nop 0
    v_add_f32 v197, v197, v201
    v_fma_f32 v198, v83, s36, v193
    v_exp_f32 v202, v198
    s_nop 0
    v_add_f32 v197, v197, v202
    v_cvt_pk_bf16_f32 v177, v201, v202
    v_fma_f32 v198, v84, s36, v193
    v_exp_f32 v201, v198
    s_nop 0
    v_add_f32 v197, v197, v201
    v_fma_f32 v198, v85, s36, v193
    v_exp_f32 v202, v198
    s_nop 0
    v_add_f32 v197, v197, v202
    v_cvt_pk_bf16_f32 v178, v201, v202
    v_fma_f32 v198, v86, s36, v193
    v_exp_f32 v201, v198
    s_nop 0
    v_add_f32 v197, v197, v201
    v_fma_f32 v198, v87, s36, v193
    v_exp_f32 v202, v198
    s_nop 0
    v_add_f32 v197, v197, v202
    v_cvt_pk_bf16_f32 v179, v201, v202
    v_fma_f32 v198, v88, s36, v193
    v_exp_f32 v201, v198
    s_nop 0
    v_add_f32 v197, v197, v201
    v_fma_f32 v198, v89, s36, v193
    v_exp_f32 v202, v198
    s_nop 0
    v_add_f32 v197, v197, v202
    v_cvt_pk_bf16_f32 v180, v201, v202
    v_fma_f32 v198, v90, s36, v193
    v_exp_f32 v201, v198
    s_nop 0
    v_add_f32 v197, v197, v201
    v_fma_f32 v198, v91, s36, v193
    v_exp_f32 v202, v198
    s_nop 0
    v_add_f32 v197, v197, v202
    v_cvt_pk_bf16_f32 v181, v201, v202
    v_fma_f32 v198, v92, s36, v193
    v_exp_f32 v201, v198
    s_nop 0
    v_add_f32 v197, v197, v201
    v_fma_f32 v198, v93, s36, v193
    v_exp_f32 v202, v198
    s_nop 0
    v_add_f32 v197, v197, v202
    v_cvt_pk_bf16_f32 v182, v201, v202
    v_fma_f32 v198, v94, s36, v193
    v_exp_f32 v201, v198
    s_nop 0
    v_add_f32 v197, v197, v201
    v_fma_f32 v198, v95, s36, v193
    v_exp_f32 v202, v198
    s_nop 0
    v_add_f32 v197, v197, v202
    v_cvt_pk_bf16_f32 v183, v201, v202
    v_fma_f32 v198, v112, s36, v193
    v_exp_f32 v201, v198
    s_nop 0
    v_add_f32 v197, v197, v201
    v_fma_f32 v198, v113, s36, v193
    v_exp_f32 v202, v198
    s_nop 0
    v_add_f32 v197, v197, v202
    v_cvt_pk_bf16_f32 v184, v201, v202
    v_fma_f32 v198, v114, s36, v193
    v_exp_f32 v201, v198
    s_nop 0
    v_add_f32 v197, v197, v201
    v_fma_f32 v198, v115, s36, v193
    v_exp_f32 v202, v198
    s_nop 0
    v_add_f32 v197, v197, v202
    v_cvt_pk_bf16_f32 v185, v201, v202
    v_fma_f32 v198, v116, s36, v193
    v_exp_f32 v201, v198
    s_nop 0
    v_add_f32 v197, v197, v201
    v_fma_f32 v198, v117, s36, v193
    v_exp_f32 v202, v198
    s_nop 0
    v_add_f32 v197, v197, v202
    v_cvt_pk_bf16_f32 v186, v201, v202
    v_fma_f32 v198, v118, s36, v193
    v_exp_f32 v201, v198
    s_nop 0
    v_add_f32 v197, v197, v201
    v_fma_f32 v198, v119, s36, v193
    v_exp_f32 v202, v198
    s_nop 0
    v_add_f32 v197, v197, v202
    v_cvt_pk_bf16_f32 v187, v201, v202
    v_fma_f32 v198, v120, s36, v193
    v_exp_f32 v201, v198
    s_nop 0
    v_add_f32 v197, v197, v201
    v_fma_f32 v198, v121, s36, v193
    v_exp_f32 v202, v198
    s_nop 0
    v_add_f32 v197, v197, v202
    v_cvt_pk_bf16_f32 v188, v201, v202
    v_fma_f32 v198, v122, s36, v193
    v_exp_f32 v201, v198
    s_nop 0
    v_add_f32 v197, v197, v201
    v_fma_f32 v198, v123, s36, v193
    v_exp_f32 v202, v198
    s_nop 0
    v_add_f32 v197, v197, v202
    v_cvt_pk_bf16_f32 v189, v201, v202
    v_fma_f32 v198, v124, s36, v193
    v_exp_f32 v201, v198
    s_nop 0
    v_add_f32 v197, v197, v201
    v_fma_f32 v198, v125, s36, v193
    v_exp_f32 v202, v198
    s_nop 0
    v_add_f32 v197, v197, v202
    v_cvt_pk_bf16_f32 v190, v201, v202
    v_fma_f32 v198, v126, s36, v193
    v_exp_f32 v201, v198
    s_nop 0
    v_add_f32 v197, v197, v201
    v_fma_f32 v198, v127, s36, v193
    v_exp_f32 v202, v198
    s_nop 0
    v_add_f32 v197, v197, v202
    v_cvt_pk_bf16_f32 v191, v201, v202
    v_add_f32 v195, v195, v197
    v_mov_b32 v197, 0
    s_nop 3
    s_branch BACK_X31
RARE_E0:
    s_nop 7
    v_max3_f32 v252, v0, v1, v2
    v_max3_f32 v252, v252, v3, v4
    v_max3_f32 v252, v252, v5, v6
    v_max3_f32 v252, v252, v7, v8
    v_max3_f32 v252, v252, v9, v10
    v_max3_f32 v252, v252, v11, v12
    v_max3_f32 v252, v252, v13, v14
    v_max3_f32 v252, v252, v15, v32
    v_max3_f32 v252, v252, v33, v34
    v_max3_f32 v252, v252, v35, v36
    v_max3_f32 v252, v252, v37, v38
    v_max3_f32 v252, v252, v39, v40
    v_max3_f32 v252, v252, v41, v42
    v_max3_f32 v252, v252, v43, v44
    v_max3_f32 v252, v252, v45, v46
    v_max_f32 v252, v252, v47
    v_mov_b32 v253, v252
    s_nop 1
    v_permlane32_swap_b32 v252, v253
    v_max_f32 v252, v252, v253
    v_mul_f32 v252, s36, v252
    v_max_f32 v253, v252, -v192
    v_add_f32 v254, v192, v253
    v_exp_f32 v254, -v254
    v_sub_f32 v192, 0, v253
    v_mul_f32 v194, v194, v254
    v_accvgpr_read_b32 v253, a0
    v_mul_f32 v253, v253, v254
    v_accvgpr_write_b32 a0, v253
    v_accvgpr_read_b32 v255, a1
    v_mul_f32 v255, v255, v254
    v_accvgpr_write_b32 a1, v255
    v_accvgpr_read_b32 v253, a2
    v_mul_f32 v253, v253, v254
    v_accvgpr_write_b32 a2, v253
    v_accvgpr_read_b32 v255, a3
    v_mul_f32 v255, v255, v254
    v_accvgpr_write_b32 a3, v255
    v_accvgpr_read_b32 v253, a4
    v_mul_f32 v253, v253, v254
    v_accvgpr_write_b32 a4, v253
    v_accvgpr_read_b32 v255, a5
    v_mul_f32 v255, v255, v254
    v_accvgpr_write_b32 a5, v255
    v_accvgpr_read_b32 v253, a6
    v_mul_f32 v253, v253, v254
    v_accvgpr_write_b32 a6, v253
    v_accvgpr_read_b32 v255, a7
    v_mul_f32 v255, v255, v254
    v_accvgpr_write_b32 a7, v255
    v_accvgpr_read_b32 v253, a8
    v_mul_f32 v253, v253, v254
    v_accvgpr_write_b32 a8, v253
    v_accvgpr_read_b32 v255, a9
    v_mul_f32 v255, v255, v254
    v_accvgpr_write_b32 a9, v255
    v_accvgpr_read_b32 v253, a10
    v_mul_f32 v253, v253, v254
    v_accvgpr_write_b32 a10, v253
    v_accvgpr_read_b32 v255, a11
    v_mul_f32 v255, v255, v254
    v_accvgpr_write_b32 a11, v255
    v_accvgpr_read_b32 v253, a12
    v_mul_f32 v253, v253, v254
    v_accvgpr_write_b32 a12, v253
    v_accvgpr_read_b32 v255, a13
    v_mul_f32 v255, v255, v254
    v_accvgpr_write_b32 a13, v255
    v_accvgpr_read_b32 v253, a14
    v_mul_f32 v253, v253, v254
    v_accvgpr_write_b32 a14, v253
    v_accvgpr_read_b32 v255, a15
    v_mul_f32 v255, v255, v254
    v_accvgpr_write_b32 a15, v255
    v_accvgpr_read_b32 v253, a16
    v_mul_f32 v253, v253, v254
    v_accvgpr_write_b32 a16, v253
    v_accvgpr_read_b32 v255, a17
    v_mul_f32 v255, v255, v254
    v_accvgpr_write_b32 a17, v255
    v_accvgpr_read_b32 v253, a18
    v_mul_f32 v253, v253, v254
    v_accvgpr_write_b32 a18, v253
    v_accvgpr_read_b32 v255, a19
    v_mul_f32 v255, v255, v254
    v_accvgpr_write_b32 a19, v255
    v_accvgpr_read_b32 v253, a20
    v_mul_f32 v253, v253, v254
    v_accvgpr_write_b32 a20, v253
    v_accvgpr_read_b32 v255, a21
    v_mul_f32 v255, v255, v254
    v_accvgpr_write_b32 a21, v255
    v_accvgpr_read_b32 v253, a22
    v_mul_f32 v253, v253, v254
    v_accvgpr_write_b32 a22, v253
    v_accvgpr_read_b32 v255, a23
    v_mul_f32 v255, v255, v254
    v_accvgpr_write_b32 a23, v255
    v_accvgpr_read_b32 v253, a24
    v_mul_f32 v253, v253, v254
    v_accvgpr_write_b32 a24, v253
    v_accvgpr_read_b32 v255, a25
    v_mul_f32 v255, v255, v254
    v_accvgpr_write_b32 a25, v255
    v_accvgpr_read_b32 v253, a26
    v_mul_f32 v253, v253, v254
    v_accvgpr_write_b32 a26, v253
    v_accvgpr_read_b32 v255, a27
    v_mul_f32 v255, v255, v254
    v_accvgpr_write_b32 a27, v255
    v_accvgpr_read_b32 v253, a28
    v_mul_f32 v253, v253, v254
    v_accvgpr_write_b32 a28, v253
    v_accvgpr_read_b32 v255, a29
    v_mul_f32 v255, v255, v254
    v_accvgpr_write_b32 a29, v255
    v_accvgpr_read_b32 v253, a30
    v_mul_f32 v253, v253, v254
    v_accvgpr_write_b32 a30, v253
    v_accvgpr_read_b32 v255, a31
    v_mul_f32 v255, v255, v254
    v_accvgpr_write_b32 a31, v255
    v_accvgpr_read_b32 v253, a32
    v_mul_f32 v253, v253, v254
    v_accvgpr_write_b32 a32, v253
    v_accvgpr_read_b32 v255, a33
    v_mul_f32 v255, v255, v254
    v_accvgpr_write_b32 a33, v255
    v_accvgpr_read_b32 v253, a34
    v_mul_f32 v253, v253, v254
    v_accvgpr_write_b32 a34, v253
    v_accvgpr_read_b32 v255, a35
    v_mul_f32 v255, v255, v254
    v_accvgpr_write_b32 a35, v255
    v_accvgpr_read_b32 v253, a36
    v_mul_f32 v253, v253, v254
    v_accvgpr_write_b32 a36, v253
    v_accvgpr_read_b32 v255, a37
    v_mul_f32 v255, v255, v254
    v_accvgpr_write_b32 a37, v255
    v_accvgpr_read_b32 v253, a38
    v_mul_f32 v253, v253, v254
    v_accvgpr_write_b32 a38, v253
    v_accvgpr_read_b32 v255, a39
    v_mul_f32 v255, v255, v254
    v_accvgpr_write_b32 a39, v255
    v_accvgpr_read_b32 v253, a40
    v_mul_f32 v253, v253, v254
    v_accvgpr_write_b32 a40, v253
    v_accvgpr_read_b32 v255, a41
    v_mul_f32 v255, v255, v254
    v_accvgpr_write_b32 a41, v255
    v_accvgpr_read_b32 v253, a42
    v_mul_f32 v253, v253, v254
    v_accvgpr_write_b32 a42, v253
    v_accvgpr_read_b32 v255, a43
    v_mul_f32 v255, v255, v254
    v_accvgpr_write_b32 a43, v255
    v_accvgpr_read_b32 v253, a44
    v_mul_f32 v253, v253, v254
    v_accvgpr_write_b32 a44, v253
    v_accvgpr_read_b32 v255, a45
    v_mul_f32 v255, v255, v254
    v_accvgpr_write_b32 a45, v255
    v_accvgpr_read_b32 v253, a46
    v_mul_f32 v253, v253, v254
    v_accvgpr_write_b32 a46, v253
    v_accvgpr_read_b32 v255, a47
    v_mul_f32 v255, v255, v254
    v_accvgpr_write_b32 a47, v255
    v_accvgpr_read_b32 v253, a48
    v_mul_f32 v253, v253, v254
    v_accvgpr_write_b32 a48, v253
    v_accvgpr_read_b32 v255, a49
    v_mul_f32 v255, v255, v254
    v_accvgpr_write_b32 a49, v255
    v_accvgpr_read_b32 v253, a50
    v_mul_f32 v253, v253, v254
    v_accvgpr_write_b32 a50, v253
    v_accvgpr_read_b32 v255, a51
    v_mul_f32 v255, v255, v254
    v_accvgpr_write_b32 a51, v255
    v_accvgpr_read_b32 v253, a52
    v_mul_f32 v253, v253, v254
    v_accvgpr_write_b32 a52, v253
    v_accvgpr_read_b32 v255, a53
    v_mul_f32 v255, v255, v254
    v_accvgpr_write_b32 a53, v255
    v_accvgpr_read_b32 v253, a54
    v_mul_f32 v253, v253, v254
    v_accvgpr_write_b32 a54, v253
    v_accvgpr_read_b32 v255, a55
    v_mul_f32 v255, v255, v254
    v_accvgpr_write_b32 a55, v255
    v_accvgpr_read_b32 v253, a56
    v_mul_f32 v253, v253, v254
    v_accvgpr_write_b32 a56, v253
    v_accvgpr_read_b32 v255, a57
    v_mul_f32 v255, v255, v254
    v_accvgpr_write_b32 a57, v255
    v_accvgpr_read_b32 v253, a58
    v_mul_f32 v253, v253, v254
    v_accvgpr_write_b32 a58, v253
    v_accvgpr_read_b32 v255, a59
    v_mul_f32 v255, v255, v254
    v_accvgpr_write_b32 a59, v255
    v_accvgpr_read_b32 v253, a60
    v_mul_f32 v253, v253, v254
    v_accvgpr_write_b32 a60, v253
    v_accvgpr_read_b32 v255, a61
    v_mul_f32 v255, v255, v254
    v_accvgpr_write_b32 a61, v255
    v_accvgpr_read_b32 v253, a62
    v_mul_f32 v253, v253, v254
    v_accvgpr_write_b32 a62, v253
    v_accvgpr_read_b32 v255, a63
    v_mul_f32 v255, v255, v254
    v_accvgpr_write_b32 a63, v255
    v_mov_b32 v196, 0
    v_fma_f32 v198, v0, s36, v192
    v_exp_f32 v201, v198
    s_nop 0
    v_add_f32 v196, v196, v201
    v_fma_f32 v198, v1, s36, v192
    v_exp_f32 v202, v198
    s_nop 0
    v_add_f32 v196, v196, v202
    v_cvt_pk_bf16_f32 v128, v201, v202
    v_fma_f32 v198, v2, s36, v192
    v_exp_f32 v201, v198
    s_nop 0
    v_add_f32 v196, v196, v201
    v_fma_f32 v198, v3, s36, v192
    v_exp_f32 v202, v198
    s_nop 0
    v_add_f32 v196, v196, v202
    v_cvt_pk_bf16_f32 v129, v201, v202
    v_fma_f32 v198, v4, s36, v192
    v_exp_f32 v201, v198
    s_nop 0
    v_add_f32 v196, v196, v201
    v_fma_f32 v198, v5, s36, v192
    v_exp_f32 v202, v198
    s_nop 0
    v_add_f32 v196, v196, v202
    v_cvt_pk_bf16_f32 v130, v201, v202
    v_fma_f32 v198, v6, s36, v192
    v_exp_f32 v201, v198
    s_nop 0
    v_add_f32 v196, v196, v201
    v_fma_f32 v198, v7, s36, v192
    v_exp_f32 v202, v198
    s_nop 0
    v_add_f32 v196, v196, v202
    v_cvt_pk_bf16_f32 v131, v201, v202
    v_fma_f32 v198, v8, s36, v192
    v_exp_f32 v201, v198
    s_nop 0
    v_add_f32 v196, v196, v201
    v_fma_f32 v198, v9, s36, v192
    v_exp_f32 v202, v198
    s_nop 0
    v_add_f32 v196, v196, v202
    v_cvt_pk_bf16_f32 v132, v201, v202
    v_fma_f32 v198, v10, s36, v192
    v_exp_f32 v201, v198
    s_nop 0
    v_add_f32 v196, v196, v201
    v_fma_f32 v198, v11, s36, v192
    v_exp_f32 v202, v198
    s_nop 0
    v_add_f32 v196, v196, v202
    v_cvt_pk_bf16_f32 v133, v201, v202
    v_fma_f32 v198, v12, s36, v192
    v_exp_f32 v201, v198
    s_nop 0
    v_add_f32 v196, v196, v201
    v_fma_f32 v198, v13, s36, v192
    v_exp_f32 v202, v198
    s_nop 0
    v_add_f32 v196, v196, v202
    v_cvt_pk_bf16_f32 v134, v201, v202
    v_fma_f32 v198, v14, s36, v192
    v_exp_f32 v201, v198
    s_nop 0
    v_add_f32 v196, v196, v201
    v_fma_f32 v198, v15, s36, v192
    v_exp_f32 v202, v198
    s_nop 0
    v_add_f32 v196, v196, v202
    v_cvt_pk_bf16_f32 v135, v201, v202
    v_fma_f32 v198, v32, s36, v192
    v_exp_f32 v201, v198
    s_nop 0
    v_add_f32 v196, v196, v201
    v_fma_f32 v198, v33, s36, v192
    v_exp_f32 v202, v198
    s_nop 0
    v_add_f32 v196, v196, v202
    v_cvt_pk_bf16_f32 v136, v201, v202
    v_fma_f32 v198, v34, s36, v192
    v_exp_f32 v201, v198
    s_nop 0
    v_add_f32 v196, v196, v201
    v_fma_f32 v198, v35, s36, v192
    v_exp_f32 v202, v198
    s_nop 0
    v_add_f32 v196, v196, v202
    v_cvt_pk_bf16_f32 v137, v201, v202
    v_fma_f32 v198, v36, s36, v192
    v_exp_f32 v201, v198
    s_nop 0
    v_add_f32 v196, v196, v201
    v_fma_f32 v198, v37, s36, v192
    v_exp_f32 v202, v198
    s_nop 0
    v_add_f32 v196, v196, v202
    v_cvt_pk_bf16_f32 v138, v201, v202
    v_fma_f32 v198, v38, s36, v192
    v_exp_f32 v201, v198
    s_nop 0
    v_add_f32 v196, v196, v201
    v_fma_f32 v198, v39, s36, v192
    v_exp_f32 v202, v198
    s_nop 0
    v_add_f32 v196, v196, v202
    v_cvt_pk_bf16_f32 v139, v201, v202
    v_fma_f32 v198, v40, s36, v192
    v_exp_f32 v201, v198
    s_nop 0
    v_add_f32 v196, v196, v201
    v_fma_f32 v198, v41, s36, v192
    v_exp_f32 v202, v198
    s_nop 0
    v_add_f32 v196, v196, v202
    v_cvt_pk_bf16_f32 v140, v201, v202
    v_fma_f32 v198, v42, s36, v192
    v_exp_f32 v201, v198
    s_nop 0
    v_add_f32 v196, v196, v201
    v_fma_f32 v198, v43, s36, v192
    v_exp_f32 v202, v198
    s_nop 0
    v_add_f32 v196, v196, v202
    v_cvt_pk_bf16_f32 v141, v201, v202
    v_fma_f32 v198, v44, s36, v192
    v_exp_f32 v201, v198
    s_nop 0
    v_add_f32 v196, v196, v201
    v_fma_f32 v198, v45, s36, v192
    v_exp_f32 v202, v198
    s_nop 0
    v_add_f32 v196, v196, v202
    v_cvt_pk_bf16_f32 v142, v201, v202
    v_fma_f32 v198, v46, s36, v192
    v_exp_f32 v201, v198
    s_nop 0
    v_add_f32 v196, v196, v201
    v_fma_f32 v198, v47, s36, v192
    v_exp_f32 v202, v198
    s_nop 0
    v_add_f32 v196, v196, v202
    v_cvt_pk_bf16_f32 v143, v201, v202
    v_add_f32 v194, v194, v196
    v_mov_b32 v196, 0
    v_max3_f32 v252, v16, v17, v18
    v_max3_f32 v252, v252, v19, v20
    v_max3_f32 v252, v252, v21, v22
    v_max3_f32 v252, v252, v23, v24
    v_max3_f32 v252, v252, v25, v26
    v_max3_f32 v252, v252, v27, v28
    v_max3_f32 v252, v252, v29, v30
    v_max3_f32 v252, v252, v31, v48
    v_max3_f32 v252, v252, v49, v50
    v_max3_f32 v252, v252, v51, v52
    v_max3_f32 v252, v252, v53, v54
    v_max3_f32 v252, v252, v55, v56
    v_max3_f32 v252, v252, v57, v58
    v_max3_f32 v252, v252, v59, v60
    v_max3_f32 v252, v252, v61, v62
    v_max_f32 v252, v252, v63
    v_mov_b32 v253, v252
    s_nop 1
    v_permlane32_swap_b32 v252, v253
    v_max_f32 v252, v252, v253
    v_mul_f32 v252, s36, v252
    v_max_f32 v253, v252, -v193
    v_add_f32 v254, v193, v253
    v_exp_f32 v254, -v254
    v_sub_f32 v193, 0, v253
    v_mul_f32 v195, v195, v254
    v_accvgpr_read_b32 v253, a64
    v_mul_f32 v253, v253, v254
    v_accvgpr_write_b32 a64, v253
    v_accvgpr_read_b32 v255, a65
    v_mul_f32 v255, v255, v254
    v_accvgpr_write_b32 a65, v255
    v_accvgpr_read_b32 v253, a66
    v_mul_f32 v253, v253, v254
    v_accvgpr_write_b32 a66, v253
    v_accvgpr_read_b32 v255, a67
    v_mul_f32 v255, v255, v254
    v_accvgpr_write_b32 a67, v255
    v_accvgpr_read_b32 v253, a68
    v_mul_f32 v253, v253, v254
    v_accvgpr_write_b32 a68, v253
    v_accvgpr_read_b32 v255, a69
    v_mul_f32 v255, v255, v254
    v_accvgpr_write_b32 a69, v255
    v_accvgpr_read_b32 v253, a70
    v_mul_f32 v253, v253, v254
    v_accvgpr_write_b32 a70, v253
    v_accvgpr_read_b32 v255, a71
    v_mul_f32 v255, v255, v254
    v_accvgpr_write_b32 a71, v255
    v_accvgpr_read_b32 v253, a72
    v_mul_f32 v253, v253, v254
    v_accvgpr_write_b32 a72, v253
    v_accvgpr_read_b32 v255, a73
    v_mul_f32 v255, v255, v254
    v_accvgpr_write_b32 a73, v255
    v_accvgpr_read_b32 v253, a74
    v_mul_f32 v253, v253, v254
    v_accvgpr_write_b32 a74, v253
    v_accvgpr_read_b32 v255, a75
    v_mul_f32 v255, v255, v254
    v_accvgpr_write_b32 a75, v255
    v_accvgpr_read_b32 v253, a76
    v_mul_f32 v253, v253, v254
    v_accvgpr_write_b32 a76, v253
    v_accvgpr_read_b32 v255, a77
    v_mul_f32 v255, v255, v254
    v_accvgpr_write_b32 a77, v255
    v_accvgpr_read_b32 v253, a78
    v_mul_f32 v253, v253, v254
    v_accvgpr_write_b32 a78, v253
    v_accvgpr_read_b32 v255, a79
    v_mul_f32 v255, v255, v254
    v_accvgpr_write_b32 a79, v255
    v_accvgpr_read_b32 v253, a80
    v_mul_f32 v253, v253, v254
    v_accvgpr_write_b32 a80, v253
    v_accvgpr_read_b32 v255, a81
    v_mul_f32 v255, v255, v254
    v_accvgpr_write_b32 a81, v255
    v_accvgpr_read_b32 v253, a82
    v_mul_f32 v253, v253, v254
    v_accvgpr_write_b32 a82, v253
    v_accvgpr_read_b32 v255, a83
    v_mul_f32 v255, v255, v254
    v_accvgpr_write_b32 a83, v255
    v_accvgpr_read_b32 v253, a84
    v_mul_f32 v253, v253, v254
    v_accvgpr_write_b32 a84, v253
    v_accvgpr_read_b32 v255, a85
    v_mul_f32 v255, v255, v254
    v_accvgpr_write_b32 a85, v255
    v_accvgpr_read_b32 v253, a86
    v_mul_f32 v253, v253, v254
    v_accvgpr_write_b32 a86, v253
    v_accvgpr_read_b32 v255, a87
    v_mul_f32 v255, v255, v254
    v_accvgpr_write_b32 a87, v255
    v_accvgpr_read_b32 v253, a88
    v_mul_f32 v253, v253, v254
    v_accvgpr_write_b32 a88, v253
    v_accvgpr_read_b32 v255, a89
    v_mul_f32 v255, v255, v254
    v_accvgpr_write_b32 a89, v255
    v_accvgpr_read_b32 v253, a90
    v_mul_f32 v253, v253, v254
    v_accvgpr_write_b32 a90, v253
    v_accvgpr_read_b32 v255, a91
    v_mul_f32 v255, v255, v254
    v_accvgpr_write_b32 a91, v255
    v_accvgpr_read_b32 v253, a92
    v_mul_f32 v253, v253, v254
    v_accvgpr_write_b32 a92, v253
    v_accvgpr_read_b32 v255, a93
    v_mul_f32 v255, v255, v254
    v_accvgpr_write_b32 a93, v255
    v_accvgpr_read_b32 v253, a94
    v_mul_f32 v253, v253, v254
    v_accvgpr_write_b32 a94, v253
    v_accvgpr_read_b32 v255, a95
    v_mul_f32 v255, v255, v254
    v_accvgpr_write_b32 a95, v255
    v_accvgpr_read_b32 v253, a96
    v_mul_f32 v253, v253, v254
    v_accvgpr_write_b32 a96, v253
    v_accvgpr_read_b32 v255, a97
    v_mul_f32 v255, v255, v254
    v_accvgpr_write_b32 a97, v255
    v_accvgpr_read_b32 v253, a98
    v_mul_f32 v253, v253, v254
    v_accvgpr_write_b32 a98, v253
    v_accvgpr_read_b32 v255, a99
    v_mul_f32 v255, v255, v254
    v_accvgpr_write_b32 a99, v255
    v_accvgpr_read_b32 v253, a100
    v_mul_f32 v253, v253, v254
    v_accvgpr_write_b32 a100, v253
    v_accvgpr_read_b32 v255, a101
    v_mul_f32 v255, v255, v254
    v_accvgpr_write_b32 a101, v255
    v_accvgpr_read_b32 v253, a102
    v_mul_f32 v253, v253, v254
    v_accvgpr_write_b32 a102, v253
    v_accvgpr_read_b32 v255, a103
    v_mul_f32 v255, v255, v254
    v_accvgpr_write_b32 a103, v255
    v_accvgpr_read_b32 v253, a104
    v_mul_f32 v253, v253, v254
    v_accvgpr_write_b32 a104, v253
    v_accvgpr_read_b32 v255, a105
    v_mul_f32 v255, v255, v254
    v_accvgpr_write_b32 a105, v255
    v_accvgpr_read_b32 v253, a106
    v_mul_f32 v253, v253, v254
    v_accvgpr_write_b32 a106, v253
    v_accvgpr_read_b32 v255, a107
    v_mul_f32 v255, v255, v254
    v_accvgpr_write_b32 a107, v255
    v_accvgpr_read_b32 v253, a108
    v_mul_f32 v253, v253, v254
    v_accvgpr_write_b32 a108, v253
    v_accvgpr_read_b32 v255, a109
    v_mul_f32 v255, v255, v254
    v_accvgpr_write_b32 a109, v255
    v_accvgpr_read_b32 v253, a110
    v_mul_f32 v253, v253, v254
    v_accvgpr_write_b32 a110, v253
    v_accvgpr_read_b32 v255, a111
    v_mul_f32 v255, v255, v254
    v_accvgpr_write_b32 a111, v255
    v_accvgpr_read_b32 v253, a112
    v_mul_f32 v253, v253, v254
    v_accvgpr_write_b32 a112, v253
    v_accvgpr_read_b32 v255, a113
    v_mul_f32 v255, v255, v254
    v_accvgpr_write_b32 a113, v255
    v_accvgpr_read_b32 v253, a114
    v_mul_f32 v253, v253, v254
    v_accvgpr_write_b32 a114, v253
    v_accvgpr_read_b32 v255, a115
    v_mul_f32 v255, v255, v254
    v_accvgpr_write_b32 a115, v255
    v_accvgpr_read_b32 v253, a116
    v_mul_f32 v253, v253, v254
    v_accvgpr_write_b32 a116, v253
    v_accvgpr_read_b32 v255, a117
    v_mul_f32 v255, v255, v254
    v_accvgpr_write_b32 a117, v255
    v_accvgpr_read_b32 v253, a118
    v_mul_f32 v253, v253, v254
    v_accvgpr_write_b32 a118, v253
    v_accvgpr_read_b32 v255, a119
    v_mul_f32 v255, v255, v254
    v_accvgpr_write_b32 a119, v255
    v_accvgpr_read_b32 v253, a120
    v_mul_f32 v253, v253, v254
    v_accvgpr_write_b32 a120, v253
    v_accvgpr_read_b32 v255, a121
    v_mul_f32 v255, v255, v254
    v_accvgpr_write_b32 a121, v255
    v_accvgpr_read_b32 v253, a122
    v_mul_f32 v253, v253, v254
    v_accvgpr_write_b32 a122, v253
    v_accvgpr_read_b32 v255, a123
    v_mul_f32 v255, v255, v254
    v_accvgpr_write_b32 a123, v255
    v_accvgpr_read_b32 v253, a124
    v_mul_f32 v253, v253, v254
    v_accvgpr_write_b32 a124, v253
    v_accvgpr_read_b32 v255, a125
    v_mul_f32 v255, v255, v254
    v_accvgpr_write_b32 a125, v255
    v_accvgpr_read_b32 v253, a126
    v_mul_f32 v253, v253, v254
    v_accvgpr_write_b32 a126, v253
    v_accvgpr_read_b32 v255, a127
    v_mul_f32 v255, v255, v254
    v_accvgpr_write_b32 a127, v255
    v_mov_b32 v197, 0
    v_fma_f32 v198, v16, s36, v193
    v_exp_f32 v201, v198
    s_nop 0
    v_add_f32 v197, v197, v201
    v_fma_f32 v198, v17, s36, v193
    v_exp_f32 v202, v198
    s_nop 0
    v_add_f32 v197, v197, v202
    v_cvt_pk_bf16_f32 v144, v201, v202
    v_fma_f32 v198, v18, s36, v193
    v_exp_f32 v201, v198
    s_nop 0
    v_add_f32 v197, v197, v201
    v_fma_f32 v198, v19, s36, v193
    v_exp_f32 v202, v198
    s_nop 0
    v_add_f32 v197, v197, v202
    v_cvt_pk_bf16_f32 v145, v201, v202
    v_fma_f32 v198, v20, s36, v193
    v_exp_f32 v201, v198
    s_nop 0
    v_add_f32 v197, v197, v201
    v_fma_f32 v198, v21, s36, v193
    v_exp_f32 v202, v198
    s_nop 0
    v_add_f32 v197, v197, v202
    v_cvt_pk_bf16_f32 v146, v201, v202
    v_fma_f32 v198, v22, s36, v193
    v_exp_f32 v201, v198
    s_nop 0
    v_add_f32 v197, v197, v201
    v_fma_f32 v198, v23, s36, v193
    v_exp_f32 v202, v198
    s_nop 0
    v_add_f32 v197, v197, v202
    v_cvt_pk_bf16_f32 v147, v201, v202
    v_fma_f32 v198, v24, s36, v193
    v_exp_f32 v201, v198
    s_nop 0
    v_add_f32 v197, v197, v201
    v_fma_f32 v198, v25, s36, v193
    v_exp_f32 v202, v198
    s_nop 0
    v_add_f32 v197, v197, v202
    v_cvt_pk_bf16_f32 v148, v201, v202
    v_fma_f32 v198, v26, s36, v193
    v_exp_f32 v201, v198
    s_nop 0
    v_add_f32 v197, v197, v201
    v_fma_f32 v198, v27, s36, v193
    v_exp_f32 v202, v198
    s_nop 0
    v_add_f32 v197, v197, v202
    v_cvt_pk_bf16_f32 v149, v201, v202
    v_fma_f32 v198, v28, s36, v193
    v_exp_f32 v201, v198
    s_nop 0
    v_add_f32 v197, v197, v201
    v_fma_f32 v198, v29, s36, v193
    v_exp_f32 v202, v198
    s_nop 0
    v_add_f32 v197, v197, v202
    v_cvt_pk_bf16_f32 v150, v201, v202
    v_fma_f32 v198, v30, s36, v193
    v_exp_f32 v201, v198
    s_nop 0
    v_add_f32 v197, v197, v201
    v_fma_f32 v198, v31, s36, v193
    v_exp_f32 v202, v198
    s_nop 0
    v_add_f32 v197, v197, v202
    v_cvt_pk_bf16_f32 v151, v201, v202
    v_fma_f32 v198, v48, s36, v193
    v_exp_f32 v201, v198
    s_nop 0
    v_add_f32 v197, v197, v201
    v_fma_f32 v198, v49, s36, v193
    v_exp_f32 v202, v198
    s_nop 0
    v_add_f32 v197, v197, v202
    v_cvt_pk_bf16_f32 v152, v201, v202
    v_fma_f32 v198, v50, s36, v193
    v_exp_f32 v201, v198
    s_nop 0
    v_add_f32 v197, v197, v201
    v_fma_f32 v198, v51, s36, v193
    v_exp_f32 v202, v198
    s_nop 0
    v_add_f32 v197, v197, v202
    v_cvt_pk_bf16_f32 v153, v201, v202
    v_fma_f32 v198, v52, s36, v193
    v_exp_f32 v201, v198
    s_nop 0
    v_add_f32 v197, v197, v201
    v_fma_f32 v198, v53, s36, v193
    v_exp_f32 v202, v198
    s_nop 0
    v_add_f32 v197, v197, v202
    v_cvt_pk_bf16_f32 v154, v201, v202
    v_fma_f32 v198, v54, s36, v193
    v_exp_f32 v201, v198
    s_nop 0
    v_add_f32 v197, v197, v201
    v_fma_f32 v198, v55, s36, v193
    v_exp_f32 v202, v198
    s_nop 0
    v_add_f32 v197, v197, v202
    v_cvt_pk_bf16_f32 v155, v201, v202
    v_fma_f32 v198, v56, s36, v193
    v_exp_f32 v201, v198
    s_nop 0
    v_add_f32 v197, v197, v201
    v_fma_f32 v198, v57, s36, v193
    v_exp_f32 v202, v198
    s_nop 0
    v_add_f32 v197, v197, v202
    v_cvt_pk_bf16_f32 v156, v201, v202
    v_fma_f32 v198, v58, s36, v193
    v_exp_f32 v201, v198
    s_nop 0
    v_add_f32 v197, v197, v201
    v_fma_f32 v198, v59, s36, v193
    v_exp_f32 v202, v198
    s_nop 0
    v_add_f32 v197, v197, v202
    v_cvt_pk_bf16_f32 v157, v201, v202
    v_fma_f32 v198, v60, s36, v193
    v_exp_f32 v201, v198
    s_nop 0
    v_add_f32 v197, v197, v201
    v_fma_f32 v198, v61, s36, v193
    v_exp_f32 v202, v198
    s_nop 0
    v_add_f32 v197, v197, v202
    v_cvt_pk_bf16_f32 v158, v201, v202
    v_fma_f32 v198, v62, s36, v193
    v_exp_f32 v201, v198
    s_nop 0
    v_add_f32 v197, v197, v201
    v_fma_f32 v198, v63, s36, v193
    v_exp_f32 v202, v198
    s_nop 0
    v_add_f32 v197, v197, v202
    v_cvt_pk_bf16_f32 v159, v201, v202
    v_add_f32 v195, v195, v197
    v_mov_b32 v197, 0
    s_nop 3
    s_branch BACK_E0
RARE_E1:
    s_nop 7
    v_max3_f32 v252, v64, v65, v66
    v_max3_f32 v252, v252, v67, v68
    v_max3_f32 v252, v252, v69, v70
    v_max3_f32 v252, v252, v71, v72
    v_max3_f32 v252, v252, v73, v74
    v_max3_f32 v252, v252, v75, v76
    v_max3_f32 v252, v252, v77, v78
    v_max3_f32 v252, v252, v79, v96
    v_max3_f32 v252, v252, v97, v98
    v_max3_f32 v252, v252, v99, v100
    v_max3_f32 v252, v252, v101, v102
    v_max3_f32 v252, v252, v103, v104
    v_max3_f32 v252, v252, v105, v106
    v_max3_f32 v252, v252, v107, v108
    v_max3_f32 v252, v252, v109, v110
    v_max_f32 v252, v252, v111
    v_mov_b32 v253, v252
    s_nop 1
    v_permlane32_swap_b32 v252, v253
    v_max_f32 v252, v252, v253
    v_mul_f32 v252, s36, v252
    v_max_f32 v253, v252, -v192
    v_add_f32 v254, v192, v253
    v_exp_f32 v254, -v254
    v_sub_f32 v192, 0, v253
    v_mul_f32 v194, v194, v254
    v_accvgpr_read_b32 v253, a0
    v_mul_f32 v253, v253, v254
    v_accvgpr_write_b32 a0, v253
    v_accvgpr_read_b32 v255, a1
    v_mul_f32 v255, v255, v254
    v_accvgpr_write_b32 a1, v255
    v_accvgpr_read_b32 v253, a2
    v_mul_f32 v253, v253, v254
    v_accvgpr_write_b32 a2, v253
    v_accvgpr_read_b32 v255, a3
    v_mul_f32 v255, v255, v254
    v_accvgpr_write_b32 a3, v255
    v_accvgpr_read_b32 v253, a4
    v_mul_f32 v253, v253, v254
    v_accvgpr_write_b32 a4, v253
    v_accvgpr_read_b32 v255, a5
    v_mul_f32 v255, v255, v254
    v_accvgpr_write_b32 a5, v255
    v_accvgpr_read_b32 v253, a6
    v_mul_f32 v253, v253, v254
    v_accvgpr_write_b32 a6, v253
    v_accvgpr_read_b32 v255, a7
    v_mul_f32 v255, v255, v254
    v_accvgpr_write_b32 a7, v255
    v_accvgpr_read_b32 v253, a8
    v_mul_f32 v253, v253, v254
    v_accvgpr_write_b32 a8, v253
    v_accvgpr_read_b32 v255, a9
    v_mul_f32 v255, v255, v254
    v_accvgpr_write_b32 a9, v255
    v_accvgpr_read_b32 v253, a10
    v_mul_f32 v253, v253, v254
    v_accvgpr_write_b32 a10, v253
    v_accvgpr_read_b32 v255, a11
    v_mul_f32 v255, v255, v254
    v_accvgpr_write_b32 a11, v255
    v_accvgpr_read_b32 v253, a12
    v_mul_f32 v253, v253, v254
    v_accvgpr_write_b32 a12, v253
    v_accvgpr_read_b32 v255, a13
    v_mul_f32 v255, v255, v254
    v_accvgpr_write_b32 a13, v255
    v_accvgpr_read_b32 v253, a14
    v_mul_f32 v253, v253, v254
    v_accvgpr_write_b32 a14, v253
    v_accvgpr_read_b32 v255, a15
    v_mul_f32 v255, v255, v254
    v_accvgpr_write_b32 a15, v255
    v_accvgpr_read_b32 v253, a16
    v_mul_f32 v253, v253, v254
    v_accvgpr_write_b32 a16, v253
    v_accvgpr_read_b32 v255, a17
    v_mul_f32 v255, v255, v254
    v_accvgpr_write_b32 a17, v255
    v_accvgpr_read_b32 v253, a18
    v_mul_f32 v253, v253, v254
    v_accvgpr_write_b32 a18, v253
    v_accvgpr_read_b32 v255, a19
    v_mul_f32 v255, v255, v254
    v_accvgpr_write_b32 a19, v255
    v_accvgpr_read_b32 v253, a20
    v_mul_f32 v253, v253, v254
    v_accvgpr_write_b32 a20, v253
    v_accvgpr_read_b32 v255, a21
    v_mul_f32 v255, v255, v254
    v_accvgpr_write_b32 a21, v255
    v_accvgpr_read_b32 v253, a22
    v_mul_f32 v253, v253, v254
    v_accvgpr_write_b32 a22, v253
    v_accvgpr_read_b32 v255, a23
    v_mul_f32 v255, v255, v254
    v_accvgpr_write_b32 a23, v255
    v_accvgpr_read_b32 v253, a24
    v_mul_f32 v253, v253, v254
    v_accvgpr_write_b32 a24, v253
    v_accvgpr_read_b32 v255, a25
    v_mul_f32 v255, v255, v254
    v_accvgpr_write_b32 a25, v255
    v_accvgpr_read_b32 v253, a26
    v_mul_f32 v253, v253, v254
    v_accvgpr_write_b32 a26, v253
    v_accvgpr_read_b32 v255, a27
    v_mul_f32 v255, v255, v254
    v_accvgpr_write_b32 a27, v255
    v_accvgpr_read_b32 v253, a28
    v_mul_f32 v253, v253, v254
    v_accvgpr_write_b32 a28, v253
    v_accvgpr_read_b32 v255, a29
    v_mul_f32 v255, v255, v254
    v_accvgpr_write_b32 a29, v255
    v_accvgpr_read_b32 v253, a30
    v_mul_f32 v253, v253, v254
    v_accvgpr_write_b32 a30, v253
    v_accvgpr_read_b32 v255, a31
    v_mul_f32 v255, v255, v254
    v_accvgpr_write_b32 a31, v255
    v_accvgpr_read_b32 v253, a32
    v_mul_f32 v253, v253, v254
    v_accvgpr_write_b32 a32, v253
    v_accvgpr_read_b32 v255, a33
    v_mul_f32 v255, v255, v254
    v_accvgpr_write_b32 a33, v255
    v_accvgpr_read_b32 v253, a34
    v_mul_f32 v253, v253, v254
    v_accvgpr_write_b32 a34, v253
    v_accvgpr_read_b32 v255, a35
    v_mul_f32 v255, v255, v254
    v_accvgpr_write_b32 a35, v255
    v_accvgpr_read_b32 v253, a36
    v_mul_f32 v253, v253, v254
    v_accvgpr_write_b32 a36, v253
    v_accvgpr_read_b32 v255, a37
    v_mul_f32 v255, v255, v254
    v_accvgpr_write_b32 a37, v255
    v_accvgpr_read_b32 v253, a38
    v_mul_f32 v253, v253, v254
    v_accvgpr_write_b32 a38, v253
    v_accvgpr_read_b32 v255, a39
    v_mul_f32 v255, v255, v254
    v_accvgpr_write_b32 a39, v255
    v_accvgpr_read_b32 v253, a40
    v_mul_f32 v253, v253, v254
    v_accvgpr_write_b32 a40, v253
    v_accvgpr_read_b32 v255, a41
    v_mul_f32 v255, v255, v254
    v_accvgpr_write_b32 a41, v255
    v_accvgpr_read_b32 v253, a42
    v_mul_f32 v253, v253, v254
    v_accvgpr_write_b32 a42, v253
    v_accvgpr_read_b32 v255, a43
    v_mul_f32 v255, v255, v254
    v_accvgpr_write_b32 a43, v255
    v_accvgpr_read_b32 v253, a44
    v_mul_f32 v253, v253, v254
    v_accvgpr_write_b32 a44, v253
    v_accvgpr_read_b32 v255, a45
    v_mul_f32 v255, v255, v254
    v_accvgpr_write_b32 a45, v255
    v_accvgpr_read_b32 v253, a46
    v_mul_f32 v253, v253, v254
    v_accvgpr_write_b32 a46, v253
    v_accvgpr_read_b32 v255, a47
    v_mul_f32 v255, v255, v254
    v_accvgpr_write_b32 a47, v255
    v_accvgpr_read_b32 v253, a48
    v_mul_f32 v253, v253, v254
    v_accvgpr_write_b32 a48, v253
    v_accvgpr_read_b32 v255, a49
    v_mul_f32 v255, v255, v254
    v_accvgpr_write_b32 a49, v255
    v_accvgpr_read_b32 v253, a50
    v_mul_f32 v253, v253, v254
    v_accvgpr_write_b32 a50, v253
    v_accvgpr_read_b32 v255, a51
    v_mul_f32 v255, v255, v254
    v_accvgpr_write_b32 a51, v255
    v_accvgpr_read_b32 v253, a52
    v_mul_f32 v253, v253, v254
    v_accvgpr_write_b32 a52, v253
    v_accvgpr_read_b32 v255, a53
    v_mul_f32 v255, v255, v254
    v_accvgpr_write_b32 a53, v255
    v_accvgpr_read_b32 v253, a54
    v_mul_f32 v253, v253, v254
    v_accvgpr_write_b32 a54, v253
    v_accvgpr_read_b32 v255, a55
    v_mul_f32 v255, v255, v254
    v_accvgpr_write_b32 a55, v255
    v_accvgpr_read_b32 v253, a56
    v_mul_f32 v253, v253, v254
    v_accvgpr_write_b32 a56, v253
    v_accvgpr_read_b32 v255, a57
    v_mul_f32 v255, v255, v254
    v_accvgpr_write_b32 a57, v255
    v_accvgpr_read_b32 v253, a58
    v_mul_f32 v253, v253, v254
    v_accvgpr_write_b32 a58, v253
    v_accvgpr_read_b32 v255, a59
    v_mul_f32 v255, v255, v254
    v_accvgpr_write_b32 a59, v255
    v_accvgpr_read_b32 v253, a60
    v_mul_f32 v253, v253, v254
    v_accvgpr_write_b32 a60, v253
    v_accvgpr_read_b32 v255, a61
    v_mul_f32 v255, v255, v254
    v_accvgpr_write_b32 a61, v255
    v_accvgpr_read_b32 v253, a62
    v_mul_f32 v253, v253, v254
    v_accvgpr_write_b32 a62, v253
    v_accvgpr_read_b32 v255, a63
    v_mul_f32 v255, v255, v254
    v_accvgpr_write_b32 a63, v255
    v_mov_b32 v196, 0
    v_fma_f32 v198, v64, s36, v192
    v_exp_f32 v201, v198
    s_nop 0
    v_add_f32 v196, v196, v201
    v_fma_f32 v198, v65, s36, v192
    v_exp_f32 v202, v198
    s_nop 0
    v_add_f32 v196, v196, v202
    v_cvt_pk_bf16_f32 v160, v201, v202
    v_fma_f32 v198, v66, s36, v192
    v_exp_f32 v201, v198
    s_nop 0
    v_add_f32 v196, v196, v201
    v_fma_f32 v198, v67, s36, v192
    v_exp_f32 v202, v198
    s_nop 0
    v_add_f32 v196, v196, v202
    v_cvt_pk_bf16_f32 v161, v201, v202
    v_fma_f32 v198, v68, s36, v192
    v_exp_f32 v201, v198
    s_nop 0
    v_add_f32 v196, v196, v201
    v_fma_f32 v198, v69, s36, v192
    v_exp_f32 v202, v198
    s_nop 0
    v_add_f32 v196, v196, v202
    v_cvt_pk_bf16_f32 v162, v201, v202
    v_fma_f32 v198, v70, s36, v192
    v_exp_f32 v201, v198
    s_nop 0
    v_add_f32 v196, v196, v201
    v_fma_f32 v198, v71, s36, v192
    v_exp_f32 v202, v198
    s_nop 0
    v_add_f32 v196, v196, v202
    v_cvt_pk_bf16_f32 v163, v201, v202
    v_fma_f32 v198, v72, s36, v192
    v_exp_f32 v201, v198
    s_nop 0
    v_add_f32 v196, v196, v201
    v_fma_f32 v198, v73, s36, v192
    v_exp_f32 v202, v198
    s_nop 0
    v_add_f32 v196, v196, v202
    v_cvt_pk_bf16_f32 v164, v201, v202
    v_fma_f32 v198, v74, s36, v192
    v_exp_f32 v201, v198
    s_nop 0
    v_add_f32 v196, v196, v201
    v_fma_f32 v198, v75, s36, v192
    v_exp_f32 v202, v198
    s_nop 0
    v_add_f32 v196, v196, v202
    v_cvt_pk_bf16_f32 v165, v201, v202
    v_fma_f32 v198, v76, s36, v192
    v_exp_f32 v201, v198
    s_nop 0
    v_add_f32 v196, v196, v201
    v_fma_f32 v198, v77, s36, v192
    v_exp_f32 v202, v198
    s_nop 0
    v_add_f32 v196, v196, v202
    v_cvt_pk_bf16_f32 v166, v201, v202
    v_fma_f32 v198, v78, s36, v192
    v_exp_f32 v201, v198
    s_nop 0
    v_add_f32 v196, v196, v201
    v_fma_f32 v198, v79, s36, v192
    v_exp_f32 v202, v198
    s_nop 0
    v_add_f32 v196, v196, v202
    v_cvt_pk_bf16_f32 v167, v201, v202
    v_fma_f32 v198, v96, s36, v192
    v_exp_f32 v201, v198
    s_nop 0
    v_add_f32 v196, v196, v201
    v_fma_f32 v198, v97, s36, v192
    v_exp_f32 v202, v198
    s_nop 0
    v_add_f32 v196, v196, v202
    v_cvt_pk_bf16_f32 v168, v201, v202
    v_fma_f32 v198, v98, s36, v192
    v_exp_f32 v201, v198
    s_nop 0
    v_add_f32 v196, v196, v201
    v_fma_f32 v198, v99, s36, v192
    v_exp_f32 v202, v198
    s_nop 0
    v_add_f32 v196, v196, v202
    v_cvt_pk_bf16_f32 v169, v201, v202
    v_fma_f32 v198, v100, s36, v192
    v_exp_f32 v201, v198
    s_nop 0
    v_add_f32 v196, v196, v201
    v_fma_f32 v198, v101, s36, v192
    v_exp_f32 v202, v198
    s_nop 0
    v_add_f32 v196, v196, v202
    v_cvt_pk_bf16_f32 v170, v201, v202
    v_fma_f32 v198, v102, s36, v192
    v_exp_f32 v201, v198
    s_nop 0
    v_add_f32 v196, v196, v201
    v_fma_f32 v198, v103, s36, v192
    v_exp_f32 v202, v198
    s_nop 0
    v_add_f32 v196, v196, v202
    v_cvt_pk_bf16_f32 v171, v201, v202
    v_fma_f32 v198, v104, s36, v192
    v_exp_f32 v201, v198
    s_nop 0
    v_add_f32 v196, v196, v201
    v_fma_f32 v198, v105, s36, v192
    v_exp_f32 v202, v198
    s_nop 0
    v_add_f32 v196, v196, v202
    v_cvt_pk_bf16_f32 v172, v201, v202
    v_fma_f32 v198, v106, s36, v192
    v_exp_f32 v201, v198
    s_nop 0
    v_add_f32 v196, v196, v201
    v_fma_f32 v198, v107, s36, v192
    v_exp_f32 v202, v198
    s_nop 0
    v_add_f32 v196, v196, v202
    v_cvt_pk_bf16_f32 v173, v201, v202
    v_fma_f32 v198, v108, s36, v192
    v_exp_f32 v201, v198
    s_nop 0
    v_add_f32 v196, v196, v201
    v_fma_f32 v198, v109, s36, v192
    v_exp_f32 v202, v198
    s_nop 0
    v_add_f32 v196, v196, v202
    v_cvt_pk_bf16_f32 v174, v201, v202
    v_fma_f32 v198, v110, s36, v192
    v_exp_f32 v201, v198
    s_nop 0
    v_add_f32 v196, v196, v201
    v_fma_f32 v198, v111, s36, v192
    v_exp_f32 v202, v198
    s_nop 0
    v_add_f32 v196, v196, v202
    v_cvt_pk_bf16_f32 v175, v201, v202
    v_add_f32 v194, v194, v196
    v_mov_b32 v196, 0
    v_max3_f32 v252, v80, v81, v82
    v_max3_f32 v252, v252, v83, v84
    v_max3_f32 v252, v252, v85, v86
    v_max3_f32 v252, v252, v87, v88
    v_max3_f32 v252, v252, v89, v90
    v_max3_f32 v252, v252, v91, v92
    v_max3_f32 v252, v252, v93, v94
    v_max3_f32 v252, v252, v95, v112
    v_max3_f32 v252, v252, v113, v114
    v_max3_f32 v252, v252, v115, v116
    v_max3_f32 v252, v252, v117, v118
    v_max3_f32 v252, v252, v119, v120
    v_max3_f32 v252, v252, v121, v122
    v_max3_f32 v252, v252, v123, v124
    v_max3_f32 v252, v252, v125, v126
    v_max_f32 v252, v252, v127
    v_mov_b32 v253, v252
    s_nop 1
    v_permlane32_swap_b32 v252, v253
    v_max_f32 v252, v252, v253
    v_mul_f32 v252, s36, v252
    v_max_f32 v253, v252, -v193
    v_add_f32 v254, v193, v253
    v_exp_f32 v254, -v254
    v_sub_f32 v193, 0, v253
    v_mul_f32 v195, v195, v254
    v_accvgpr_read_b32 v253, a64
    v_mul_f32 v253, v253, v254
    v_accvgpr_write_b32 a64, v253
    v_accvgpr_read_b32 v255, a65
    v_mul_f32 v255, v255, v254
    v_accvgpr_write_b32 a65, v255
    v_accvgpr_read_b32 v253, a66
    v_mul_f32 v253, v253, v254
    v_accvgpr_write_b32 a66, v253
    v_accvgpr_read_b32 v255, a67
    v_mul_f32 v255, v255, v254
    v_accvgpr_write_b32 a67, v255
    v_accvgpr_read_b32 v253, a68
    v_mul_f32 v253, v253, v254
    v_accvgpr_write_b32 a68, v253
    v_accvgpr_read_b32 v255, a69
    v_mul_f32 v255, v255, v254
    v_accvgpr_write_b32 a69, v255
    v_accvgpr_read_b32 v253, a70
    v_mul_f32 v253, v253, v254
    v_accvgpr_write_b32 a70, v253
    v_accvgpr_read_b32 v255, a71
    v_mul_f32 v255, v255, v254
    v_accvgpr_write_b32 a71, v255
    v_accvgpr_read_b32 v253, a72
    v_mul_f32 v253, v253, v254
    v_accvgpr_write_b32 a72, v253
    v_accvgpr_read_b32 v255, a73
    v_mul_f32 v255, v255, v254
    v_accvgpr_write_b32 a73, v255
    v_accvgpr_read_b32 v253, a74
    v_mul_f32 v253, v253, v254
    v_accvgpr_write_b32 a74, v253
    v_accvgpr_read_b32 v255, a75
    v_mul_f32 v255, v255, v254
    v_accvgpr_write_b32 a75, v255
    v_accvgpr_read_b32 v253, a76
    v_mul_f32 v253, v253, v254
    v_accvgpr_write_b32 a76, v253
    v_accvgpr_read_b32 v255, a77
    v_mul_f32 v255, v255, v254
    v_accvgpr_write_b32 a77, v255
    v_accvgpr_read_b32 v253, a78
    v_mul_f32 v253, v253, v254
    v_accvgpr_write_b32 a78, v253
    v_accvgpr_read_b32 v255, a79
    v_mul_f32 v255, v255, v254
    v_accvgpr_write_b32 a79, v255
    v_accvgpr_read_b32 v253, a80
    v_mul_f32 v253, v253, v254
    v_accvgpr_write_b32 a80, v253
    v_accvgpr_read_b32 v255, a81
    v_mul_f32 v255, v255, v254
    v_accvgpr_write_b32 a81, v255
    v_accvgpr_read_b32 v253, a82
    v_mul_f32 v253, v253, v254
    v_accvgpr_write_b32 a82, v253
    v_accvgpr_read_b32 v255, a83
    v_mul_f32 v255, v255, v254
    v_accvgpr_write_b32 a83, v255
    v_accvgpr_read_b32 v253, a84
    v_mul_f32 v253, v253, v254
    v_accvgpr_write_b32 a84, v253
    v_accvgpr_read_b32 v255, a85
    v_mul_f32 v255, v255, v254
    v_accvgpr_write_b32 a85, v255
    v_accvgpr_read_b32 v253, a86
    v_mul_f32 v253, v253, v254
    v_accvgpr_write_b32 a86, v253
    v_accvgpr_read_b32 v255, a87
    v_mul_f32 v255, v255, v254
    v_accvgpr_write_b32 a87, v255
    v_accvgpr_read_b32 v253, a88
    v_mul_f32 v253, v253, v254
    v_accvgpr_write_b32 a88, v253
    v_accvgpr_read_b32 v255, a89
    v_mul_f32 v255, v255, v254
    v_accvgpr_write_b32 a89, v255
    v_accvgpr_read_b32 v253, a90
    v_mul_f32 v253, v253, v254
    v_accvgpr_write_b32 a90, v253
    v_accvgpr_read_b32 v255, a91
    v_mul_f32 v255, v255, v254
    v_accvgpr_write_b32 a91, v255
    v_accvgpr_read_b32 v253, a92
    v_mul_f32 v253, v253, v254
    v_accvgpr_write_b32 a92, v253
    v_accvgpr_read_b32 v255, a93
    v_mul_f32 v255, v255, v254
    v_accvgpr_write_b32 a93, v255
    v_accvgpr_read_b32 v253, a94
    v_mul_f32 v253, v253, v254
    v_accvgpr_write_b32 a94, v253
    v_accvgpr_read_b32 v255, a95
    v_mul_f32 v255, v255, v254
    v_accvgpr_write_b32 a95, v255
    v_accvgpr_read_b32 v253, a96
    v_mul_f32 v253, v253, v254
    v_accvgpr_write_b32 a96, v253
    v_accvgpr_read_b32 v255, a97
    v_mul_f32 v255, v255, v254
    v_accvgpr_write_b32 a97, v255
    v_accvgpr_read_b32 v253, a98
    v_mul_f32 v253, v253, v254
    v_accvgpr_write_b32 a98, v253
    v_accvgpr_read_b32 v255, a99
    v_mul_f32 v255, v255, v254
    v_accvgpr_write_b32 a99, v255
    v_accvgpr_read_b32 v253, a100
    v_mul_f32 v253, v253, v254
    v_accvgpr_write_b32 a100, v253
    v_accvgpr_read_b32 v255, a101
    v_mul_f32 v255, v255, v254
    v_accvgpr_write_b32 a101, v255
    v_accvgpr_read_b32 v253, a102
    v_mul_f32 v253, v253, v254
    v_accvgpr_write_b32 a102, v253
    v_accvgpr_read_b32 v255, a103
    v_mul_f32 v255, v255, v254
    v_accvgpr_write_b32 a103, v255
    v_accvgpr_read_b32 v253, a104
    v_mul_f32 v253, v253, v254
    v_accvgpr_write_b32 a104, v253
    v_accvgpr_read_b32 v255, a105
    v_mul_f32 v255, v255, v254
    v_accvgpr_write_b32 a105, v255
    v_accvgpr_read_b32 v253, a106
    v_mul_f32 v253, v253, v254
    v_accvgpr_write_b32 a106, v253
    v_accvgpr_read_b32 v255, a107
    v_mul_f32 v255, v255, v254
    v_accvgpr_write_b32 a107, v255
    v_accvgpr_read_b32 v253, a108
    v_mul_f32 v253, v253, v254
    v_accvgpr_write_b32 a108, v253
    v_accvgpr_read_b32 v255, a109
    v_mul_f32 v255, v255, v254
    v_accvgpr_write_b32 a109, v255
    v_accvgpr_read_b32 v253, a110
    v_mul_f32 v253, v253, v254
    v_accvgpr_write_b32 a110, v253
    v_accvgpr_read_b32 v255, a111
    v_mul_f32 v255, v255, v254
    v_accvgpr_write_b32 a111, v255
    v_accvgpr_read_b32 v253, a112
    v_mul_f32 v253, v253, v254
    v_accvgpr_write_b32 a112, v253
    v_accvgpr_read_b32 v255, a113
    v_mul_f32 v255, v255, v254
    v_accvgpr_write_b32 a113, v255
    v_accvgpr_read_b32 v253, a114
    v_mul_f32 v253, v253, v254
    v_accvgpr_write_b32 a114, v253
    v_accvgpr_read_b32 v255, a115
    v_mul_f32 v255, v255, v254
    v_accvgpr_write_b32 a115, v255
    v_accvgpr_read_b32 v253, a116
    v_mul_f32 v253, v253, v254
    v_accvgpr_write_b32 a116, v253
    v_accvgpr_read_b32 v255, a117
    v_mul_f32 v255, v255, v254
    v_accvgpr_write_b32 a117, v255
    v_accvgpr_read_b32 v253, a118
    v_mul_f32 v253, v253, v254
    v_accvgpr_write_b32 a118, v253
    v_accvgpr_read_b32 v255, a119
    v_mul_f32 v255, v255, v254
    v_accvgpr_write_b32 a119, v255
    v_accvgpr_read_b32 v253, a120
    v_mul_f32 v253, v253, v254
    v_accvgpr_write_b32 a120, v253
    v_accvgpr_read_b32 v255, a121
    v_mul_f32 v255, v255, v254
    v_accvgpr_write_b32 a121, v255
    v_accvgpr_read_b32 v253, a122
    v_mul_f32 v253, v253, v254
    v_accvgpr_write_b32 a122, v253
    v_accvgpr_read_b32 v255, a123
    v_mul_f32 v255, v255, v254
    v_accvgpr_write_b32 a123, v255
    v_accvgpr_read_b32 v253, a124
    v_mul_f32 v253, v253, v254
    v_accvgpr_write_b32 a124, v253
    v_accvgpr_read_b32 v255, a125
    v_mul_f32 v255, v255, v254
    v_accvgpr_write_b32 a125, v255
    v_accvgpr_read_b32 v253, a126
    v_mul_f32 v253, v253, v254
    v_accvgpr_write_b32 a126, v253
    v_accvgpr_read_b32 v255, a127
    v_mul_f32 v255, v255, v254
    v_accvgpr_write_b32 a127, v255
    v_mov_b32 v197, 0
    v_fma_f32 v198, v80, s36, v193
    v_exp_f32 v201, v198
    s_nop 0
    v_add_f32 v197, v197, v201
    v_fma_f32 v198, v81, s36, v193
    v_exp_f32 v202, v198
    s_nop 0
    v_add_f32 v197, v197, v202
    v_cvt_pk_bf16_f32 v176, v201, v202
    v_fma_f32 v198, v82, s36, v193
    v_exp_f32 v201, v198
    s_nop 0
    v_add_f32 v197, v197, v201
    v_fma_f32 v198, v83, s36, v193
    v_exp_f32 v202, v198
    s_nop 0
    v_add_f32 v197, v197, v202
    v_cvt_pk_bf16_f32 v177, v201, v202
    v_fma_f32 v198, v84, s36, v193
    v_exp_f32 v201, v198
    s_nop 0
    v_add_f32 v197, v197, v201
    v_fma_f32 v198, v85, s36, v193
    v_exp_f32 v202, v198
    s_nop 0
    v_add_f32 v197, v197, v202
    v_cvt_pk_bf16_f32 v178, v201, v202
    v_fma_f32 v198, v86, s36, v193
    v_exp_f32 v201, v198
    s_nop 0
    v_add_f32 v197, v197, v201
    v_fma_f32 v198, v87, s36, v193
    v_exp_f32 v202, v198
    s_nop 0
    v_add_f32 v197, v197, v202
    v_cvt_pk_bf16_f32 v179, v201, v202
    v_fma_f32 v198, v88, s36, v193
    v_exp_f32 v201, v198
    s_nop 0
    v_add_f32 v197, v197, v201
    v_fma_f32 v198, v89, s36, v193
    v_exp_f32 v202, v198
    s_nop 0
    v_add_f32 v197, v197, v202
    v_cvt_pk_bf16_f32 v180, v201, v202
    v_fma_f32 v198, v90, s36, v193
    v_exp_f32 v201, v198
    s_nop 0
    v_add_f32 v197, v197, v201
    v_fma_f32 v198, v91, s36, v193
    v_exp_f32 v202, v198
    s_nop 0
    v_add_f32 v197, v197, v202
    v_cvt_pk_bf16_f32 v181, v201, v202
    v_fma_f32 v198, v92, s36, v193
    v_exp_f32 v201, v198
    s_nop 0
    v_add_f32 v197, v197, v201
    v_fma_f32 v198, v93, s36, v193
    v_exp_f32 v202, v198
    s_nop 0
    v_add_f32 v197, v197, v202
    v_cvt_pk_bf16_f32 v182, v201, v202
    v_fma_f32 v198, v94, s36, v193
    v_exp_f32 v201, v198
    s_nop 0
    v_add_f32 v197, v197, v201
    v_fma_f32 v198, v95, s36, v193
    v_exp_f32 v202, v198
    s_nop 0
    v_add_f32 v197, v197, v202
    v_cvt_pk_bf16_f32 v183, v201, v202
    v_fma_f32 v198, v112, s36, v193
    v_exp_f32 v201, v198
    s_nop 0
    v_add_f32 v197, v197, v201
    v_fma_f32 v198, v113, s36, v193
    v_exp_f32 v202, v198
    s_nop 0
    v_add_f32 v197, v197, v202
    v_cvt_pk_bf16_f32 v184, v201, v202
    v_fma_f32 v198, v114, s36, v193
    v_exp_f32 v201, v198
    s_nop 0
    v_add_f32 v197, v197, v201
    v_fma_f32 v198, v115, s36, v193
    v_exp_f32 v202, v198
    s_nop 0
    v_add_f32 v197, v197, v202
    v_cvt_pk_bf16_f32 v185, v201, v202
    v_fma_f32 v198, v116, s36, v193
    v_exp_f32 v201, v198
    s_nop 0
    v_add_f32 v197, v197, v201
    v_fma_f32 v198, v117, s36, v193
    v_exp_f32 v202, v198
    s_nop 0
    v_add_f32 v197, v197, v202
    v_cvt_pk_bf16_f32 v186, v201, v202
    v_fma_f32 v198, v118, s36, v193
    v_exp_f32 v201, v198
    s_nop 0
    v_add_f32 v197, v197, v201
    v_fma_f32 v198, v119, s36, v193
    v_exp_f32 v202, v198
    s_nop 0
    v_add_f32 v197, v197, v202
    v_cvt_pk_bf16_f32 v187, v201, v202
    v_fma_f32 v198, v120, s36, v193
    v_exp_f32 v201, v198
    s_nop 0
    v_add_f32 v197, v197, v201
    v_fma_f32 v198, v121, s36, v193
    v_exp_f32 v202, v198
    s_nop 0
    v_add_f32 v197, v197, v202
    v_cvt_pk_bf16_f32 v188, v201, v202
    v_fma_f32 v198, v122, s36, v193
    v_exp_f32 v201, v198
    s_nop 0
    v_add_f32 v197, v197, v201
    v_fma_f32 v198, v123, s36, v193
    v_exp_f32 v202, v198
    s_nop 0
    v_add_f32 v197, v197, v202
    v_cvt_pk_bf16_f32 v189, v201, v202
    v_fma_f32 v198, v124, s36, v193
    v_exp_f32 v201, v198
    s_nop 0
    v_add_f32 v197, v197, v201
    v_fma_f32 v198, v125, s36, v193
    v_exp_f32 v202, v198
    s_nop 0
    v_add_f32 v197, v197, v202
    v_cvt_pk_bf16_f32 v190, v201, v202
    v_fma_f32 v198, v126, s36, v193
    v_exp_f32 v201, v198
    s_nop 0
    v_add_f32 v197, v197, v201
    v_fma_f32 v198, v127, s36, v193
    v_exp_f32 v202, v198
    s_nop 0
    v_add_f32 v197, v197, v202
    v_cvt_pk_bf16_f32 v191, v201, v202
    v_add_f32 v195, v195, v197
    v_mov_b32 v197, 0
    s_nop 3
    s_branch BACK_E1
.section .rodata,"a"
.p2align 6
.amdhsa_kernel tsv_prep_kernel
  .amdhsa_next_free_vgpr 128
  .amdhsa_next_free_sgpr 102
  .amdhsa_accum_offset 128
  .amdhsa_group_segment_fixed_size 0
  .amdhsa_kernarg_size 72
  .amdhsa_user_sgpr_count 2
  .amdhsa_user_sgpr_kernarg_segment_ptr 1
  .amdhsa_system_sgpr_workgroup_id_x 1
.end_amdhsa_kernel
.section .rodata,"a"
.p2align 6
.amdhsa_kernel standalone__tree_speculative_verify_tree_attention_over_candidate_token_tree__prompt_kernel
  .amdhsa_next_free_vgpr 512
  .amdhsa_next_free_sgpr 102
  .amdhsa_accum_offset 256
  .amdhsa_group_segment_fixed_size 0
  .amdhsa_kernarg_size 72
  .amdhsa_user_sgpr_count 2
  .amdhsa_user_sgpr_kernarg_segment_ptr 1
  .amdhsa_system_sgpr_workgroup_id_x 1
.end_amdhsa_kernel
```
